```python
import torch

def _softmax(x, axis=-1):
    return torch.softmax(x, dim=axis)
def _gelu(x):
    return torch.nn.functional.gelu(x, approximate="tanh")
def _silu(x):
    return torch.nn.functional.silu(x)
def _sigmoid(x):
    return torch.sigmoid(x)
def _layernorm(x, axis=-1, eps=1e-5):
    m = x.mean(dim=axis, keepdim=True)
    v = x.var(dim=axis, keepdim=True, unbiased=False)
    return (x - m) / torch.sqrt(v + eps)
def _scatter_add(tgt, idx, src, axis=0):
    return tgt.clone().index_add_(axis, idx, src)
def _segment_sum(src, seg, n):
    out = torch.zeros((n,) + src.shape[1:], dtype=src.dtype)
    return out.index_add_(0, seg, src)
def _pad(x, pw):
    flat = tuple(v for pair in reversed(pw) for v in pair)
    return torch.nn.functional.pad(x, flat)

kernel_name = 'gated_mix__spectral_gfnet__mixer_token_mlp__prompt'

def setup_inputs():

    _w = (lambda a: (lambda t: t.to(torch.bfloat16) if t.is_floating_point() else t)(torch.as_tensor(a)))
    def _A_setup():
        B, S, D = 1, 2048, 576
        Df = D // 2 + 1
        return {
            "x": _w((lambda *s: torch.randn(*s, dtype=torch.bfloat16) * 0.05)(B, S, D)),
            "w_r": _w((lambda *s: torch.randn(*s, dtype=torch.bfloat16) * 1.6)(S, Df) * 0.02),
            "w_i": _w((lambda *s: torch.randn(*s, dtype=torch.bfloat16) * 1.6)(S, Df) * 0.02),
        }
    _A_in = _A_setup()

    def _B_setup():
        B, S, D, F = 1, 2048, 576, 4608
        return {
            "x": _w((lambda *s: torch.randn(*s, dtype=torch.bfloat16) * 0.05)(B, S, D)),
            "w1": _w((lambda *s: torch.randn(*s, dtype=torch.bfloat16) * 0.2)(S, F) * (S ** -0.5)),
            "b1": _w((lambda *s: torch.randn(*s, dtype=torch.bfloat16) * 3.2)(F) * 0.02),
            "w2": _w((lambda *s: torch.randn(*s, dtype=torch.bfloat16) * 0.05)(F, S) * (F ** -0.5)),
            "b2": _w((lambda *s: torch.randn(*s, dtype=torch.bfloat16) * 0.1)(S) * 0.02),
        }
    _B_in = _B_setup()

    return {
        "A_x": _A_in["x"],
        "A_w_r": _A_in["w_r"],
        "A_w_i": _A_in["w_i"],
        "B_x": _B_in["x"],
        "B_w1": _B_in["w1"],
        "B_b1": _B_in["b1"],
        "B_w2": _B_in["w2"],
        "B_b2": _B_in["b2"],
        "gate_w": _w((lambda *s: torch.randn(*s, dtype=torch.bfloat16) * 0.05)(576) * 16.0),
    }

def reference(A_x, A_w_r, A_w_i, B_x, B_w1, B_b1, B_w2, B_b2, gate_w):
    def _A_ref(x, w_r, w_i):
        B, S, D = x.shape
        X = (lambda x, axes=(-2,-1): torch.fft.rfft2(x.float(), dim=axes))(x, axes=(-2, -1))
        W = w_r + 1j * w_i
        X = X * W
        y = (lambda x, s, axes=(-2,-1): torch.fft.irfft2(x, s=s, dim=axes).to(torch.bfloat16))(X, (S, D), axes=(-2, -1))
        return y

    def _B_ref(x, w1, b1, w2, b2):
        B, S, D = x.shape
        h = _layernorm(x, axis=-1)
        u = torch.einsum("bsd,sf->bdf", h, w1) + b1
        u = _gelu(u)
        y = torch.einsum("bdf,fs->bds", u, w2) + b2
        return (lambda x, *d: x.permute(*d))(y, 0, 2, 1)

    x = A_x
    g = _sigmoid((x * gate_w).sum(-1, keepdims=True))
    a = _A_ref(x, A_w_r, A_w_i)
    b = _B_ref(x, B_w1, B_b1, B_w2, B_b2)
    return g * a + (1 - g) * b
```

```asm
; @launch grid=(256,1,1) block=(512,1,1) lds=163840
.amdgcn_target "amdgcn-amd-amdhsa--gfx950"
.text
.globl gated_mix__spectral_gfnet__mixer_token_mlp__prompt_kernel
.p2align 8
.type gated_mix__spectral_gfnet__mixer_token_mlp__prompt_kernel,@function
gated_mix__spectral_gfnet__mixer_token_mlp__prompt_kernel:
    s_cmp_ge_u32 s2, 256
    s_cbranch_scc1 .end_1
    s_load_dwordx16 s[52:67], s[0:1], 0
    s_load_dwordx8 s[68:75], s[0:1], 64
    v_mov_b32 v252, v0
    v_lshrrev_b32 v1, 6, v0
    v_and_b32 v0, 63, v0
    v_readfirstlane_b32 s30, v1
    s_and_b32 s28, s2, 7
    s_lshr_b32 s3, s2, 5
    s_lshl_b32 s3, s3, 3
    s_add_u32 s28, s28, s3
    s_bfe_u32 s29, s2, 0x20003
    s_lshl_b32 s3, s29, 6
    s_add_u32 s3, s3, s28
    s_lshl_b32 s3, s3, 7
    s_add_u32 s50, s3, 8192
    s_cmp_lt_u32 s30, 3
    s_cselect_b32 s51, 0, 188416
    s_cselect_b32 s98, 4, 8
    s_cselect_b32 s99, 2, 1
    s_add_u32 s51, s51, s3
    s_add_u32 s51, s51, 40960
    s_add_u32 s98, s98, 57344
    s_cmp_lt_u32 s30, 4
    s_cbranch_scc1 .hlp_3
    s_setprio 3
    s_and_b32 s36, s30, 1
    s_bfe_u32 s37, s30, 0x10001
    v_lshrrev_b32 v1, 3, v0
    v_and_b32 v3, 7, v0
    v_mul_u32_u24 v2, 73728, v1
    v_lshl_add_u32 v2, v3, 4, v2
    s_lshl_b32 s31, s36, 1
    s_or_b32 s31, s31, s37
    s_lshl_b32 s3, s31, 9
    s_add_u32 s3, s3, s28
    s_mul_i32 s32, s3, 1152
    s_lshl_b32 s38, s29, 8
    s_add_u32 s39, s38, 128
    s_add_u32 s40, s39, 128
    s_add_u32 s41, s40, 128
    s_cmp_eq_u32 s41, 1152
    s_cselect_b32 s41, 0, s41
    s_add_u32 s42, s41, 128
    s_cmp_eq_u32 s42, 1152
    s_cselect_b32 s42, 0, s42
    s_add_u32 s43, s42, 128
    s_cmp_eq_u32 s43, 1152
    s_cselect_b32 s43, 0, s43
    s_add_u32 s44, s43, 128
    s_cmp_eq_u32 s44, 1152
    s_cselect_b32 s44, 0, s44
    s_add_u32 s45, s44, 128
    s_cmp_eq_u32 s45, 1152
    s_cselect_b32 s45, 0, s45
    s_add_u32 s46, s45, 128
    s_cmp_eq_u32 s46, 1152
    s_cselect_b32 s46, 0, s46
    v_add_u32 v2, s32, v2
    s_waitcnt lgkmcnt(0)
    s_mov_b32 s12, s52
    s_mov_b32 s13, s53
    s_mov_b32 s14, 2359296
    s_mov_b32 s15, 0x20000
    buffer_load_dwordx4 v[64:67], v2, s[12:15], s38 offen
    buffer_load_dwordx4 v[68:71], v2, s[12:15], s39 offen
    buffer_load_dwordx4 v[72:75], v2, s[12:15], s40 offen
    buffer_load_dwordx4 v[76:79], v2, s[12:15], s41 offen
    buffer_load_dwordx4 v[80:83], v2, s[12:15], s42 offen
    buffer_load_dwordx4 v[84:87], v2, s[12:15], s43 offen
    buffer_load_dwordx4 v[88:91], v2, s[12:15], s44 offen
    buffer_load_dwordx4 v[92:95], v2, s[12:15], s45 offen
    buffer_load_dwordx4 v[96:99], v2, s[12:15], s46 offen
    s_load_dwordx2 s[96:97], s[74:75], 0
    s_mov_b32 s8, s74
    s_mov_b32 s9, s75
    s_mov_b32 s10, 262144
    s_mov_b32 s11, 0x20000
    s_mov_b32 s16, s60
    s_mov_b32 s17, s61
    s_mov_b32 s18, 18874368
    s_mov_b32 s19, 0x20000
    s_and_b32 s7, s2, 7
    s_mul_i32 s7, s7, 9
    s_lshr_b32 s7, s7, 1
    s_lshl_b32 s7, s7, 8
    s_lshr_b32 s3, s2, 3
    s_mul_i32 s3, s3, 589824
    s_add_u32 s7, s7, s3
    v_add_u32 v255, -128, v252
    v_mul_u32_u24 v253, 6554, v255
    v_lshrrev_b32 v253, 16, v253
    v_mul_u32_u24 v254, 10, v253
    v_sub_u32 v255, v255, v254
    v_and_b32 v254, 1, v253
    v_lshrrev_b32 v253, 1, v253
    v_lshl_add_u32 v253, v254, 5, v253
    v_mul_u32_u24 v253, 9216, v253
    v_lshl_add_u32 v36, v255, 7, v253
    buffer_load_dword v39, v36, s[16:19], s7 offen
    v_add_u32 v255, 128, v252
    v_mul_u32_u24 v253, 6554, v255
    v_lshrrev_b32 v253, 16, v253
    v_mul_u32_u24 v254, 10, v253
    v_sub_u32 v255, v255, v254
    v_and_b32 v254, 1, v253
    v_lshrrev_b32 v253, 1, v253
    v_lshl_add_u32 v253, v254, 5, v253
    v_mul_u32_u24 v253, 9216, v253
    v_lshl_add_u32 v37, v255, 7, v253
    v_lshrrev_b32 v4, 4, v0
    v_and_b32 v5, 15, v0
    v_xor_b32 v6, v3, v4
    s_lshl_b32 s3, s36, 2
    v_xor_b32 v6, s3, v6
    v_lshlrev_b32 v6, 1, v6
    v_lshl_add_u32 v6, v1, 4, v6
    s_and_b32 s35, s30, 3
    s_mul_i32 s3, s35, 1152
    s_add_u32 s3, s3, 7680
    v_add_u32 v6, s3, v6
    v_add_lshl_u32 v100, v6, s38, 3
    v_add_lshl_u32 v101, v6, s39, 3
    v_add_lshl_u32 v102, v6, s40, 3
    v_add_lshl_u32 v103, v6, s41, 3
    v_add_lshl_u32 v104, v6, s42, 3
    v_add_lshl_u32 v105, v6, s43, 3
    v_add_lshl_u32 v106, v6, s44, 3
    v_add_lshl_u32 v107, v6, s45, 3
    v_add_lshl_u32 v108, v6, s46, 3
    s_mul_i32 s44, s37, 98304
    s_lshl_b32 s3, s36, 12
    s_add_u32 s44, s44, s3
    s_add_u32 s45, s44, 24576
    s_cmp_lt_u32 s2, 40
    s_cselect_b32 s45, s44, s45
    s_cselect_b32 s44, 16384, s44
    s_cselect_b32 s39, 0, 8192
    v_mul_u32_u24 v109, 400, v1
    v_lshl_add_u32 v109, v3, 4, v109
    v_add_u32 v109, s45, v109
    v_lshrrev_b32 v6, 2, v5
    v_mul_u32_u24 v114, 400, v6
    v_and_b32 v6, 3, v5
    v_mul_u32_u24 v6, 24, v6
    v_mul_u32_u24 v7, 96, v4
    v_add3_u32 v114, v114, v6, v7
    s_lshl_b32 s3, s29, 5
    s_add_u32 s3, s3, s45
    v_add_u32 v114, s3, v114
    v_mul_u32_u24 v115, 196608, v4
    v_lshl_add_u32 v115, v5, 4, v115
    s_mul_i32 s48, s29, 589824
    s_mul_i32 s3, s28, 3072
    s_add_u32 s48, s48, s3
    s_lshl_b32 s3, s35, 8
    s_add_u32 s48, s48, s3
    v_lshlrev_b32 v200, 4, v3
    s_lshl_b32 s3, s29, 8
    s_add_u32 s3, s3, 58368
    v_add_u32 v200, s3, v200
    v_lshlrev_b32 v201, 3, v1
    s_lshl_b32 s49, s28, 8
    s_lshl_b32 s3, s31, 6
    s_add_u32 s49, s49, s3
    v_mov_b64 v[110:111], 0
    v_mov_b64 v[112:113], 0
    s_mov_b32 s47, 0x3f803f80
    s_add_u32 s20, s74, 262144
    s_addc_u32 s21, s75, 0
    s_mov_b32 s22, 2359296
    s_mov_b32 s23, 0x20000
    s_add_u32 s24, s74, 12648448
    s_addc_u32 s25, s75, 0
    s_mov_b32 s26, 16384
    s_mov_b32 s27, 0x20000
    s_and_b32 s3, s2, 7
    s_mul_i32 s3, s3, 27
    s_lshr_b32 s33, s2, 3
    s_add_u32 s33, s33, s3
    s_sub_u32 s33, s33, 5
    s_mul_i32 s34, s33, 171
    s_lshr_b32 s34, s34, 10
    s_mul_i32 s3, s34, 6
    s_sub_u32 s33, s33, s3
    v_lshrrev_b32 v2, 1, v5
    v_xor_b32 v2, v2, v4
    v_lshlrev_b32 v2, 5, v2
    v_and_b32 v3, 1, v5
    v_lshl_add_u32 v2, v3, 4, v2
    v_mul_u32_u24 v3, 589824, v4
    v_add_u32 v2, v2, v3
    v_xor_b32 v3, 128, v2
    v_add_u32 v38, 4716544, v2
    v_add_u32 v1, 14152704, v3
    v_add_u32 v3, 9436160, v3
    s_lshl_b32 s3, s36, 8
    s_lshl_b32 s38, s37, 5
    s_add_u32 s3, s3, s38
    s_mul_i32 s41, s3, 9216
    s_lshl_b32 s3, s34, 8
    s_add_u32 s41, s41, s3
    s_add_u32 s42, s41, 73728
    s_mov_b32 s45, 0
    s_mov_b32 s43, 0
    s_mul_i32 s40, s33, 5
    s_lshr_b32 s40, 239113312, s40
    s_mul_i32 s3, s34, 0
    s_add_u32 s40, s40, s3
    s_and_b32 s40, s40, 7
    s_mul_i32 s40, s40, 9216
    s_add_u32 s40, s40, s41
    s_mov_b32 s12, s60
    s_mov_b32 s13, s61
    s_mov_b32 s14, 18874368
    s_mov_b32 s15, 0x20000
    s_cmp_lt_u32 s2, 40
    s_cselect_b32 s14, 0, s14
    s_add_u32 m0, s44, s45
    s_add_u32 s45, s45, s39
    buffer_load_dwordx4 v2, s[12:15], s40 offen offset:0 lds
    s_and_b32 s45, s45, 0xffff
    buffer_load_dwordx4 v3, s[12:15], s40 offen offset:1024 lds
    s_add_u32 s43, s43, 1
    buffer_load_dwordx4 v38, s[12:15], s40 offen offset:2048 lds
    s_and_b32 s38, s43, 7
    s_cselect_b32 s38, 0, 73728
    buffer_load_dwordx4 v1, s[12:15], s40 offen offset:3072 lds
    s_add_u32 s40, s40, 9216
    s_cmp_eq_u32 s40, s42
    s_cselect_b32 s40, s41, s40
    s_add_u32 s40, s40, s38
    s_add_u32 s41, s41, s38
    s_add_u32 s42, s42, s38
    s_waitcnt vmcnt(13)
    ds_write_b128 v100, v[64:67]
    v_dot2c_f32_bf16 v110, s47, v64
    v_dot2c_f32_bf16 v112, v64, v64
    v_dot2c_f32_bf16 v111, s47, v65
    v_dot2c_f32_bf16 v113, v65, v65
    v_dot2c_f32_bf16 v110, s47, v66
    v_dot2c_f32_bf16 v112, v66, v66
    v_dot2c_f32_bf16 v111, s47, v67
    v_dot2c_f32_bf16 v113, v67, v67
    v_lshlrev_b32 v116, 16, v64
    v_and_b32 v117, 0xffff0000, v64
    v_lshlrev_b32 v118, 16, v65
    v_and_b32 v119, 0xffff0000, v65
    v_lshlrev_b32 v120, 16, v66
    v_and_b32 v121, 0xffff0000, v66
    v_lshlrev_b32 v122, 16, v67
    v_and_b32 v123, 0xffff0000, v67
    s_waitcnt vmcnt(12)
    ds_write_b128 v101, v[68:71]
    v_dot2c_f32_bf16 v110, s47, v68
    v_dot2c_f32_bf16 v112, v68, v68
    v_dot2c_f32_bf16 v111, s47, v69
    v_dot2c_f32_bf16 v113, v69, v69
    v_dot2c_f32_bf16 v110, s47, v70
    v_dot2c_f32_bf16 v112, v70, v70
    v_dot2c_f32_bf16 v111, s47, v71
    v_dot2c_f32_bf16 v113, v71, v71
    v_lshlrev_b32 v124, 16, v68
    v_and_b32 v125, 0xffff0000, v68
    v_lshlrev_b32 v126, 16, v69
    v_and_b32 v127, 0xffff0000, v69
    v_lshlrev_b32 v128, 16, v70
    v_and_b32 v129, 0xffff0000, v70
    v_lshlrev_b32 v130, 16, v71
    v_and_b32 v131, 0xffff0000, v71
    s_waitcnt vmcnt(11)
    ds_write_b128 v102, v[72:75]
    v_dot2c_f32_bf16 v110, s47, v72
    v_dot2c_f32_bf16 v112, v72, v72
    v_dot2c_f32_bf16 v111, s47, v73
    v_dot2c_f32_bf16 v113, v73, v73
    v_dot2c_f32_bf16 v110, s47, v74
    v_dot2c_f32_bf16 v112, v74, v74
    v_dot2c_f32_bf16 v111, s47, v75
    v_dot2c_f32_bf16 v113, v75, v75
    v_lshlrev_b32 v132, 16, v72
    v_and_b32 v133, 0xffff0000, v72
    v_lshlrev_b32 v134, 16, v73
    v_and_b32 v135, 0xffff0000, v73
    v_lshlrev_b32 v136, 16, v74
    v_and_b32 v137, 0xffff0000, v74
    v_lshlrev_b32 v138, 16, v75
    v_and_b32 v139, 0xffff0000, v75
    s_waitcnt vmcnt(10)
    ds_write_b128 v103, v[76:79]
    v_dot2c_f32_bf16 v110, s47, v76
    v_dot2c_f32_bf16 v112, v76, v76
    v_dot2c_f32_bf16 v111, s47, v77
    v_dot2c_f32_bf16 v113, v77, v77
    v_dot2c_f32_bf16 v110, s47, v78
    v_dot2c_f32_bf16 v112, v78, v78
    v_dot2c_f32_bf16 v111, s47, v79
    v_dot2c_f32_bf16 v113, v79, v79
    s_waitcnt vmcnt(9)
    ds_write_b128 v104, v[80:83]
    v_dot2c_f32_bf16 v110, s47, v80
    v_dot2c_f32_bf16 v112, v80, v80
    v_dot2c_f32_bf16 v111, s47, v81
    v_dot2c_f32_bf16 v113, v81, v81
    v_dot2c_f32_bf16 v110, s47, v82
    v_dot2c_f32_bf16 v112, v82, v82
    v_dot2c_f32_bf16 v111, s47, v83
    v_dot2c_f32_bf16 v113, v83, v83
    s_waitcnt vmcnt(8)
    ds_write_b128 v105, v[84:87]
    v_dot2c_f32_bf16 v110, s47, v84
    v_dot2c_f32_bf16 v112, v84, v84
    v_dot2c_f32_bf16 v111, s47, v85
    v_dot2c_f32_bf16 v113, v85, v85
    v_dot2c_f32_bf16 v110, s47, v86
    v_dot2c_f32_bf16 v112, v86, v86
    v_dot2c_f32_bf16 v111, s47, v87
    v_dot2c_f32_bf16 v113, v87, v87
    s_waitcnt vmcnt(7)
    ds_write_b128 v106, v[88:91]
    v_dot2c_f32_bf16 v110, s47, v88
    v_dot2c_f32_bf16 v112, v88, v88
    v_dot2c_f32_bf16 v111, s47, v89
    v_dot2c_f32_bf16 v113, v89, v89
    v_dot2c_f32_bf16 v110, s47, v90
    v_dot2c_f32_bf16 v112, v90, v90
    v_dot2c_f32_bf16 v111, s47, v91
    v_dot2c_f32_bf16 v113, v91, v91
    s_waitcnt vmcnt(6)
    ds_write_b128 v107, v[92:95]
    v_dot2c_f32_bf16 v110, s47, v92
    v_dot2c_f32_bf16 v112, v92, v92
    v_dot2c_f32_bf16 v111, s47, v93
    v_dot2c_f32_bf16 v113, v93, v93
    v_dot2c_f32_bf16 v110, s47, v94
    v_dot2c_f32_bf16 v112, v94, v94
    v_dot2c_f32_bf16 v111, s47, v95
    v_dot2c_f32_bf16 v113, v95, v95
    s_waitcnt vmcnt(5)
    ds_write_b128 v108, v[96:99]
    v_dot2c_f32_bf16 v110, s47, v96
    v_dot2c_f32_bf16 v112, v96, v96
    v_dot2c_f32_bf16 v111, s47, v97
    v_dot2c_f32_bf16 v113, v97, v97
    v_dot2c_f32_bf16 v110, s47, v98
    v_dot2c_f32_bf16 v112, v98, v98
    v_dot2c_f32_bf16 v111, s47, v99
    v_dot2c_f32_bf16 v113, v99, v99
    s_nop 1
    v_add_f32 v110, v110, v111
    v_add_f32 v112, v112, v113
    s_nop 0
    v_add_f32_dpp v110, v110, v110 quad_perm:[1,0,3,2] row_mask:0xf bank_mask:0xf
    v_add_f32_dpp v112, v112, v112 quad_perm:[1,0,3,2] row_mask:0xf bank_mask:0xf
    s_nop 0
    v_add_f32_dpp v110, v110, v110 quad_perm:[2,3,0,1] row_mask:0xf bank_mask:0xf
    v_add_f32_dpp v112, v112, v112 quad_perm:[2,3,0,1] row_mask:0xf bank_mask:0xf
    s_nop 0
    v_add_f32_dpp v110, v110, v110 row_half_mirror row_mask:0xf bank_mask:0xf
    v_add_f32_dpp v112, v112, v112 row_half_mirror row_mask:0xf bank_mask:0xf
    v_mul_f32 v110, 0x3ae38e39, v110
    v_mul_f32 v112, 0x3ae38e39, v112
    v_fma_f32 v112, -v110, v110, v112
    v_max_f32 v112, 0, v112
    v_cvt_pk_bf16_f32 v112, 0, v112
    v_cvt_pk_bf16_f32 v110, 0, v110
    v_add_f32 v112, 0x3727c5ac, v112
    v_cvt_pk_bf16_f32 v112, 0, v112
    v_sqrt_f32 v112, v112
    s_nop 0
    v_cvt_pk_bf16_f32 v112, 0, v112
    v_rcp_f32 v112, v112
    s_waitcnt lgkmcnt(0)
    s_barrier
    v_mul_f32 v110, -v110, v112
    v_fma_f32 v116, v116, v112, v110
    v_fma_f32 v117, v117, v112, v110
    v_fma_f32 v118, v118, v112, v110
    v_fma_f32 v119, v119, v112, v110
    v_fma_f32 v120, v120, v112, v110
    v_fma_f32 v121, v121, v112, v110
    v_fma_f32 v122, v122, v112, v110
    v_fma_f32 v123, v123, v112, v110
    v_cvt_pk_bf16_f32 v140, v116, v117
    v_cvt_pk_bf16_f32 v141, v118, v119
    v_cvt_pk_bf16_f32 v142, v120, v121
    v_cvt_pk_bf16_f32 v143, v122, v123
    ds_write_b128 v109, v[140:143] offset:0
    v_fma_f32 v124, v124, v112, v110
    v_fma_f32 v125, v125, v112, v110
    v_fma_f32 v126, v126, v112, v110
    v_fma_f32 v127, v127, v112, v110
    v_fma_f32 v128, v128, v112, v110
    v_fma_f32 v129, v129, v112, v110
    v_fma_f32 v130, v130, v112, v110
    v_fma_f32 v131, v131, v112, v110
    v_cvt_pk_bf16_f32 v144, v124, v125
    v_cvt_pk_bf16_f32 v145, v126, v127
    v_cvt_pk_bf16_f32 v146, v128, v129
    v_cvt_pk_bf16_f32 v147, v130, v131
    ds_write_b128 v109, v[144:147] offset:128
    v_fma_f32 v132, v132, v112, v110
    v_fma_f32 v133, v133, v112, v110
    v_fma_f32 v134, v134, v112, v110
    v_fma_f32 v135, v135, v112, v110
    v_fma_f32 v136, v136, v112, v110
    v_fma_f32 v137, v137, v112, v110
    v_fma_f32 v138, v138, v112, v110
    v_fma_f32 v139, v139, v112, v110
    v_cvt_pk_bf16_f32 v148, v132, v133
    v_cvt_pk_bf16_f32 v149, v134, v135
    v_cvt_pk_bf16_f32 v150, v136, v137
    v_cvt_pk_bf16_f32 v151, v138, v139
    ds_write_b128 v109, v[148:151] offset:256
    s_waitcnt lgkmcnt(0)
    ds_read_b64_tr_b16 v[152:153], v114 offset:0
    ds_read_b64_tr_b16 v[154:155], v114 offset:1600
    ds_read_b64_tr_b16 v[156:157], v114 offset:8
    ds_read_b64_tr_b16 v[158:159], v114 offset:1608
    ds_read_b64_tr_b16 v[160:161], v114 offset:16
    ds_read_b64_tr_b16 v[162:163], v114 offset:1616
    s_mul_i32 s96, s96, 0x41c64e6d
    s_mul_i32 s97, s97, 0x2c9277b5
    s_add_u32 s96, s96, 0x3c6ef35f
    s_add_u32 s97, s97, 0x1b873593
    s_mov_b32 exec_hi, 0xffff
    s_waitcnt lgkmcnt(4)
    buffer_store_dwordx4 v[152:155], v115, s[20:23], s48 offen offset:0 sc1
    s_waitcnt lgkmcnt(2)
    buffer_store_dwordx4 v[156:159], v115, s[20:23], s48 offen offset:1024 sc1
    s_waitcnt lgkmcnt(0)
    buffer_store_dwordx4 v[160:163], v115, s[20:23], s48 offen offset:2048 sc1
    s_mov_b32 exec_hi, -1
    s_add_u32 m0, s44, s45
    s_add_u32 s45, s45, s39
    buffer_load_dwordx4 v2, s[12:15], s40 offen offset:0 lds
    s_and_b32 s45, s45, 0xffff
    buffer_load_dwordx4 v3, s[12:15], s40 offen offset:1024 lds
    s_add_u32 s43, s43, 1
    buffer_load_dwordx4 v38, s[12:15], s40 offen offset:2048 lds
    s_and_b32 s38, s43, 7
    s_cselect_b32 s38, 0, 73728
    buffer_load_dwordx4 v1, s[12:15], s40 offen offset:3072 lds
    s_add_u32 s40, s40, 9216
    s_cmp_eq_u32 s40, s42
    s_cselect_b32 s40, s41, s40
    s_add_u32 s40, s40, s38
    s_add_u32 s41, s41, s38
    s_add_u32 s42, s42, s38
    s_waitcnt vmcnt(4)
    s_mov_b64 exec, 1
    v_mov_b32 v32, 57344
    v_mov_b32 v33, 1
    ds_add_rtn_u32 v33, v32, v33
    v_mov_b64 v[34:35], s[96:97]
    s_waitcnt lgkmcnt(0)
    v_readfirstlane_b32 s3, v33
    s_cmp_lg_u32 s3, 3
    s_cbranch_scc1 .nf_9
    buffer_store_dwordx2 v[34:35], off, s[8:11], s50 sc1
.nf_9:
    s_mov_b64 exec, -1
    s_setprio 0
    s_cmp_lg_u32 s35, s29
    s_cbranch_scc1 .ng_10
    ds_read_b128 v[164:167], v200 offset:0
    ds_read_b128 v[168:171], v200 offset:128
    ds_read_b128 v[172:175], v200 offset:256
    ds_read_b128 v[176:179], v200 offset:384
    ds_read_b128 v[180:183], v200 offset:512
    ds_read_b128 v[184:187], v200 offset:640
    ds_read_b128 v[188:191], v200 offset:768
    ds_read_b128 v[192:195], v200 offset:896
    ds_read_b128 v[196:199], v200 offset:1024
    v_mov_b64 v[110:111], 0
    s_waitcnt lgkmcnt(8)
    v_dot2c_f32_bf16 v110, v164, v64
    v_dot2c_f32_bf16 v111, v165, v65
    v_dot2c_f32_bf16 v110, v166, v66
    v_dot2c_f32_bf16 v111, v167, v67
    s_waitcnt lgkmcnt(7)
    v_dot2c_f32_bf16 v110, v168, v68
    v_dot2c_f32_bf16 v111, v169, v69
    v_dot2c_f32_bf16 v110, v170, v70
    v_dot2c_f32_bf16 v111, v171, v71
    s_waitcnt lgkmcnt(6)
    v_dot2c_f32_bf16 v110, v172, v72
    v_dot2c_f32_bf16 v111, v173, v73
    v_dot2c_f32_bf16 v110, v174, v74
    v_dot2c_f32_bf16 v111, v175, v75
    s_waitcnt lgkmcnt(5)
    v_dot2c_f32_bf16 v110, v176, v76
    v_dot2c_f32_bf16 v111, v177, v77
    v_dot2c_f32_bf16 v110, v178, v78
    v_dot2c_f32_bf16 v111, v179, v79
    s_waitcnt lgkmcnt(4)
    v_dot2c_f32_bf16 v110, v180, v80
    v_dot2c_f32_bf16 v111, v181, v81
    v_dot2c_f32_bf16 v110, v182, v82
    v_dot2c_f32_bf16 v111, v183, v83
    s_waitcnt lgkmcnt(3)
    v_dot2c_f32_bf16 v110, v184, v84
    v_dot2c_f32_bf16 v111, v185, v85
    v_dot2c_f32_bf16 v110, v186, v86
    v_dot2c_f32_bf16 v111, v187, v87
    s_waitcnt lgkmcnt(2)
    v_dot2c_f32_bf16 v110, v188, v88
    v_dot2c_f32_bf16 v111, v189, v89
    v_dot2c_f32_bf16 v110, v190, v90
    v_dot2c_f32_bf16 v111, v191, v91
    s_waitcnt lgkmcnt(1)
    v_dot2c_f32_bf16 v110, v192, v92
    v_dot2c_f32_bf16 v111, v193, v93
    v_dot2c_f32_bf16 v110, v194, v94
    v_dot2c_f32_bf16 v111, v195, v95
    s_waitcnt lgkmcnt(0)
    v_dot2c_f32_bf16 v110, v196, v96
    v_dot2c_f32_bf16 v111, v197, v97
    v_dot2c_f32_bf16 v110, v198, v98
    v_dot2c_f32_bf16 v111, v199, v99
    s_nop 2
    v_add_f32 v110, v110, v111
    s_nop 1
    v_add_f32_dpp v110, v110, v110 quad_perm:[1,0,3,2] row_mask:0xf bank_mask:0xf
    s_nop 1
    v_add_f32_dpp v110, v110, v110 quad_perm:[2,3,0,1] row_mask:0xf bank_mask:0xf
    s_nop 1
    v_add_f32_dpp v110, v110, v110 row_half_mirror row_mask:0xf bank_mask:0xf
    v_cvt_pk_bf16_f32 v110, 0, v110
    v_mul_f32 v110, 0xbfb8aa3b, v110
    v_exp_f32 v110, v110
    s_nop 0
    v_add_f32 v110, 1.0, v110
    v_rcp_f32 v110, v110
    s_nop 0
    v_cvt_pk_bf16_f32 v110, 0, v110
    v_sub_f32 v111, 1.0, v110
    v_cvt_pk_bf16_f32 v111, 0, v111
    v_mul_f32 v110, 0x35e38e39, v110
    s_mov_b32 exec_lo, 0x01010101
    s_mov_b32 exec_hi, 0x01010101
    buffer_store_dwordx2 v[110:111], v201, s[24:27], s49 offen sc1
    s_mov_b64 exec, -1
.ng_10:
    s_add_u32 m0, s44, s45
    s_add_u32 s45, s45, s39
    buffer_load_dwordx4 v2, s[12:15], s40 offen offset:0 lds
    s_and_b32 s45, s45, 0xffff
    buffer_load_dwordx4 v3, s[12:15], s40 offen offset:1024 lds
    s_add_u32 s43, s43, 1
    buffer_load_dwordx4 v38, s[12:15], s40 offen offset:2048 lds
    s_and_b32 s38, s43, 7
    s_cselect_b32 s38, 0, 73728
    buffer_load_dwordx4 v1, s[12:15], s40 offen offset:3072 lds
    s_add_u32 s40, s40, 9216
    s_cmp_eq_u32 s40, s42
    s_cselect_b32 s40, s41, s40
    s_add_u32 s40, s40, s38
    s_add_u32 s41, s41, s38
    s_add_u32 s42, s42, s38
    s_add_u32 m0, s44, s45
    s_add_u32 s45, s45, s39
    buffer_load_dwordx4 v2, s[12:15], s40 offen offset:0 lds
    s_and_b32 s45, s45, 0xffff
    buffer_load_dwordx4 v3, s[12:15], s40 offen offset:1024 lds
    s_add_u32 s43, s43, 1
    buffer_load_dwordx4 v38, s[12:15], s40 offen offset:2048 lds
    s_and_b32 s38, s43, 7
    s_cselect_b32 s38, 0, 73728
    buffer_load_dwordx4 v1, s[12:15], s40 offen offset:3072 lds
    s_add_u32 s40, s40, 9216
    s_cmp_eq_u32 s40, s42
    s_cselect_b32 s40, s41, s40
    s_add_u32 s40, s40, s38
    s_add_u32 s41, s41, s38
    s_add_u32 s42, s42, s38
    s_cmp_lg_u32 s35, s29
    s_cbranch_scc1 .ng_11
    s_waitcnt vmcnt(8)
    s_mov_b64 exec, 1
    v_mov_b32 v32, s98
    v_mov_b32 v33, 1
    ds_add_rtn_u32 v33, v32, v33
    v_mov_b64 v[34:35], s[96:97]
    s_waitcnt lgkmcnt(0)
    v_readfirstlane_b32 s3, v33
    s_cmp_lg_u32 s3, s99
    s_cbranch_scc1 .nf_15
    buffer_store_dwordx2 v[34:35], off, s[8:11], s51 sc1
.nf_15:
    s_mov_b64 exec, -1
.ng_11:
    buffer_load_dword v39, v37, s[16:19], s7 offen
    s_cmp_lt_u32 s2, 40
    s_cbranch_scc1 .fft_5
.tabs_6:
    s_cmp_eq_u32 s30, 7
    s_cbranch_scc1 .sa_13
    v_and_b32 v7, 15, v0
    v_lshrrev_b32 v8, 4, v0
    v_lshrrev_b32 v4, 2, v7
    v_mul_u32_u24 v4, 12, v4
    v_and_b32 v9, 3, v7
    v_add_u32 v4, v4, v9
    s_mul_i32 s6, s29, 3
    s_add_u32 s6, s6, s35
    s_mul_i32 s6, s6, 48
    v_add_u32 v4, s6, v4
    v_cvt_f32_u32 v4, v4
    v_lshlrev_b32 v14, 1, v8
    v_cvt_f32_u32 v14, v14
    v_lshlrev_b32 v15, 31, v7
    v_or_b32 v15, 0x3f003f00, v15
    s_mov_b64 s[4:5], 0xffff
    v_add_f32 v5, 0x00000000, v4
    v_mul_f32 v5, 0x3ae38e39, v5
    v_mul_f32 v6, v5, v14
    v_add_f32 v11, 0x3e800000, v6
    v_mul_f32 v12, 0x41800000, v5
    v_cos_f32 v12, v12
    v_mov_b32 v16, v6
    v_mov_b32 v17, v11
    v_fmamk_f32 v18, v5, 0x3f800000, v6
    v_fmamk_f32 v19, v5, 0x3f800000, v11
    v_fmamk_f32 v20, v5, 0x41000000, v6
    v_fmamk_f32 v21, v5, 0x41000000, v11
    v_fmamk_f32 v22, v5, 0x41100000, v6
    v_fmamk_f32 v23, v5, 0x41100000, v11
    v_cos_f32 v16, v16
    v_cos_f32 v17, v17
    v_cos_f32 v18, v18
    v_cos_f32 v19, v19
    v_cos_f32 v20, v20
    v_cos_f32 v21, v21
    v_cos_f32 v22, v22
    v_cos_f32 v23, v23
    v_add_f32 v12, v12, v12
    v_fmamk_f32 v24, v5, 0x41800000, v6
    v_fmamk_f32 v25, v5, 0x41800000, v11
    v_fmamk_f32 v26, v5, 0x41880000, v6
    v_fmamk_f32 v27, v5, 0x41880000, v11
    v_fmamk_f32 v28, v5, 0x41c00000, v6
    v_fmamk_f32 v29, v5, 0x41c00000, v11
    v_fmamk_f32 v30, v5, 0x41c80000, v6
    v_fmamk_f32 v31, v5, 0x41c80000, v11
    v_cos_f32 v24, v24
    v_cos_f32 v25, v25
    v_cos_f32 v26, v26
    v_cos_f32 v27, v27
    v_cos_f32 v28, v28
    v_cos_f32 v29, v29
    v_cos_f32 v30, v30
    v_cos_f32 v31, v31
    v_cvt_pk_bf16_f32 v40, v16, v17
    v_cvt_pk_bf16_f32 v41, v18, v19
    v_cvt_pk_bf16_f32 v42, v20, v21
    v_cvt_pk_bf16_f32 v43, v22, v23
    v_cvt_pk_bf16_f32 v52, v24, v25
    v_cvt_pk_bf16_f32 v53, v26, v27
    v_cvt_pk_bf16_f32 v54, v28, v29
    v_cvt_pk_bf16_f32 v55, v30, v31
    v_pk_fma_f32 v[16:17], v[12:13], v[24:25], v[16:17] op_sel_hi:[0,1,1] neg_lo:[0,0,1] neg_hi:[0,0,1]
    v_pk_fma_f32 v[18:19], v[12:13], v[26:27], v[18:19] op_sel_hi:[0,1,1] neg_lo:[0,0,1] neg_hi:[0,0,1]
    v_pk_fma_f32 v[20:21], v[12:13], v[28:29], v[20:21] op_sel_hi:[0,1,1] neg_lo:[0,0,1] neg_hi:[0,0,1]
    v_pk_fma_f32 v[22:23], v[12:13], v[30:31], v[22:23] op_sel_hi:[0,1,1] neg_lo:[0,0,1] neg_hi:[0,0,1]
    v_cvt_pk_bf16_f32 v64, v16, v17
    v_cvt_pk_bf16_f32 v65, v18, v19
    v_cvt_pk_bf16_f32 v66, v20, v21
    v_cvt_pk_bf16_f32 v67, v22, v23
    v_pk_fma_f32 v[24:25], v[12:13], v[16:17], v[24:25] op_sel_hi:[0,1,1] neg_lo:[0,0,1] neg_hi:[0,0,1]
    v_pk_fma_f32 v[26:27], v[12:13], v[18:19], v[26:27] op_sel_hi:[0,1,1] neg_lo:[0,0,1] neg_hi:[0,0,1]
    v_pk_fma_f32 v[28:29], v[12:13], v[20:21], v[28:29] op_sel_hi:[0,1,1] neg_lo:[0,0,1] neg_hi:[0,0,1]
    v_pk_fma_f32 v[30:31], v[12:13], v[22:23], v[30:31] op_sel_hi:[0,1,1] neg_lo:[0,0,1] neg_hi:[0,0,1]
    v_cvt_pk_bf16_f32 v76, v24, v25
    v_cvt_pk_bf16_f32 v77, v26, v27
    v_cvt_pk_bf16_f32 v78, v28, v29
    v_cvt_pk_bf16_f32 v79, v30, v31
    v_pk_fma_f32 v[16:17], v[12:13], v[24:25], v[16:17] op_sel_hi:[0,1,1] neg_lo:[0,0,1] neg_hi:[0,0,1]
    v_pk_fma_f32 v[18:19], v[12:13], v[26:27], v[18:19] op_sel_hi:[0,1,1] neg_lo:[0,0,1] neg_hi:[0,0,1]
    v_pk_fma_f32 v[20:21], v[12:13], v[28:29], v[20:21] op_sel_hi:[0,1,1] neg_lo:[0,0,1] neg_hi:[0,0,1]
    v_pk_fma_f32 v[22:23], v[12:13], v[30:31], v[22:23] op_sel_hi:[0,1,1] neg_lo:[0,0,1] neg_hi:[0,0,1]
    v_cvt_pk_bf16_f32 v88, v16, v17
    v_cvt_pk_bf16_f32 v89, v18, v19
    v_cvt_pk_bf16_f32 v90, v20, v21
    v_cvt_pk_bf16_f32 v91, v22, v23
    v_pk_fma_f32 v[24:25], v[12:13], v[16:17], v[24:25] op_sel_hi:[0,1,1] neg_lo:[0,0,1] neg_hi:[0,0,1]
    v_pk_fma_f32 v[26:27], v[12:13], v[18:19], v[26:27] op_sel_hi:[0,1,1] neg_lo:[0,0,1] neg_hi:[0,0,1]
    v_pk_fma_f32 v[28:29], v[12:13], v[20:21], v[28:29] op_sel_hi:[0,1,1] neg_lo:[0,0,1] neg_hi:[0,0,1]
    v_pk_fma_f32 v[30:31], v[12:13], v[22:23], v[30:31] op_sel_hi:[0,1,1] neg_lo:[0,0,1] neg_hi:[0,0,1]
    v_cvt_pk_bf16_f32 v100, v24, v25
    v_cvt_pk_bf16_f32 v101, v26, v27
    v_cvt_pk_bf16_f32 v102, v28, v29
    v_cvt_pk_bf16_f32 v103, v30, v31
    v_pk_fma_f32 v[16:17], v[12:13], v[24:25], v[16:17] op_sel_hi:[0,1,1] neg_lo:[0,0,1] neg_hi:[0,0,1]
    v_pk_fma_f32 v[18:19], v[12:13], v[26:27], v[18:19] op_sel_hi:[0,1,1] neg_lo:[0,0,1] neg_hi:[0,0,1]
    v_pk_fma_f32 v[20:21], v[12:13], v[28:29], v[20:21] op_sel_hi:[0,1,1] neg_lo:[0,0,1] neg_hi:[0,0,1]
    v_pk_fma_f32 v[22:23], v[12:13], v[30:31], v[22:23] op_sel_hi:[0,1,1] neg_lo:[0,0,1] neg_hi:[0,0,1]
    v_cvt_pk_bf16_f32 v112, v16, v17
    v_cvt_pk_bf16_f32 v113, v18, v19
    v_cvt_pk_bf16_f32 v114, v20, v21
    v_cvt_pk_bf16_f32 v115, v22, v23
    v_pk_fma_f32 v[24:25], v[12:13], v[16:17], v[24:25] op_sel_hi:[0,1,1] neg_lo:[0,0,1] neg_hi:[0,0,1]
    v_pk_fma_f32 v[26:27], v[12:13], v[18:19], v[26:27] op_sel_hi:[0,1,1] neg_lo:[0,0,1] neg_hi:[0,0,1]
    v_pk_fma_f32 v[28:29], v[12:13], v[20:21], v[28:29] op_sel_hi:[0,1,1] neg_lo:[0,0,1] neg_hi:[0,0,1]
    v_pk_fma_f32 v[30:31], v[12:13], v[22:23], v[30:31] op_sel_hi:[0,1,1] neg_lo:[0,0,1] neg_hi:[0,0,1]
    v_cvt_pk_bf16_f32 v124, v24, v25
    v_cvt_pk_bf16_f32 v125, v26, v27
    v_cvt_pk_bf16_f32 v126, v28, v29
    v_cvt_pk_bf16_f32 v127, v30, v31
    v_pk_fma_f32 v[16:17], v[12:13], v[24:25], v[16:17] op_sel_hi:[0,1,1] neg_lo:[0,0,1] neg_hi:[0,0,1]
    v_pk_fma_f32 v[18:19], v[12:13], v[26:27], v[18:19] op_sel_hi:[0,1,1] neg_lo:[0,0,1] neg_hi:[0,0,1]
    v_pk_fma_f32 v[20:21], v[12:13], v[28:29], v[20:21] op_sel_hi:[0,1,1] neg_lo:[0,0,1] neg_hi:[0,0,1]
    v_pk_fma_f32 v[22:23], v[12:13], v[30:31], v[22:23] op_sel_hi:[0,1,1] neg_lo:[0,0,1] neg_hi:[0,0,1]
    v_cvt_pk_bf16_f32 v136, v16, v17
    v_cvt_pk_bf16_f32 v137, v18, v19
    v_cvt_pk_bf16_f32 v138, v20, v21
    v_cvt_pk_bf16_f32 v139, v22, v23
    v_pk_fma_f32 v[24:25], v[12:13], v[16:17], v[24:25] op_sel_hi:[0,1,1] neg_lo:[0,0,1] neg_hi:[0,0,1]
    v_pk_fma_f32 v[26:27], v[12:13], v[18:19], v[26:27] op_sel_hi:[0,1,1] neg_lo:[0,0,1] neg_hi:[0,0,1]
    v_pk_fma_f32 v[28:29], v[12:13], v[20:21], v[28:29] op_sel_hi:[0,1,1] neg_lo:[0,0,1] neg_hi:[0,0,1]
    v_pk_fma_f32 v[30:31], v[12:13], v[22:23], v[30:31] op_sel_hi:[0,1,1] neg_lo:[0,0,1] neg_hi:[0,0,1]
    v_cvt_pk_bf16_f32 v148, v24, v25
    v_cvt_pk_bf16_f32 v149, v26, v27
    v_cvt_pk_bf16_f32 v150, v28, v29
    v_cvt_pk_bf16_f32 v151, v30, v31
    v_pk_fma_f32 v[16:17], v[12:13], v[24:25], v[16:17] op_sel_hi:[0,1,1] neg_lo:[0,0,1] neg_hi:[0,0,1]
    v_pk_fma_f32 v[18:19], v[12:13], v[26:27], v[18:19] op_sel_hi:[0,1,1] neg_lo:[0,0,1] neg_hi:[0,0,1]
    v_pk_fma_f32 v[20:21], v[12:13], v[28:29], v[20:21] op_sel_hi:[0,1,1] neg_lo:[0,0,1] neg_hi:[0,0,1]
    v_pk_fma_f32 v[22:23], v[12:13], v[30:31], v[22:23] op_sel_hi:[0,1,1] neg_lo:[0,0,1] neg_hi:[0,0,1]
    v_cvt_pk_bf16_f32 v160, v16, v17
    v_cvt_pk_bf16_f32 v161, v18, v19
    v_cvt_pk_bf16_f32 v162, v20, v21
    v_cvt_pk_bf16_f32 v163, v22, v23
    v_pk_fma_f32 v[24:25], v[12:13], v[16:17], v[24:25] op_sel_hi:[0,1,1] neg_lo:[0,0,1] neg_hi:[0,0,1]
    v_pk_fma_f32 v[26:27], v[12:13], v[18:19], v[26:27] op_sel_hi:[0,1,1] neg_lo:[0,0,1] neg_hi:[0,0,1]
    v_pk_fma_f32 v[28:29], v[12:13], v[20:21], v[28:29] op_sel_hi:[0,1,1] neg_lo:[0,0,1] neg_hi:[0,0,1]
    v_pk_fma_f32 v[30:31], v[12:13], v[22:23], v[30:31] op_sel_hi:[0,1,1] neg_lo:[0,0,1] neg_hi:[0,0,1]
    v_cvt_pk_bf16_f32 v172, v24, v25
    v_cvt_pk_bf16_f32 v173, v26, v27
    v_cvt_pk_bf16_f32 v174, v28, v29
    v_cvt_pk_bf16_f32 v175, v30, v31
    v_pk_fma_f32 v[16:17], v[12:13], v[24:25], v[16:17] op_sel_hi:[0,1,1] neg_lo:[0,0,1] neg_hi:[0,0,1]
    v_pk_fma_f32 v[18:19], v[12:13], v[26:27], v[18:19] op_sel_hi:[0,1,1] neg_lo:[0,0,1] neg_hi:[0,0,1]
    v_pk_fma_f32 v[20:21], v[12:13], v[28:29], v[20:21] op_sel_hi:[0,1,1] neg_lo:[0,0,1] neg_hi:[0,0,1]
    v_pk_fma_f32 v[22:23], v[12:13], v[30:31], v[22:23] op_sel_hi:[0,1,1] neg_lo:[0,0,1] neg_hi:[0,0,1]
    v_cvt_pk_bf16_f32 v184, v16, v17
    v_cvt_pk_bf16_f32 v185, v18, v19
    v_cvt_pk_bf16_f32 v186, v20, v21
.sa_13:
    s_cmp_lt_u32 s2, 40
    s_cbranch_scc1 .tb_12
.tb_12:
    s_cmp_eq_u32 s30, 7
    s_cbranch_scc1 .sb_14
    v_cvt_pk_bf16_f32 v187, v22, v23
    v_pk_fma_f32 v[24:25], v[12:13], v[16:17], v[24:25] op_sel_hi:[0,1,1] neg_lo:[0,0,1] neg_hi:[0,0,1]
    v_pk_fma_f32 v[26:27], v[12:13], v[18:19], v[26:27] op_sel_hi:[0,1,1] neg_lo:[0,0,1] neg_hi:[0,0,1]
    v_pk_fma_f32 v[28:29], v[12:13], v[20:21], v[28:29] op_sel_hi:[0,1,1] neg_lo:[0,0,1] neg_hi:[0,0,1]
    v_pk_fma_f32 v[30:31], v[12:13], v[22:23], v[30:31] op_sel_hi:[0,1,1] neg_lo:[0,0,1] neg_hi:[0,0,1]
    v_cvt_pk_bf16_f32 v196, v24, v25
    v_cvt_pk_bf16_f32 v197, v26, v27
    v_cvt_pk_bf16_f32 v198, v28, v29
    v_cvt_pk_bf16_f32 v199, v30, v31
    v_pk_fma_f32 v[16:17], v[12:13], v[24:25], v[16:17] op_sel_hi:[0,1,1] neg_lo:[0,0,1] neg_hi:[0,0,1]
    v_pk_fma_f32 v[18:19], v[12:13], v[26:27], v[18:19] op_sel_hi:[0,1,1] neg_lo:[0,0,1] neg_hi:[0,0,1]
    v_pk_fma_f32 v[20:21], v[12:13], v[28:29], v[20:21] op_sel_hi:[0,1,1] neg_lo:[0,0,1] neg_hi:[0,0,1]
    v_pk_fma_f32 v[22:23], v[12:13], v[30:31], v[22:23] op_sel_hi:[0,1,1] neg_lo:[0,0,1] neg_hi:[0,0,1]
    v_cvt_pk_bf16_f32 v208, v16, v17
    v_cvt_pk_bf16_f32 v209, v18, v19
    v_cvt_pk_bf16_f32 v210, v20, v21
    v_cvt_pk_bf16_f32 v211, v22, v23
    v_pk_fma_f32 v[24:25], v[12:13], v[16:17], v[24:25] op_sel_hi:[0,1,1] neg_lo:[0,0,1] neg_hi:[0,0,1]
    v_pk_fma_f32 v[26:27], v[12:13], v[18:19], v[26:27] op_sel_hi:[0,1,1] neg_lo:[0,0,1] neg_hi:[0,0,1]
    v_pk_fma_f32 v[28:29], v[12:13], v[20:21], v[28:29] op_sel_hi:[0,1,1] neg_lo:[0,0,1] neg_hi:[0,0,1]
    v_pk_fma_f32 v[30:31], v[12:13], v[22:23], v[30:31] op_sel_hi:[0,1,1] neg_lo:[0,0,1] neg_hi:[0,0,1]
    v_cvt_pk_bf16_f32 v220, v24, v25
    v_cvt_pk_bf16_f32 v221, v26, v27
    v_cvt_pk_bf16_f32 v222, v28, v29
    v_cvt_pk_bf16_f32 v223, v30, v31
    v_pk_fma_f32 v[16:17], v[12:13], v[24:25], v[16:17] op_sel_hi:[0,1,1] neg_lo:[0,0,1] neg_hi:[0,0,1]
    v_pk_fma_f32 v[18:19], v[12:13], v[26:27], v[18:19] op_sel_hi:[0,1,1] neg_lo:[0,0,1] neg_hi:[0,0,1]
    v_pk_fma_f32 v[20:21], v[12:13], v[28:29], v[20:21] op_sel_hi:[0,1,1] neg_lo:[0,0,1] neg_hi:[0,0,1]
    v_pk_fma_f32 v[22:23], v[12:13], v[30:31], v[22:23] op_sel_hi:[0,1,1] neg_lo:[0,0,1] neg_hi:[0,0,1]
    v_cvt_pk_bf16_f32 v232, v16, v17
    v_cvt_pk_bf16_f32 v233, v18, v19
    v_cvt_pk_bf16_f32 v234, v20, v21
    v_cvt_pk_bf16_f32 v235, v22, v23
    v_pk_fma_f32 v[24:25], v[12:13], v[16:17], v[24:25] op_sel_hi:[0,1,1] neg_lo:[0,0,1] neg_hi:[0,0,1]
    v_pk_fma_f32 v[26:27], v[12:13], v[18:19], v[26:27] op_sel_hi:[0,1,1] neg_lo:[0,0,1] neg_hi:[0,0,1]
    v_pk_fma_f32 v[28:29], v[12:13], v[20:21], v[28:29] op_sel_hi:[0,1,1] neg_lo:[0,0,1] neg_hi:[0,0,1]
    v_pk_fma_f32 v[30:31], v[12:13], v[22:23], v[30:31] op_sel_hi:[0,1,1] neg_lo:[0,0,1] neg_hi:[0,0,1]
    v_cvt_pk_bf16_f32 v244, v24, v25
    v_cvt_pk_bf16_f32 v245, v26, v27
    v_cvt_pk_bf16_f32 v246, v28, v29
    v_cvt_pk_bf16_f32 v247, v30, v31
    v_cndmask_b32 v40, v40, v15, s[4:5]
    v_add_f32 v5, 0x40800000, v4
    v_mul_f32 v5, 0x3ae38e39, v5
    v_mul_f32 v6, v5, v14
    v_add_f32 v11, 0x3e800000, v6
    v_mul_f32 v12, 0x41800000, v5
    v_cos_f32 v12, v12
    v_mov_b32 v16, v6
    v_mov_b32 v17, v11
    v_fmamk_f32 v18, v5, 0x3f800000, v6
    v_fmamk_f32 v19, v5, 0x3f800000, v11
    v_fmamk_f32 v20, v5, 0x41000000, v6
    v_fmamk_f32 v21, v5, 0x41000000, v11
    v_fmamk_f32 v22, v5, 0x41100000, v6
    v_fmamk_f32 v23, v5, 0x41100000, v11
    v_cos_f32 v16, v16
    v_cos_f32 v17, v17
    v_cos_f32 v18, v18
    v_cos_f32 v19, v19
    v_cos_f32 v20, v20
    v_cos_f32 v21, v21
    v_cos_f32 v22, v22
    v_cos_f32 v23, v23
    v_add_f32 v12, v12, v12
    v_fmamk_f32 v24, v5, 0x41800000, v6
    v_fmamk_f32 v25, v5, 0x41800000, v11
    v_fmamk_f32 v26, v5, 0x41880000, v6
    v_fmamk_f32 v27, v5, 0x41880000, v11
    v_fmamk_f32 v28, v5, 0x41c00000, v6
    v_fmamk_f32 v29, v5, 0x41c00000, v11
    v_fmamk_f32 v30, v5, 0x41c80000, v6
    v_fmamk_f32 v31, v5, 0x41c80000, v11
    v_cos_f32 v24, v24
    v_cos_f32 v25, v25
    v_cos_f32 v26, v26
    v_cos_f32 v27, v27
    v_cos_f32 v28, v28
    v_cos_f32 v29, v29
    v_cos_f32 v30, v30
    v_cos_f32 v31, v31
    v_cvt_pk_bf16_f32 v44, v16, v17
    v_cvt_pk_bf16_f32 v45, v18, v19
    v_cvt_pk_bf16_f32 v46, v20, v21
    v_cvt_pk_bf16_f32 v47, v22, v23
    v_cvt_pk_bf16_f32 v56, v24, v25
    v_cvt_pk_bf16_f32 v57, v26, v27
    v_cvt_pk_bf16_f32 v58, v28, v29
    v_cvt_pk_bf16_f32 v59, v30, v31
    v_pk_fma_f32 v[16:17], v[12:13], v[24:25], v[16:17] op_sel_hi:[0,1,1] neg_lo:[0,0,1] neg_hi:[0,0,1]
    v_pk_fma_f32 v[18:19], v[12:13], v[26:27], v[18:19] op_sel_hi:[0,1,1] neg_lo:[0,0,1] neg_hi:[0,0,1]
    v_pk_fma_f32 v[20:21], v[12:13], v[28:29], v[20:21] op_sel_hi:[0,1,1] neg_lo:[0,0,1] neg_hi:[0,0,1]
    v_pk_fma_f32 v[22:23], v[12:13], v[30:31], v[22:23] op_sel_hi:[0,1,1] neg_lo:[0,0,1] neg_hi:[0,0,1]
    v_cvt_pk_bf16_f32 v68, v16, v17
    v_cvt_pk_bf16_f32 v69, v18, v19
    v_cvt_pk_bf16_f32 v70, v20, v21
    v_cvt_pk_bf16_f32 v71, v22, v23
    v_pk_fma_f32 v[24:25], v[12:13], v[16:17], v[24:25] op_sel_hi:[0,1,1] neg_lo:[0,0,1] neg_hi:[0,0,1]
    v_pk_fma_f32 v[26:27], v[12:13], v[18:19], v[26:27] op_sel_hi:[0,1,1] neg_lo:[0,0,1] neg_hi:[0,0,1]
    v_pk_fma_f32 v[28:29], v[12:13], v[20:21], v[28:29] op_sel_hi:[0,1,1] neg_lo:[0,0,1] neg_hi:[0,0,1]
    v_pk_fma_f32 v[30:31], v[12:13], v[22:23], v[30:31] op_sel_hi:[0,1,1] neg_lo:[0,0,1] neg_hi:[0,0,1]
    v_cvt_pk_bf16_f32 v80, v24, v25
    v_cvt_pk_bf16_f32 v81, v26, v27
    v_cvt_pk_bf16_f32 v82, v28, v29
    v_cvt_pk_bf16_f32 v83, v30, v31
    v_pk_fma_f32 v[16:17], v[12:13], v[24:25], v[16:17] op_sel_hi:[0,1,1] neg_lo:[0,0,1] neg_hi:[0,0,1]
    v_pk_fma_f32 v[18:19], v[12:13], v[26:27], v[18:19] op_sel_hi:[0,1,1] neg_lo:[0,0,1] neg_hi:[0,0,1]
    v_pk_fma_f32 v[20:21], v[12:13], v[28:29], v[20:21] op_sel_hi:[0,1,1] neg_lo:[0,0,1] neg_hi:[0,0,1]
    v_pk_fma_f32 v[22:23], v[12:13], v[30:31], v[22:23] op_sel_hi:[0,1,1] neg_lo:[0,0,1] neg_hi:[0,0,1]
    v_cvt_pk_bf16_f32 v92, v16, v17
    v_cvt_pk_bf16_f32 v93, v18, v19
    v_cvt_pk_bf16_f32 v94, v20, v21
    v_cvt_pk_bf16_f32 v95, v22, v23
    v_pk_fma_f32 v[24:25], v[12:13], v[16:17], v[24:25] op_sel_hi:[0,1,1] neg_lo:[0,0,1] neg_hi:[0,0,1]
    v_pk_fma_f32 v[26:27], v[12:13], v[18:19], v[26:27] op_sel_hi:[0,1,1] neg_lo:[0,0,1] neg_hi:[0,0,1]
    v_pk_fma_f32 v[28:29], v[12:13], v[20:21], v[28:29] op_sel_hi:[0,1,1] neg_lo:[0,0,1] neg_hi:[0,0,1]
    v_pk_fma_f32 v[30:31], v[12:13], v[22:23], v[30:31] op_sel_hi:[0,1,1] neg_lo:[0,0,1] neg_hi:[0,0,1]
    v_cvt_pk_bf16_f32 v104, v24, v25
    v_cvt_pk_bf16_f32 v105, v26, v27
    v_cvt_pk_bf16_f32 v106, v28, v29
    v_cvt_pk_bf16_f32 v107, v30, v31
    v_pk_fma_f32 v[16:17], v[12:13], v[24:25], v[16:17] op_sel_hi:[0,1,1] neg_lo:[0,0,1] neg_hi:[0,0,1]
    v_pk_fma_f32 v[18:19], v[12:13], v[26:27], v[18:19] op_sel_hi:[0,1,1] neg_lo:[0,0,1] neg_hi:[0,0,1]
    v_pk_fma_f32 v[20:21], v[12:13], v[28:29], v[20:21] op_sel_hi:[0,1,1] neg_lo:[0,0,1] neg_hi:[0,0,1]
    v_pk_fma_f32 v[22:23], v[12:13], v[30:31], v[22:23] op_sel_hi:[0,1,1] neg_lo:[0,0,1] neg_hi:[0,0,1]
    v_cvt_pk_bf16_f32 v116, v16, v17
    v_cvt_pk_bf16_f32 v117, v18, v19
    v_cvt_pk_bf16_f32 v118, v20, v21
    v_cvt_pk_bf16_f32 v119, v22, v23
    v_pk_fma_f32 v[24:25], v[12:13], v[16:17], v[24:25] op_sel_hi:[0,1,1] neg_lo:[0,0,1] neg_hi:[0,0,1]
    v_pk_fma_f32 v[26:27], v[12:13], v[18:19], v[26:27] op_sel_hi:[0,1,1] neg_lo:[0,0,1] neg_hi:[0,0,1]
    v_pk_fma_f32 v[28:29], v[12:13], v[20:21], v[28:29] op_sel_hi:[0,1,1] neg_lo:[0,0,1] neg_hi:[0,0,1]
    v_pk_fma_f32 v[30:31], v[12:13], v[22:23], v[30:31] op_sel_hi:[0,1,1] neg_lo:[0,0,1] neg_hi:[0,0,1]
    v_cvt_pk_bf16_f32 v128, v24, v25
    v_cvt_pk_bf16_f32 v129, v26, v27
    v_cvt_pk_bf16_f32 v130, v28, v29
    v_cvt_pk_bf16_f32 v131, v30, v31
    v_pk_fma_f32 v[16:17], v[12:13], v[24:25], v[16:17] op_sel_hi:[0,1,1] neg_lo:[0,0,1] neg_hi:[0,0,1]
    v_pk_fma_f32 v[18:19], v[12:13], v[26:27], v[18:19] op_sel_hi:[0,1,1] neg_lo:[0,0,1] neg_hi:[0,0,1]
    v_pk_fma_f32 v[20:21], v[12:13], v[28:29], v[20:21] op_sel_hi:[0,1,1] neg_lo:[0,0,1] neg_hi:[0,0,1]
    v_pk_fma_f32 v[22:23], v[12:13], v[30:31], v[22:23] op_sel_hi:[0,1,1] neg_lo:[0,0,1] neg_hi:[0,0,1]
    v_cvt_pk_bf16_f32 v140, v16, v17
    v_cvt_pk_bf16_f32 v141, v18, v19
    v_cvt_pk_bf16_f32 v142, v20, v21
    v_cvt_pk_bf16_f32 v143, v22, v23
    v_pk_fma_f32 v[24:25], v[12:13], v[16:17], v[24:25] op_sel_hi:[0,1,1] neg_lo:[0,0,1] neg_hi:[0,0,1]
    v_pk_fma_f32 v[26:27], v[12:13], v[18:19], v[26:27] op_sel_hi:[0,1,1] neg_lo:[0,0,1] neg_hi:[0,0,1]
    v_pk_fma_f32 v[28:29], v[12:13], v[20:21], v[28:29] op_sel_hi:[0,1,1] neg_lo:[0,0,1] neg_hi:[0,0,1]
    v_pk_fma_f32 v[30:31], v[12:13], v[22:23], v[30:31] op_sel_hi:[0,1,1] neg_lo:[0,0,1] neg_hi:[0,0,1]
    v_cvt_pk_bf16_f32 v152, v24, v25
    v_cvt_pk_bf16_f32 v153, v26, v27
    v_cvt_pk_bf16_f32 v154, v28, v29
    v_cvt_pk_bf16_f32 v155, v30, v31
    v_pk_fma_f32 v[16:17], v[12:13], v[24:25], v[16:17] op_sel_hi:[0,1,1] neg_lo:[0,0,1] neg_hi:[0,0,1]
    v_pk_fma_f32 v[18:19], v[12:13], v[26:27], v[18:19] op_sel_hi:[0,1,1] neg_lo:[0,0,1] neg_hi:[0,0,1]
    v_pk_fma_f32 v[20:21], v[12:13], v[28:29], v[20:21] op_sel_hi:[0,1,1] neg_lo:[0,0,1] neg_hi:[0,0,1]
    v_pk_fma_f32 v[22:23], v[12:13], v[30:31], v[22:23] op_sel_hi:[0,1,1] neg_lo:[0,0,1] neg_hi:[0,0,1]
    v_cvt_pk_bf16_f32 v164, v16, v17
    v_cvt_pk_bf16_f32 v165, v18, v19
    v_cvt_pk_bf16_f32 v166, v20, v21
    v_cvt_pk_bf16_f32 v167, v22, v23
    v_pk_fma_f32 v[24:25], v[12:13], v[16:17], v[24:25] op_sel_hi:[0,1,1] neg_lo:[0,0,1] neg_hi:[0,0,1]
    v_pk_fma_f32 v[26:27], v[12:13], v[18:19], v[26:27] op_sel_hi:[0,1,1] neg_lo:[0,0,1] neg_hi:[0,0,1]
    v_pk_fma_f32 v[28:29], v[12:13], v[20:21], v[28:29] op_sel_hi:[0,1,1] neg_lo:[0,0,1] neg_hi:[0,0,1]
    v_pk_fma_f32 v[30:31], v[12:13], v[22:23], v[30:31] op_sel_hi:[0,1,1] neg_lo:[0,0,1] neg_hi:[0,0,1]
    v_cvt_pk_bf16_f32 v176, v24, v25
    v_cvt_pk_bf16_f32 v177, v26, v27
    v_cvt_pk_bf16_f32 v178, v28, v29
    v_cvt_pk_bf16_f32 v179, v30, v31
    v_pk_fma_f32 v[16:17], v[12:13], v[24:25], v[16:17] op_sel_hi:[0,1,1] neg_lo:[0,0,1] neg_hi:[0,0,1]
    v_pk_fma_f32 v[18:19], v[12:13], v[26:27], v[18:19] op_sel_hi:[0,1,1] neg_lo:[0,0,1] neg_hi:[0,0,1]
    v_pk_fma_f32 v[20:21], v[12:13], v[28:29], v[20:21] op_sel_hi:[0,1,1] neg_lo:[0,0,1] neg_hi:[0,0,1]
    v_pk_fma_f32 v[22:23], v[12:13], v[30:31], v[22:23] op_sel_hi:[0,1,1] neg_lo:[0,0,1] neg_hi:[0,0,1]
    v_cvt_pk_bf16_f32 v188, v16, v17
    v_cvt_pk_bf16_f32 v189, v18, v19
    v_cvt_pk_bf16_f32 v190, v20, v21
    v_cvt_pk_bf16_f32 v191, v22, v23
    v_pk_fma_f32 v[24:25], v[12:13], v[16:17], v[24:25] op_sel_hi:[0,1,1] neg_lo:[0,0,1] neg_hi:[0,0,1]
    v_pk_fma_f32 v[26:27], v[12:13], v[18:19], v[26:27] op_sel_hi:[0,1,1] neg_lo:[0,0,1] neg_hi:[0,0,1]
    v_pk_fma_f32 v[28:29], v[12:13], v[20:21], v[28:29] op_sel_hi:[0,1,1] neg_lo:[0,0,1] neg_hi:[0,0,1]
    v_pk_fma_f32 v[30:31], v[12:13], v[22:23], v[30:31] op_sel_hi:[0,1,1] neg_lo:[0,0,1] neg_hi:[0,0,1]
    v_cvt_pk_bf16_f32 v200, v24, v25
    v_cvt_pk_bf16_f32 v201, v26, v27
    v_cvt_pk_bf16_f32 v202, v28, v29
    v_cvt_pk_bf16_f32 v203, v30, v31
    v_pk_fma_f32 v[16:17], v[12:13], v[24:25], v[16:17] op_sel_hi:[0,1,1] neg_lo:[0,0,1] neg_hi:[0,0,1]
    v_pk_fma_f32 v[18:19], v[12:13], v[26:27], v[18:19] op_sel_hi:[0,1,1] neg_lo:[0,0,1] neg_hi:[0,0,1]
    v_pk_fma_f32 v[20:21], v[12:13], v[28:29], v[20:21] op_sel_hi:[0,1,1] neg_lo:[0,0,1] neg_hi:[0,0,1]
    v_pk_fma_f32 v[22:23], v[12:13], v[30:31], v[22:23] op_sel_hi:[0,1,1] neg_lo:[0,0,1] neg_hi:[0,0,1]
    v_cvt_pk_bf16_f32 v212, v16, v17
    v_cvt_pk_bf16_f32 v213, v18, v19
    v_cvt_pk_bf16_f32 v214, v20, v21
    v_cvt_pk_bf16_f32 v215, v22, v23
    v_pk_fma_f32 v[24:25], v[12:13], v[16:17], v[24:25] op_sel_hi:[0,1,1] neg_lo:[0,0,1] neg_hi:[0,0,1]
    v_pk_fma_f32 v[26:27], v[12:13], v[18:19], v[26:27] op_sel_hi:[0,1,1] neg_lo:[0,0,1] neg_hi:[0,0,1]
    v_pk_fma_f32 v[28:29], v[12:13], v[20:21], v[28:29] op_sel_hi:[0,1,1] neg_lo:[0,0,1] neg_hi:[0,0,1]
    v_pk_fma_f32 v[30:31], v[12:13], v[22:23], v[30:31] op_sel_hi:[0,1,1] neg_lo:[0,0,1] neg_hi:[0,0,1]
    v_cvt_pk_bf16_f32 v224, v24, v25
    v_cvt_pk_bf16_f32 v225, v26, v27
    v_cvt_pk_bf16_f32 v226, v28, v29
    v_cvt_pk_bf16_f32 v227, v30, v31
    v_pk_fma_f32 v[16:17], v[12:13], v[24:25], v[16:17] op_sel_hi:[0,1,1] neg_lo:[0,0,1] neg_hi:[0,0,1]
    v_pk_fma_f32 v[18:19], v[12:13], v[26:27], v[18:19] op_sel_hi:[0,1,1] neg_lo:[0,0,1] neg_hi:[0,0,1]
    v_pk_fma_f32 v[20:21], v[12:13], v[28:29], v[20:21] op_sel_hi:[0,1,1] neg_lo:[0,0,1] neg_hi:[0,0,1]
    v_pk_fma_f32 v[22:23], v[12:13], v[30:31], v[22:23] op_sel_hi:[0,1,1] neg_lo:[0,0,1] neg_hi:[0,0,1]
    v_cvt_pk_bf16_f32 v236, v16, v17
    v_cvt_pk_bf16_f32 v237, v18, v19
    v_cvt_pk_bf16_f32 v238, v20, v21
    v_cvt_pk_bf16_f32 v239, v22, v23
    v_pk_fma_f32 v[24:25], v[12:13], v[16:17], v[24:25] op_sel_hi:[0,1,1] neg_lo:[0,0,1] neg_hi:[0,0,1]
    v_pk_fma_f32 v[26:27], v[12:13], v[18:19], v[26:27] op_sel_hi:[0,1,1] neg_lo:[0,0,1] neg_hi:[0,0,1]
    v_pk_fma_f32 v[28:29], v[12:13], v[20:21], v[28:29] op_sel_hi:[0,1,1] neg_lo:[0,0,1] neg_hi:[0,0,1]
    v_pk_fma_f32 v[30:31], v[12:13], v[22:23], v[30:31] op_sel_hi:[0,1,1] neg_lo:[0,0,1] neg_hi:[0,0,1]
    v_cvt_pk_bf16_f32 v248, v24, v25
    v_cvt_pk_bf16_f32 v249, v26, v27
    v_cvt_pk_bf16_f32 v250, v28, v29
    v_cvt_pk_bf16_f32 v251, v30, v31
    v_cndmask_b32 v44, v44, v15, s[4:5]
    v_add_f32 v5, 0x41000000, v4
    v_mul_f32 v5, 0x3ae38e39, v5
    v_mul_f32 v6, v5, v14
    v_add_f32 v11, 0x3e800000, v6
    v_mul_f32 v12, 0x41800000, v5
    v_cos_f32 v12, v12
    v_mov_b32 v16, v6
    v_mov_b32 v17, v11
    v_fmamk_f32 v18, v5, 0x3f800000, v6
    v_fmamk_f32 v19, v5, 0x3f800000, v11
    v_fmamk_f32 v20, v5, 0x41000000, v6
    v_fmamk_f32 v21, v5, 0x41000000, v11
    v_fmamk_f32 v22, v5, 0x41100000, v6
    v_fmamk_f32 v23, v5, 0x41100000, v11
    v_cos_f32 v16, v16
    v_cos_f32 v17, v17
    v_cos_f32 v18, v18
    v_cos_f32 v19, v19
    v_cos_f32 v20, v20
    v_cos_f32 v21, v21
    v_cos_f32 v22, v22
    v_cos_f32 v23, v23
    v_add_f32 v12, v12, v12
    v_fmamk_f32 v24, v5, 0x41800000, v6
    v_fmamk_f32 v25, v5, 0x41800000, v11
    v_fmamk_f32 v26, v5, 0x41880000, v6
    v_fmamk_f32 v27, v5, 0x41880000, v11
    v_fmamk_f32 v28, v5, 0x41c00000, v6
    v_fmamk_f32 v29, v5, 0x41c00000, v11
    v_fmamk_f32 v30, v5, 0x41c80000, v6
    v_fmamk_f32 v31, v5, 0x41c80000, v11
    v_cos_f32 v24, v24
.sb_14:
    s_cmp_lt_u32 s2, 40
    s_cbranch_scc1 .seam_7
    s_waitcnt vmcnt(12)
    s_barrier
    s_mov_b32 s46, 28
.g1lloop_16:
    s_waitcnt vmcnt(8)
    s_barrier
    s_add_u32 m0, s44, s45
    s_add_u32 s45, s45, s39
    buffer_load_dwordx4 v2, s[12:15], s40 offen offset:0 lds
    s_and_b32 s45, s45, 0xffff
    buffer_load_dwordx4 v3, s[12:15], s40 offen offset:1024 lds
    s_add_u32 s43, s43, 1
    buffer_load_dwordx4 v38, s[12:15], s40 offen offset:2048 lds
    s_and_b32 s38, s43, 7
    s_cselect_b32 s38, 0, 73728
    buffer_load_dwordx4 v1, s[12:15], s40 offen offset:3072 lds
    s_add_u32 s40, s40, 9216
    s_cmp_eq_u32 s40, s42
    s_cselect_b32 s40, s41, s40
    s_add_u32 s40, s40, s38
    s_add_u32 s41, s41, s38
    s_add_u32 s42, s42, s38
    s_sub_u32 s46, s46, 1
    s_cmp_lg_u32 s46, 0
    s_cbranch_scc1 .g1lloop_16
.seam_7:
    s_and_b32 s31, s2, 3
    s_bfe_u32 s33, s2, 0x10002
    s_lshl_b32 s33, s33, 3
    s_lshr_b32 s3, s2, 5
    s_add_u32 s33, s33, s3
    s_lshl_b32 s34, s33, 2
    s_add_u32 s34, s34, s29
    v_and_b32 v34, 15, v0
    v_lshrrev_b32 v35, 4, v0
    v_lshrrev_b32 v32, 1, v34
    v_xor_b32 v32, v32, v35
    v_lshlrev_b32 v32, 5, v32
    v_and_b32 v34, 1, v34
    v_lshl_add_u32 v32, v34, 4, v32
    v_lshl_add_u32 v32, v35, 12, v32
    s_mul_i32 s41, s31, 4718592
    s_lshl_b32 s3, s33, 8
    s_add_u32 s41, s41, s3
    v_lshrrev_b32 v33, 3, v0
    v_lshlrev_b32 v33, 13, v33
    v_and_b32 v35, 1, v35
    v_and_b32 v34, 7, v0
    v_xor_b32 v34, v34, v35
    v_lshl_add_u32 v33, v34, 4, v33
    s_lshl_b32 s44, s33, 9
    s_lshl_b32 s3, s31, 7
    s_add_u32 s44, s44, s3
    s_lshl_b32 s3, s35, 16
    s_add_u32 s44, s44, s3
    s_lshl_b32 s39, s35, 10
    s_add_u32 s39, s39, 65536
    s_sub_u32 s45, s39, 0
    s_add_u32 s47, s39, 98304
    s_mov_b32 s48, s39
    s_lshr_b32 s3, s2, 5
    s_lshl_b32 s51, s29, 1
    s_add_u32 s51, s51, s3
    s_mul_i32 s51, s51, 0
    s_lshr_b32 s51, s51, 1
    s_sub_u32 s3, s51, 36
    s_cselect_b32 s51, s51, s3
    s_mov_b32 s12, s64
    s_mov_b32 s13, s65
    s_mov_b32 s14, 18874368
    s_mov_b32 s15, 0x20000
    s_add_u32 s20, s74, 10289152
    s_addc_u32 s21, s75, 0
    s_mov_b32 s22, 2359296
    s_mov_b32 s23, 0x20000
    s_cmp_eq_u32 s30, 7
    s_cbranch_scc1 .g2w7_17
    s_and_b32 s3, s35, 1
    s_lshl_b32 s3, s3, 7
    v_xor_b32 v32, s3, v32
    s_lshl_b32 s3, s35, 14
    s_add_u32 s41, s41, s3
    v_lshlrev_b32 v1, 4, v0
    s_mul_i32 s36, s29, 3
    s_add_u32 s36, s36, s35
    s_lshl_b32 s3, s36, 2
    s_add_u32 s3, s3, s31
    s_mul_i32 s43, s3, 110592
    s_mul_i32 s3, s3, 2304
    s_add_u32 s3, s3, 73728
    v_lshlrev_b32 v34, 7, v0
    v_add_u32 v35, 182016, v34
    v_min_u32 v35, 188928, v35
    v_add_u32 v34, s3, v34
    v_cmp_gt_u32 vcc, 18, v0
    s_nop 1
    v_cndmask_b32 v34, v35, v34, vcc
    s_mul_i32 s38, s35, 3072
    s_add_u32 s49, s38, 64512
    s_mov_b32 s50, s38
    s_mov_b32 s28, s43
    s_add_u32 s32, s43, 110592
    s_mul_i32 s3, s51, 3072
    s_add_u32 s43, s43, s3
    s_mov_b32 s37, s41
    s_add_u32 s40, s41, 4718592
    s_lshl_b32 s3, s51, 17
    s_add_u32 s41, s41, s3
    s_add_u32 s16, s74, 4980736
    s_addc_u32 s17, s75, 0
    s_mov_b32 s18, 5308416
    s_mov_b32 s19, 0x20000
    s_waitcnt vmcnt(8)
    s_barrier
    s_mov_b32 m0, s39
    s_add_u32 s39, s39, 8192
    buffer_load_dwordx4 v32, s[12:15], s41 offen lds
    s_add_u32 s41, s41, 131072
    s_cmp_eq_u32 s41, s40
    s_cselect_b32 s41, s37, s41
    s_cmp_eq_u32 s39, s47
    s_cselect_b32 s39, s48, s39
    s_mov_b32 m0, s39
    s_add_u32 s39, s39, 8192
    buffer_load_dwordx4 v32, s[12:15], s41 offen lds
    s_add_u32 s41, s41, 131072
    s_cmp_eq_u32 s41, s40
    s_cselect_b32 s41, s37, s41
    s_cmp_eq_u32 s39, s47
    s_cselect_b32 s39, s48, s39
    s_mov_b32 m0, s39
    s_add_u32 s39, s39, 8192
    buffer_load_dwordx4 v32, s[12:15], s41 offen lds
    s_add_u32 s41, s41, 131072
    s_cmp_eq_u32 s41, s40
    s_cselect_b32 s41, s37, s41
    s_cmp_eq_u32 s39, s47
    s_cselect_b32 s39, s48, s39
    s_mov_b32 m0, s39
    s_add_u32 s39, s39, 8192
    buffer_load_dwordx4 v32, s[12:15], s41 offen lds
    s_add_u32 s41, s41, 131072
    s_cmp_eq_u32 s41, s40
    s_cselect_b32 s41, s37, s41
    s_cmp_eq_u32 s39, s47
    s_cselect_b32 s39, s48, s39
    s_waitcnt vmcnt(8)
    s_barrier
    s_mov_b32 m0, s39
    s_add_u32 s39, s39, 8192
    buffer_load_dwordx4 v32, s[12:15], s41 offen lds
    s_add_u32 s41, s41, 131072
    s_cmp_eq_u32 s41, s40
    s_cselect_b32 s41, s37, s41
    s_cmp_eq_u32 s39, s47
    s_cselect_b32 s39, s48, s39
    s_mov_b32 m0, s39
    s_add_u32 s39, s39, 8192
    buffer_load_dwordx4 v32, s[12:15], s41 offen lds
    s_add_u32 s41, s41, 131072
    s_cmp_eq_u32 s41, s40
    s_cselect_b32 s41, s37, s41
    s_cmp_eq_u32 s39, s47
    s_cselect_b32 s39, s48, s39
    s_waitcnt vmcnt(6)
    s_barrier
    s_mov_b32 m0, s39
    s_add_u32 s39, s39, 8192
    buffer_load_dwordx4 v32, s[12:15], s41 offen lds
    s_add_u32 s41, s41, 131072
    s_cmp_eq_u32 s41, s40
    s_cselect_b32 s41, s37, s41
    s_cmp_eq_u32 s39, s47
    s_cselect_b32 s39, s48, s39
    s_mov_b32 m0, s39
    s_add_u32 s39, s39, 8192
    buffer_load_dwordx4 v32, s[12:15], s41 offen lds
    s_add_u32 s41, s41, 131072
    s_cmp_eq_u32 s41, s40
    s_cselect_b32 s41, s37, s41
    s_cmp_eq_u32 s39, s47
    s_cselect_b32 s39, s48, s39
    s_barrier
    s_mov_b32 m0, s39
    s_add_u32 s39, s39, 8192
    buffer_load_dwordx4 v32, s[12:15], s41 offen lds
    s_add_u32 s41, s41, 131072
    s_cmp_eq_u32 s41, s40
    s_cselect_b32 s41, s37, s41
    s_cmp_eq_u32 s39, s47
    s_cselect_b32 s39, s48, s39
    s_mov_b32 m0, s39
    s_add_u32 s39, s39, 8192
    buffer_load_dwordx4 v32, s[12:15], s41 offen lds
    s_add_u32 s41, s41, 131072
    s_cmp_eq_u32 s41, s40
    s_cselect_b32 s41, s37, s41
    s_cmp_eq_u32 s39, s47
    s_cselect_b32 s39, s48, s39
    s_barrier
    s_mov_b32 m0, s39
    s_add_u32 s39, s39, 8192
    buffer_load_dwordx4 v32, s[12:15], s41 offen lds
    s_add_u32 s41, s41, 131072
    s_cmp_eq_u32 s41, s40
    s_cselect_b32 s41, s37, s41
    s_cmp_eq_u32 s39, s47
    s_cselect_b32 s39, s48, s39
    s_mov_b32 m0, s39
    s_add_u32 s39, s39, 8192
    buffer_load_dwordx4 v32, s[12:15], s41 offen lds
    s_add_u32 s41, s41, 131072
    s_cmp_eq_u32 s41, s40
    s_cselect_b32 s41, s37, s41
    s_cmp_eq_u32 s39, s47
    s_cselect_b32 s39, s48, s39
    s_barrier
    v_cos_f32 v25, v25
    v_cos_f32 v26, v26
    v_cos_f32 v27, v27
    v_cos_f32 v28, v28
    v_cos_f32 v29, v29
    v_cos_f32 v30, v30
    v_cos_f32 v31, v31
    v_cvt_pk_bf16_f32 v48, v16, v17
    v_cvt_pk_bf16_f32 v49, v18, v19
    v_cvt_pk_bf16_f32 v50, v20, v21
    v_cvt_pk_bf16_f32 v51, v22, v23
    v_cvt_pk_bf16_f32 v60, v24, v25
    v_cvt_pk_bf16_f32 v61, v26, v27
    v_cvt_pk_bf16_f32 v62, v28, v29
    v_cvt_pk_bf16_f32 v63, v30, v31
    v_pk_fma_f32 v[16:17], v[12:13], v[24:25], v[16:17] op_sel_hi:[0,1,1] neg_lo:[0,0,1] neg_hi:[0,0,1]
    v_pk_fma_f32 v[18:19], v[12:13], v[26:27], v[18:19] op_sel_hi:[0,1,1] neg_lo:[0,0,1] neg_hi:[0,0,1]
    v_pk_fma_f32 v[20:21], v[12:13], v[28:29], v[20:21] op_sel_hi:[0,1,1] neg_lo:[0,0,1] neg_hi:[0,0,1]
    v_pk_fma_f32 v[22:23], v[12:13], v[30:31], v[22:23] op_sel_hi:[0,1,1] neg_lo:[0,0,1] neg_hi:[0,0,1]
    v_cvt_pk_bf16_f32 v72, v16, v17
    v_cvt_pk_bf16_f32 v73, v18, v19
    v_cvt_pk_bf16_f32 v74, v20, v21
    v_cvt_pk_bf16_f32 v75, v22, v23
    v_pk_fma_f32 v[24:25], v[12:13], v[16:17], v[24:25] op_sel_hi:[0,1,1] neg_lo:[0,0,1] neg_hi:[0,0,1]
    v_pk_fma_f32 v[26:27], v[12:13], v[18:19], v[26:27] op_sel_hi:[0,1,1] neg_lo:[0,0,1] neg_hi:[0,0,1]
    v_pk_fma_f32 v[28:29], v[12:13], v[20:21], v[28:29] op_sel_hi:[0,1,1] neg_lo:[0,0,1] neg_hi:[0,0,1]
    v_pk_fma_f32 v[30:31], v[12:13], v[22:23], v[30:31] op_sel_hi:[0,1,1] neg_lo:[0,0,1] neg_hi:[0,0,1]
    v_cvt_pk_bf16_f32 v84, v24, v25
    v_cvt_pk_bf16_f32 v85, v26, v27
    v_cvt_pk_bf16_f32 v86, v28, v29
    v_cvt_pk_bf16_f32 v87, v30, v31
    v_pk_fma_f32 v[16:17], v[12:13], v[24:25], v[16:17] op_sel_hi:[0,1,1] neg_lo:[0,0,1] neg_hi:[0,0,1]
    v_pk_fma_f32 v[18:19], v[12:13], v[26:27], v[18:19] op_sel_hi:[0,1,1] neg_lo:[0,0,1] neg_hi:[0,0,1]
    v_pk_fma_f32 v[20:21], v[12:13], v[28:29], v[20:21] op_sel_hi:[0,1,1] neg_lo:[0,0,1] neg_hi:[0,0,1]
    v_pk_fma_f32 v[22:23], v[12:13], v[30:31], v[22:23] op_sel_hi:[0,1,1] neg_lo:[0,0,1] neg_hi:[0,0,1]
    v_cvt_pk_bf16_f32 v96, v16, v17
    v_cvt_pk_bf16_f32 v97, v18, v19
    v_cvt_pk_bf16_f32 v98, v20, v21
    v_cvt_pk_bf16_f32 v99, v22, v23
    v_pk_fma_f32 v[24:25], v[12:13], v[16:17], v[24:25] op_sel_hi:[0,1,1] neg_lo:[0,0,1] neg_hi:[0,0,1]
    v_pk_fma_f32 v[26:27], v[12:13], v[18:19], v[26:27] op_sel_hi:[0,1,1] neg_lo:[0,0,1] neg_hi:[0,0,1]
    v_pk_fma_f32 v[28:29], v[12:13], v[20:21], v[28:29] op_sel_hi:[0,1,1] neg_lo:[0,0,1] neg_hi:[0,0,1]
    v_pk_fma_f32 v[30:31], v[12:13], v[22:23], v[30:31] op_sel_hi:[0,1,1] neg_lo:[0,0,1] neg_hi:[0,0,1]
    v_cvt_pk_bf16_f32 v108, v24, v25
    v_cvt_pk_bf16_f32 v109, v26, v27
    v_cvt_pk_bf16_f32 v110, v28, v29
    v_cvt_pk_bf16_f32 v111, v30, v31
    v_pk_fma_f32 v[16:17], v[12:13], v[24:25], v[16:17] op_sel_hi:[0,1,1] neg_lo:[0,0,1] neg_hi:[0,0,1]
    v_pk_fma_f32 v[18:19], v[12:13], v[26:27], v[18:19] op_sel_hi:[0,1,1] neg_lo:[0,0,1] neg_hi:[0,0,1]
    v_pk_fma_f32 v[20:21], v[12:13], v[28:29], v[20:21] op_sel_hi:[0,1,1] neg_lo:[0,0,1] neg_hi:[0,0,1]
    v_pk_fma_f32 v[22:23], v[12:13], v[30:31], v[22:23] op_sel_hi:[0,1,1] neg_lo:[0,0,1] neg_hi:[0,0,1]
    v_cvt_pk_bf16_f32 v120, v16, v17
    v_cvt_pk_bf16_f32 v121, v18, v19
    v_cvt_pk_bf16_f32 v122, v20, v21
    v_cvt_pk_bf16_f32 v123, v22, v23
    v_pk_fma_f32 v[24:25], v[12:13], v[16:17], v[24:25] op_sel_hi:[0,1,1] neg_lo:[0,0,1] neg_hi:[0,0,1]
    v_pk_fma_f32 v[26:27], v[12:13], v[18:19], v[26:27] op_sel_hi:[0,1,1] neg_lo:[0,0,1] neg_hi:[0,0,1]
    v_pk_fma_f32 v[28:29], v[12:13], v[20:21], v[28:29] op_sel_hi:[0,1,1] neg_lo:[0,0,1] neg_hi:[0,0,1]
    v_pk_fma_f32 v[30:31], v[12:13], v[22:23], v[30:31] op_sel_hi:[0,1,1] neg_lo:[0,0,1] neg_hi:[0,0,1]
    v_cvt_pk_bf16_f32 v132, v24, v25
    v_cvt_pk_bf16_f32 v133, v26, v27
    v_cvt_pk_bf16_f32 v134, v28, v29
    v_cvt_pk_bf16_f32 v135, v30, v31
    v_pk_fma_f32 v[16:17], v[12:13], v[24:25], v[16:17] op_sel_hi:[0,1,1] neg_lo:[0,0,1] neg_hi:[0,0,1]
    v_pk_fma_f32 v[18:19], v[12:13], v[26:27], v[18:19] op_sel_hi:[0,1,1] neg_lo:[0,0,1] neg_hi:[0,0,1]
    v_pk_fma_f32 v[20:21], v[12:13], v[28:29], v[20:21] op_sel_hi:[0,1,1] neg_lo:[0,0,1] neg_hi:[0,0,1]
    v_pk_fma_f32 v[22:23], v[12:13], v[30:31], v[22:23] op_sel_hi:[0,1,1] neg_lo:[0,0,1] neg_hi:[0,0,1]
    v_cvt_pk_bf16_f32 v144, v16, v17
    v_cvt_pk_bf16_f32 v145, v18, v19
    v_cvt_pk_bf16_f32 v146, v20, v21
    v_cvt_pk_bf16_f32 v147, v22, v23
    v_pk_fma_f32 v[24:25], v[12:13], v[16:17], v[24:25] op_sel_hi:[0,1,1] neg_lo:[0,0,1] neg_hi:[0,0,1]
    v_pk_fma_f32 v[26:27], v[12:13], v[18:19], v[26:27] op_sel_hi:[0,1,1] neg_lo:[0,0,1] neg_hi:[0,0,1]
    v_pk_fma_f32 v[28:29], v[12:13], v[20:21], v[28:29] op_sel_hi:[0,1,1] neg_lo:[0,0,1] neg_hi:[0,0,1]
    v_pk_fma_f32 v[30:31], v[12:13], v[22:23], v[30:31] op_sel_hi:[0,1,1] neg_lo:[0,0,1] neg_hi:[0,0,1]
    v_cvt_pk_bf16_f32 v156, v24, v25
    v_cvt_pk_bf16_f32 v157, v26, v27
    v_cvt_pk_bf16_f32 v158, v28, v29
    v_cvt_pk_bf16_f32 v159, v30, v31
    v_pk_fma_f32 v[16:17], v[12:13], v[24:25], v[16:17] op_sel_hi:[0,1,1] neg_lo:[0,0,1] neg_hi:[0,0,1]
    v_pk_fma_f32 v[18:19], v[12:13], v[26:27], v[18:19] op_sel_hi:[0,1,1] neg_lo:[0,0,1] neg_hi:[0,0,1]
    v_pk_fma_f32 v[20:21], v[12:13], v[28:29], v[20:21] op_sel_hi:[0,1,1] neg_lo:[0,0,1] neg_hi:[0,0,1]
    v_pk_fma_f32 v[22:23], v[12:13], v[30:31], v[22:23] op_sel_hi:[0,1,1] neg_lo:[0,0,1] neg_hi:[0,0,1]
    v_cvt_pk_bf16_f32 v168, v16, v17
    v_cvt_pk_bf16_f32 v169, v18, v19
    v_cvt_pk_bf16_f32 v170, v20, v21
    v_cvt_pk_bf16_f32 v171, v22, v23
    v_pk_fma_f32 v[24:25], v[12:13], v[16:17], v[24:25] op_sel_hi:[0,1,1] neg_lo:[0,0,1] neg_hi:[0,0,1]
    v_pk_fma_f32 v[26:27], v[12:13], v[18:19], v[26:27] op_sel_hi:[0,1,1] neg_lo:[0,0,1] neg_hi:[0,0,1]
    v_pk_fma_f32 v[28:29], v[12:13], v[20:21], v[28:29] op_sel_hi:[0,1,1] neg_lo:[0,0,1] neg_hi:[0,0,1]
    v_pk_fma_f32 v[30:31], v[12:13], v[22:23], v[30:31] op_sel_hi:[0,1,1] neg_lo:[0,0,1] neg_hi:[0,0,1]
    v_cvt_pk_bf16_f32 v180, v24, v25
    v_cvt_pk_bf16_f32 v181, v26, v27
    v_cvt_pk_bf16_f32 v182, v28, v29
    v_cvt_pk_bf16_f32 v183, v30, v31
    v_pk_fma_f32 v[16:17], v[12:13], v[24:25], v[16:17] op_sel_hi:[0,1,1] neg_lo:[0,0,1] neg_hi:[0,0,1]
    v_pk_fma_f32 v[18:19], v[12:13], v[26:27], v[18:19] op_sel_hi:[0,1,1] neg_lo:[0,0,1] neg_hi:[0,0,1]
    v_pk_fma_f32 v[20:21], v[12:13], v[28:29], v[20:21] op_sel_hi:[0,1,1] neg_lo:[0,0,1] neg_hi:[0,0,1]
    v_pk_fma_f32 v[22:23], v[12:13], v[30:31], v[22:23] op_sel_hi:[0,1,1] neg_lo:[0,0,1] neg_hi:[0,0,1]
    v_cvt_pk_bf16_f32 v192, v16, v17
    v_cvt_pk_bf16_f32 v193, v18, v19
    v_cvt_pk_bf16_f32 v194, v20, v21
    v_cvt_pk_bf16_f32 v195, v22, v23
    v_pk_fma_f32 v[24:25], v[12:13], v[16:17], v[24:25] op_sel_hi:[0,1,1] neg_lo:[0,0,1] neg_hi:[0,0,1]
    v_pk_fma_f32 v[26:27], v[12:13], v[18:19], v[26:27] op_sel_hi:[0,1,1] neg_lo:[0,0,1] neg_hi:[0,0,1]
    v_pk_fma_f32 v[28:29], v[12:13], v[20:21], v[28:29] op_sel_hi:[0,1,1] neg_lo:[0,0,1] neg_hi:[0,0,1]
    v_pk_fma_f32 v[30:31], v[12:13], v[22:23], v[30:31] op_sel_hi:[0,1,1] neg_lo:[0,0,1] neg_hi:[0,0,1]
    v_cvt_pk_bf16_f32 v204, v24, v25
    v_cvt_pk_bf16_f32 v205, v26, v27
    v_cvt_pk_bf16_f32 v206, v28, v29
    v_cvt_pk_bf16_f32 v207, v30, v31
    v_pk_fma_f32 v[16:17], v[12:13], v[24:25], v[16:17] op_sel_hi:[0,1,1] neg_lo:[0,0,1] neg_hi:[0,0,1]
    v_pk_fma_f32 v[18:19], v[12:13], v[26:27], v[18:19] op_sel_hi:[0,1,1] neg_lo:[0,0,1] neg_hi:[0,0,1]
    v_pk_fma_f32 v[20:21], v[12:13], v[28:29], v[20:21] op_sel_hi:[0,1,1] neg_lo:[0,0,1] neg_hi:[0,0,1]
    v_pk_fma_f32 v[22:23], v[12:13], v[30:31], v[22:23] op_sel_hi:[0,1,1] neg_lo:[0,0,1] neg_hi:[0,0,1]
    v_cvt_pk_bf16_f32 v216, v16, v17
    v_cvt_pk_bf16_f32 v217, v18, v19
    v_cvt_pk_bf16_f32 v218, v20, v21
    v_cvt_pk_bf16_f32 v219, v22, v23
    v_pk_fma_f32 v[24:25], v[12:13], v[16:17], v[24:25] op_sel_hi:[0,1,1] neg_lo:[0,0,1] neg_hi:[0,0,1]
    v_pk_fma_f32 v[26:27], v[12:13], v[18:19], v[26:27] op_sel_hi:[0,1,1] neg_lo:[0,0,1] neg_hi:[0,0,1]
    v_pk_fma_f32 v[28:29], v[12:13], v[20:21], v[28:29] op_sel_hi:[0,1,1] neg_lo:[0,0,1] neg_hi:[0,0,1]
    v_pk_fma_f32 v[30:31], v[12:13], v[22:23], v[30:31] op_sel_hi:[0,1,1] neg_lo:[0,0,1] neg_hi:[0,0,1]
    v_cvt_pk_bf16_f32 v228, v24, v25
    v_cvt_pk_bf16_f32 v229, v26, v27
    v_cvt_pk_bf16_f32 v230, v28, v29
    v_cvt_pk_bf16_f32 v231, v30, v31
    v_pk_fma_f32 v[16:17], v[12:13], v[24:25], v[16:17] op_sel_hi:[0,1,1] neg_lo:[0,0,1] neg_hi:[0,0,1]
    v_pk_fma_f32 v[18:19], v[12:13], v[26:27], v[18:19] op_sel_hi:[0,1,1] neg_lo:[0,0,1] neg_hi:[0,0,1]
    v_pk_fma_f32 v[20:21], v[12:13], v[28:29], v[20:21] op_sel_hi:[0,1,1] neg_lo:[0,0,1] neg_hi:[0,0,1]
    v_pk_fma_f32 v[22:23], v[12:13], v[30:31], v[22:23] op_sel_hi:[0,1,1] neg_lo:[0,0,1] neg_hi:[0,0,1]
    v_cvt_pk_bf16_f32 v240, v16, v17
    v_cvt_pk_bf16_f32 v241, v18, v19
    v_cvt_pk_bf16_f32 v242, v20, v21
    v_cvt_pk_bf16_f32 v243, v22, v23
    v_pk_fma_f32 v[24:25], v[12:13], v[16:17], v[24:25] op_sel_hi:[0,1,1] neg_lo:[0,0,1] neg_hi:[0,0,1]
    v_pk_fma_f32 v[26:27], v[12:13], v[18:19], v[26:27] op_sel_hi:[0,1,1] neg_lo:[0,0,1] neg_hi:[0,0,1]
    v_pk_fma_f32 v[28:29], v[12:13], v[20:21], v[28:29] op_sel_hi:[0,1,1] neg_lo:[0,0,1] neg_hi:[0,0,1]
    v_pk_fma_f32 v[30:31], v[12:13], v[22:23], v[30:31] op_sel_hi:[0,1,1] neg_lo:[0,0,1] neg_hi:[0,0,1]
    v_cvt_pk_bf16_f32 v252, v24, v25
    v_cvt_pk_bf16_f32 v253, v26, v27
    v_cvt_pk_bf16_f32 v254, v28, v29
    v_cvt_pk_bf16_f32 v255, v30, v31
    v_cndmask_b32 v48, v48, v15, s[4:5]
    v_lshrrev_b32 v9, 2, v7
    v_lshlrev_b32 v4, 6, v9
    v_lshl_add_u32 v4, v8, 8, v4
    v_and_b32 v9, 1, v7
    v_lshl_add_u32 v4, v9, 5, v4
    v_and_b32 v9, 1, v8
    v_lshl_add_u32 v4, v9, 4, v4
    v_bfe_u32 v9, v7, 1, 1
    v_lshl_add_u32 v14, v9, 3, v4
    v_add_u32 v14, 65536, v14
    v_xor_b32 v15, 16, v14
    s_mov_b32 s3, 0x40000
.poll_18:
    buffer_load_dwordx2 v[36:37], v34, s[8:11], 0 offen sc1
    s_sub_u32 s3, s3, 1
    s_cbranch_scc1 .got_19
    s_waitcnt vmcnt(0)
    v_cmp_ne_u64 vcc, s[96:97], v[36:37]
    s_cbranch_vccnz .poll_18
.got_19:
    s_waitcnt lgkmcnt(0)
    s_mov_b32 s46, 7
.g2l_20:
    s_mov_b32 m0, s38
    s_add_u32 s38, s38, 9216
    buffer_load_dwordx4 v1, s[16:19], s43 offen offset:0 sc1 lds
    buffer_load_dwordx4 v1, s[16:19], s43 offen offset:1024 sc1 lds
    buffer_load_dwordx4 v1, s[16:19], s43 offen offset:2048 sc1 lds
    s_add_u32 s43, s43, 3072
    s_cmp_eq_u32 s43, s32
    s_cselect_b32 s43, s28, s43
    s_cmp_eq_u32 s38, s49
    s_cselect_b32 s38, s50, s38
    s_sub_u32 s46, s46, 1
    s_cmp_lg_u32 s46, 0
    s_cbranch_scc1 .g2l_20
    s_waitcnt vmcnt(18)
    s_barrier
    s_waitcnt vmcnt(12)
    s_barrier
    s_mov_b32 m0, s38
    s_add_u32 s38, s38, 9216
    buffer_load_dwordx4 v1, s[16:19], s43 offen offset:0 sc1 lds
    buffer_load_dwordx4 v1, s[16:19], s43 offen offset:1024 sc1 lds
    buffer_load_dwordx4 v1, s[16:19], s43 offen offset:2048 sc1 lds
    s_add_u32 s43, s43, 3072
    s_cmp_eq_u32 s43, s32
    s_cselect_b32 s43, s28, s43
    s_cmp_eq_u32 s38, s49
    s_cselect_b32 s38, s50, s38
    s_mov_b32 m0, s39
    s_add_u32 s39, s39, 8192
    buffer_load_dwordx4 v32, s[12:15], s41 offen lds
    s_add_u32 s41, s41, 131072
    s_cmp_eq_u32 s41, s40
    s_cselect_b32 s41, s37, s41
    s_cmp_eq_u32 s39, s47
    s_cselect_b32 s39, s48, s39
    s_waitcnt vmcnt(10)
    s_barrier
    s_mov_b32 m0, s38
    s_add_u32 s38, s38, 9216
    buffer_load_dwordx4 v1, s[16:19], s43 offen offset:0 sc1 lds
    buffer_load_dwordx4 v1, s[16:19], s43 offen offset:1024 sc1 lds
    buffer_load_dwordx4 v1, s[16:19], s43 offen offset:2048 sc1 lds
    s_add_u32 s43, s43, 3072
    s_cmp_eq_u32 s43, s32
    s_cselect_b32 s43, s28, s43
    s_cmp_eq_u32 s38, s49
    s_cselect_b32 s38, s50, s38
    s_mov_b32 m0, s39
    s_add_u32 s39, s39, 8192
    buffer_load_dwordx4 v32, s[12:15], s41 offen lds
    s_add_u32 s41, s41, 131072
    s_cmp_eq_u32 s41, s40
    s_cselect_b32 s41, s37, s41
    s_cmp_eq_u32 s39, s47
    s_cselect_b32 s39, s48, s39
    s_mov_b32 m0, s38
    s_add_u32 s38, s38, 9216
    buffer_load_dwordx4 v1, s[16:19], s43 offen offset:0 sc1 lds
    buffer_load_dwordx4 v1, s[16:19], s43 offen offset:1024 sc1 lds
    buffer_load_dwordx4 v1, s[16:19], s43 offen offset:2048 sc1 lds
    s_add_u32 s43, s43, 3072
    s_cmp_eq_u32 s43, s32
    s_cselect_b32 s43, s28, s43
    s_cmp_eq_u32 s38, s49
    s_cselect_b32 s38, s50, s38
    s_mov_b32 m0, s39
    s_add_u32 s39, s39, 8192
    buffer_load_dwordx4 v32, s[12:15], s41 offen lds
    s_add_u32 s41, s41, 131072
    s_cmp_eq_u32 s41, s40
    s_cselect_b32 s41, s37, s41
    s_cmp_eq_u32 s39, s47
    s_cselect_b32 s39, s48, s39
    s_waitcnt vmcnt(12)
    s_barrier
    s_mov_b32 m0, s38
    s_add_u32 s38, s38, 9216
    buffer_load_dwordx4 v1, s[16:19], s43 offen offset:0 sc1 lds
    buffer_load_dwordx4 v1, s[16:19], s43 offen offset:1024 sc1 lds
    buffer_load_dwordx4 v1, s[16:19], s43 offen offset:2048 sc1 lds
    s_add_u32 s43, s43, 3072
    s_cmp_eq_u32 s43, s32
    s_cselect_b32 s43, s28, s43
    s_cmp_eq_u32 s38, s49
    s_cselect_b32 s38, s50, s38
    s_mov_b32 m0, s39
    s_add_u32 s39, s39, 8192
    buffer_load_dwordx4 v32, s[12:15], s41 offen lds
    s_add_u32 s41, s41, 131072
    s_cmp_eq_u32 s41, s40
    s_cselect_b32 s41, s37, s41
    s_cmp_eq_u32 s39, s47
    s_cselect_b32 s39, s48, s39
    s_mov_b32 m0, s38
    s_add_u32 s38, s38, 9216
    buffer_load_dwordx4 v1, s[16:19], s43 offen offset:0 sc1 lds
    buffer_load_dwordx4 v1, s[16:19], s43 offen offset:1024 sc1 lds
    buffer_load_dwordx4 v1, s[16:19], s43 offen offset:2048 sc1 lds
    s_add_u32 s43, s43, 3072
    s_cmp_eq_u32 s43, s32
    s_cselect_b32 s43, s28, s43
    s_cmp_eq_u32 s38, s49
    s_cselect_b32 s38, s50, s38
    s_mov_b32 m0, s39
    s_add_u32 s39, s39, 8192
    buffer_load_dwordx4 v32, s[12:15], s41 offen lds
    s_add_u32 s41, s41, 131072
    s_cmp_eq_u32 s41, s40
    s_cselect_b32 s41, s37, s41
    s_cmp_eq_u32 s39, s47
    s_cselect_b32 s39, s48, s39
    s_mov_b32 s46, 9
.g2l_21:
    s_waitcnt vmcnt(13)
    s_barrier
    s_mov_b32 m0, s38
    s_add_u32 s38, s38, 9216
    buffer_load_dwordx4 v1, s[16:19], s43 offen offset:0 sc1 lds
    buffer_load_dwordx4 v1, s[16:19], s43 offen offset:1024 sc1 lds
    buffer_load_dwordx4 v1, s[16:19], s43 offen offset:2048 sc1 lds
    s_add_u32 s43, s43, 3072
    s_cmp_eq_u32 s43, s32
    s_cselect_b32 s43, s28, s43
    s_cmp_eq_u32 s38, s49
    s_cselect_b32 s38, s50, s38
    s_mov_b32 m0, s39
    s_add_u32 s39, s39, 8192
    buffer_load_dwordx4 v32, s[12:15], s41 offen lds
    s_add_u32 s41, s41, 131072
    s_cmp_eq_u32 s41, s40
    s_cselect_b32 s41, s37, s41
    s_cmp_eq_u32 s39, s47
    s_cselect_b32 s39, s48, s39
    s_mov_b32 m0, s38
    s_add_u32 s38, s38, 9216
    buffer_load_dwordx4 v1, s[16:19], s43 offen offset:0 sc1 lds
    buffer_load_dwordx4 v1, s[16:19], s43 offen offset:1024 sc1 lds
    buffer_load_dwordx4 v1, s[16:19], s43 offen offset:2048 sc1 lds
    s_add_u32 s43, s43, 3072
    s_cmp_eq_u32 s43, s32
    s_cselect_b32 s43, s28, s43
    s_cmp_eq_u32 s38, s49
    s_cselect_b32 s38, s50, s38
    s_mov_b32 m0, s39
    s_add_u32 s39, s39, 8192
    buffer_load_dwordx4 v32, s[12:15], s41 offen lds
    s_add_u32 s41, s41, 131072
    s_cmp_eq_u32 s41, s40
    s_cselect_b32 s41, s37, s41
    s_cmp_eq_u32 s39, s47
    s_cselect_b32 s39, s48, s39
    s_sub_u32 s46, s46, 1
    s_cmp_lg_u32 s46, 0
    s_cbranch_scc1 .g2l_21
    s_waitcnt vmcnt(13)
    s_barrier
    s_mov_b32 m0, s38
    s_add_u32 s38, s38, 9216
    buffer_load_dwordx4 v1, s[16:19], s43 offen offset:0 sc1 lds
    buffer_load_dwordx4 v1, s[16:19], s43 offen offset:1024 sc1 lds
    buffer_load_dwordx4 v1, s[16:19], s43 offen offset:2048 sc1 lds
    s_add_u32 s43, s43, 3072
    s_cmp_eq_u32 s43, s32
    s_cselect_b32 s43, s28, s43
    s_cmp_eq_u32 s38, s49
    s_cselect_b32 s38, s50, s38
    s_mov_b32 m0, s39
    s_add_u32 s39, s39, 8192
    buffer_load_dwordx4 v32, s[12:15], s41 offen lds
    s_add_u32 s41, s41, 131072
    s_cmp_eq_u32 s41, s40
    s_cselect_b32 s41, s37, s41
    s_cmp_eq_u32 s39, s47
    s_cselect_b32 s39, s48, s39
    s_mov_b32 m0, s38
    s_add_u32 s38, s38, 9216
    buffer_load_dwordx4 v1, s[16:19], s43 offen offset:0 sc1 lds
    buffer_load_dwordx4 v1, s[16:19], s43 offen offset:1024 sc1 lds
    buffer_load_dwordx4 v1, s[16:19], s43 offen offset:2048 sc1 lds
    s_add_u32 s43, s43, 3072
    s_cmp_eq_u32 s43, s32
    s_cselect_b32 s43, s28, s43
    s_cmp_eq_u32 s38, s49
    s_cselect_b32 s38, s50, s38
    s_mov_b32 m0, s45
    s_add_u32 s45, s45, 4096
    buffer_load_dwordx4 v33, s[20:23], s44 offen sc1 lds
    s_add_u32 s44, s44, 262144
    s_mov_b32 m0, s45
    s_add_u32 s45, s45, 4096
    buffer_load_dwordx4 v33, s[20:23], s44 offen sc1 lds
    s_add_u32 s44, s44, 262144
    s_waitcnt vmcnt(14)
    s_barrier
    s_mov_b32 m0, s38
    s_add_u32 s38, s38, 9216
    buffer_load_dwordx4 v1, s[16:19], s43 offen offset:0 sc1 lds
    buffer_load_dwordx4 v1, s[16:19], s43 offen offset:1024 sc1 lds
    buffer_load_dwordx4 v1, s[16:19], s43 offen offset:2048 sc1 lds
    s_add_u32 s43, s43, 3072
    s_cmp_eq_u32 s43, s32
    s_cselect_b32 s43, s28, s43
    s_cmp_eq_u32 s38, s49
    s_cselect_b32 s38, s50, s38
    s_mov_b32 m0, s45
    s_add_u32 s45, s45, 4096
    buffer_load_dwordx4 v33, s[20:23], s44 offen sc1 lds
    s_add_u32 s44, s44, 262144
    s_mov_b32 m0, s45
    s_add_u32 s45, s45, 4096
    buffer_load_dwordx4 v33, s[20:23], s44 offen sc1 lds
    s_add_u32 s44, s44, 262144
    s_mov_b32 m0, s38
    s_add_u32 s38, s38, 9216
    buffer_load_dwordx4 v1, s[16:19], s43 offen offset:0 sc1 lds
    buffer_load_dwordx4 v1, s[16:19], s43 offen offset:1024 sc1 lds
    buffer_load_dwordx4 v1, s[16:19], s43 offen offset:2048 sc1 lds
    s_add_u32 s43, s43, 3072
    s_cmp_eq_u32 s43, s32
    s_cselect_b32 s43, s28, s43
    s_cmp_eq_u32 s38, s49
    s_cselect_b32 s38, s50, s38
    s_mov_b32 m0, s45
    s_add_u32 s45, s45, 4096
    buffer_load_dwordx4 v33, s[20:23], s44 offen sc1 lds
    s_add_u32 s44, s44, 262144
    s_mov_b32 m0, s45
    s_add_u32 s45, s45, 4096
    buffer_load_dwordx4 v33, s[20:23], s44 offen sc1 lds
    s_add_u32 s44, s44, 262144
    s_waitcnt vmcnt(16)
    s_barrier
    s_mov_b32 m0, s38
    s_add_u32 s38, s38, 9216
    buffer_load_dwordx4 v1, s[16:19], s43 offen offset:0 sc1 lds
    buffer_load_dwordx4 v1, s[16:19], s43 offen offset:1024 sc1 lds
    buffer_load_dwordx4 v1, s[16:19], s43 offen offset:2048 sc1 lds
    s_add_u32 s43, s43, 3072
    s_cmp_eq_u32 s43, s32
    s_cselect_b32 s43, s28, s43
    s_cmp_eq_u32 s38, s49
    s_cselect_b32 s38, s50, s38
    s_mov_b32 m0, s45
    s_add_u32 s45, s45, 4096
    buffer_load_dwordx4 v33, s[20:23], s44 offen sc1 lds
    s_add_u32 s44, s44, 262144
    s_mov_b32 m0, s45
    s_add_u32 s45, s45, 4096
    buffer_load_dwordx4 v33, s[20:23], s44 offen sc1 lds
    s_add_u32 s44, s44, 262144
    s_mov_b32 m0, s38
    s_add_u32 s38, s38, 9216
    buffer_load_dwordx4 v1, s[16:19], s43 offen offset:0 sc1 lds
    buffer_load_dwordx4 v1, s[16:19], s43 offen offset:1024 sc1 lds
    buffer_load_dwordx4 v1, s[16:19], s43 offen offset:2048 sc1 lds
    s_add_u32 s43, s43, 3072
    s_cmp_eq_u32 s43, s32
    s_cselect_b32 s43, s28, s43
    s_cmp_eq_u32 s38, s49
    s_cselect_b32 s38, s50, s38
    s_mov_b32 m0, s45
    s_add_u32 s45, s45, 4096
    buffer_load_dwordx4 v33, s[20:23], s44 offen sc1 lds
    s_add_u32 s44, s44, 262144
    s_waitcnt vmcnt(16)
    s_barrier
    s_waitcnt vmcnt(6)
    s_barrier
    s_waitcnt vmcnt(0)
    s_barrier
.Lidft:
    ds_read_b64_tr_b16 v[2:3], v14 offset:0
    ds_read_b64_tr_b16 v[4:5], v14 offset:1024
    ds_read_b64_tr_b16 v[6:7], v15 offset:0
    ds_read_b64_tr_b16 v[8:9], v15 offset:1024
    ds_read_b64_tr_b16 v[10:11], v14 offset:2048
    ds_read_b64_tr_b16 v[12:13], v14 offset:3072
    s_waitcnt lgkmcnt(2)
    v_mfma_f32_16x16x32_bf16 v[16:19], v[40:43], v[2:5], 0
    v_mfma_f32_16x16x32_bf16 v[28:31], v[40:43], v[6:9], 0
    ds_read_b64_tr_b16 v[40:41], v15 offset:2048
    ds_read_b64_tr_b16 v[42:43], v15 offset:3072
    v_mfma_f32_16x16x32_bf16 v[20:23], v[44:47], v[2:5], 0
    v_mfma_f32_16x16x32_bf16 v[32:35], v[44:47], v[6:9], 0
    ds_read_b64_tr_b16 v[44:45], v14 offset:4096
    ds_read_b64_tr_b16 v[46:47], v14 offset:5120
    v_mfma_f32_16x16x32_bf16 v[24:27], v[48:51], v[2:5], 0
    v_mfma_f32_16x16x32_bf16 v[36:39], v[48:51], v[6:9], 0
    ds_read_b64_tr_b16 v[48:49], v15 offset:4096
    ds_read_b64_tr_b16 v[50:51], v15 offset:5120
    s_waitcnt lgkmcnt(4)
    v_mfma_f32_16x16x32_bf16 v[16:19], v[52:55], v[10:13], v[16:19]
    v_mfma_f32_16x16x32_bf16 v[28:31], v[52:55], v[40:43], v[28:31]
    ds_read_b64_tr_b16 v[2:3], v14 offset:6144
    ds_read_b64_tr_b16 v[4:5], v14 offset:7168
    v_mfma_f32_16x16x32_bf16 v[20:23], v[56:59], v[10:13], v[20:23]
    v_mfma_f32_16x16x32_bf16 v[32:35], v[56:59], v[40:43], v[32:35]
    ds_read_b64_tr_b16 v[6:7], v15 offset:6144
    ds_read_b64_tr_b16 v[8:9], v15 offset:7168
    v_mfma_f32_16x16x32_bf16 v[24:27], v[60:63], v[10:13], v[24:27]
    v_mfma_f32_16x16x32_bf16 v[36:39], v[60:63], v[40:43], v[36:39]
    ds_read_b64_tr_b16 v[52:53], v14 offset:8192
    ds_read_b64_tr_b16 v[54:55], v14 offset:9216
    s_waitcnt lgkmcnt(6)
    v_mfma_f32_16x16x32_bf16 v[16:19], v[64:67], v[44:47], v[16:19]
    v_mfma_f32_16x16x32_bf16 v[28:31], v[64:67], v[48:51], v[28:31]
    ds_read_b64_tr_b16 v[56:57], v15 offset:8192
    ds_read_b64_tr_b16 v[58:59], v15 offset:9216
    v_mfma_f32_16x16x32_bf16 v[20:23], v[68:71], v[44:47], v[20:23]
    v_mfma_f32_16x16x32_bf16 v[32:35], v[68:71], v[48:51], v[32:35]
    ds_read_b64_tr_b16 v[60:61], v14 offset:10240
    ds_read_b64_tr_b16 v[62:63], v14 offset:11264
    v_mfma_f32_16x16x32_bf16 v[24:27], v[72:75], v[44:47], v[24:27]
    v_mfma_f32_16x16x32_bf16 v[36:39], v[72:75], v[48:51], v[36:39]
    ds_read_b64_tr_b16 v[10:11], v15 offset:10240
    ds_read_b64_tr_b16 v[12:13], v15 offset:11264
    s_add_u32 s12, s74, 12648448
    s_addc_u32 s13, s75, 0
    s_mov_b32 s14, 16384
    s_mov_b32 s15, 0x20000
    s_mov_b32 s16, s66
    s_mov_b32 s17, s67
    s_mov_b32 s18, 4096
    s_mov_b32 s19, 0x20000
    s_add_u32 s24, s74, 12664832
    s_addc_u32 s25, s75, 0
    s_mov_b32 s26, 9437184
    s_mov_b32 s27, 0x20000
    s_waitcnt lgkmcnt(8)
    v_mfma_f32_16x16x32_bf16 v[16:19], v[76:79], v[2:5], v[16:19]
    v_mfma_f32_16x16x32_bf16 v[28:31], v[76:79], v[6:9], v[28:31]
    ds_read_b64_tr_b16 v[40:41], v14 offset:12288
    ds_read_b64_tr_b16 v[42:43], v14 offset:13312
    v_mfma_f32_16x16x32_bf16 v[20:23], v[80:83], v[2:5], v[20:23]
    v_mfma_f32_16x16x32_bf16 v[32:35], v[80:83], v[6:9], v[32:35]
    ds_read_b64_tr_b16 v[44:45], v15 offset:12288
    ds_read_b64_tr_b16 v[46:47], v15 offset:13312
    v_mfma_f32_16x16x32_bf16 v[24:27], v[84:87], v[2:5], v[24:27]
    v_mfma_f32_16x16x32_bf16 v[36:39], v[84:87], v[6:9], v[36:39]
    s_waitcnt lgkmcnt(8)
    v_mfma_f32_16x16x32_bf16 v[16:19], v[88:91], v[52:55], v[16:19]
    v_mfma_f32_16x16x32_bf16 v[28:31], v[88:91], v[56:59], v[28:31]
    ds_read_b64_tr_b16 v[48:49], v14 offset:14336
    ds_read_b64_tr_b16 v[50:51], v14 offset:15360
    v_mfma_f32_16x16x32_bf16 v[20:23], v[92:95], v[52:55], v[20:23]
    v_mfma_f32_16x16x32_bf16 v[32:35], v[92:95], v[56:59], v[32:35]
    ds_read_b64_tr_b16 v[80:81], v15 offset:14336
    ds_read_b64_tr_b16 v[82:83], v15 offset:15360
    v_mfma_f32_16x16x32_bf16 v[24:27], v[96:99], v[52:55], v[24:27]
    v_mfma_f32_16x16x32_bf16 v[36:39], v[96:99], v[56:59], v[36:39]
    v_and_b32 v64, 15, v0
    v_lshrrev_b32 v65, 4, v0
    v_lshlrev_b32 v66, 8, v64
    v_lshlrev_b32 v67, 1, v64
    s_and_b32 s3, s31, 1
    s_lshl_b32 s40, s3, 13
    s_lshl_b32 s41, s33, 1
    s_lshr_b32 s3, s31, 1
    s_add_u32 s41, s41, s3
    s_lshl_b32 s3, s41, 3
    s_add_u32 s40, s40, s3
    s_add_u32 s42, s40, 4096
    s_lshl_b32 s41, s33, 2
    s_add_u32 s41, s41, s31
    s_lshl_b32 s43, s41, 6
    buffer_load_dwordx2 v[68:69], v66, s[12:15], s40 offen sc1
    buffer_load_dwordx2 v[70:71], v66, s[12:15], s42 offen sc1
    buffer_load_ushort v72, v67, s[16:19], s43 offen
    buffer_load_ushort v73, v67, s[16:19], s43 offen offset:32
    v_add_u32 v74, 0, v0
    v_add_u32 v74, 0, v74
    v_and_b32 v74, 3, v74
    v_mul_u32_u24 v74, 32, v74
    s_lshl_b32 s44, s34, 2
    s_add_u32 s44, s44, s31
    s_lshl_b32 s44, s44, 7
    s_add_u32 s44, s44, 196608
    s_mul_i32 s3, s35, 6144
    s_add_u32 s3, s3, 106496
    v_add_u32 v77, s3, v1
    s_lshl_b32 s3, s34, 2
    s_add_u32 s3, s3, s31
    s_mul_i32 s45, s3, 36864
    s_mul_i32 s3, s35, 3072
    s_add_u32 s45, s45, s3
    v_mul_u32_u24 v75, 1152, v64
    v_mul_u32_u24 v76, 24, v65
    v_add_u32 v75, v75, v76
    s_mul_i32 s46, s41, 36864
    s_mul_i32 s3, s36, 96
    s_add_u32 s46, s46, s3
    s_add_u32 s47, s46, 18432
    s_waitcnt lgkmcnt(8)
    v_mfma_f32_16x16x32_bf16 v[16:19], v[100:103], v[60:63], v[16:19]
    v_mfma_f32_16x16x32_bf16 v[28:31], v[100:103], v[10:13], v[28:31]
    ds_read_b64_tr_b16 v[84:85], v14 offset:16384
    ds_read_b64_tr_b16 v[86:87], v14 offset:17408
    v_mfma_f32_16x16x32_bf16 v[20:23], v[104:107], v[60:63], v[20:23]
    v_mfma_f32_16x16x32_bf16 v[32:35], v[104:107], v[10:13], v[32:35]
    ds_read_b64_tr_b16 v[2:3], v15 offset:16384
    ds_read_b64_tr_b16 v[4:5], v15 offset:17408
    v_mfma_f32_16x16x32_bf16 v[24:27], v[108:111], v[60:63], v[24:27]
    v_mfma_f32_16x16x32_bf16 v[36:39], v[108:111], v[10:13], v[36:39]
    s_waitcnt lgkmcnt(8)
    v_mfma_f32_16x16x32_bf16 v[16:19], v[112:115], v[40:43], v[16:19]
    v_mfma_f32_16x16x32_bf16 v[28:31], v[112:115], v[44:47], v[28:31]
    ds_read_b64_tr_b16 v[6:7], v14 offset:18432
    ds_read_b64_tr_b16 v[8:9], v14 offset:19456
    v_mfma_f32_16x16x32_bf16 v[20:23], v[116:119], v[40:43], v[20:23]
    v_mfma_f32_16x16x32_bf16 v[32:35], v[116:119], v[44:47], v[32:35]
    ds_read_b64_tr_b16 v[88:89], v15 offset:18432
    ds_read_b64_tr_b16 v[90:91], v15 offset:19456
    v_mfma_f32_16x16x32_bf16 v[24:27], v[120:123], v[40:43], v[24:27]
    v_mfma_f32_16x16x32_bf16 v[36:39], v[120:123], v[44:47], v[36:39]
    s_add_u32 s3, s31, 1
    s_and_b32 s3, s3, 3
    s_mul_i32 s3, s3, 9216
    s_add_u32 s48, s45, s3
    s_add_u32 s3, s31, 2
    s_and_b32 s3, s3, 3
    s_mul_i32 s3, s3, 9216
    s_add_u32 s49, s45, s3
    s_add_u32 s3, s31, 3
    s_and_b32 s3, s3, 3
    s_mul_i32 s3, s3, 9216
    s_add_u32 s50, s45, s3
    s_mov_b32 s20, s70
    s_mov_b32 s21, s71
    s_mov_b32 s22, 2359296
    s_mov_b32 s23, 0x20000
    s_waitcnt lgkmcnt(8)
    v_mfma_f32_16x16x32_bf16 v[16:19], v[124:127], v[48:51], v[16:19]
    v_mfma_f32_16x16x32_bf16 v[28:31], v[124:127], v[80:83], v[28:31]
    ds_read_b64_tr_b16 v[92:93], v14 offset:20480
    ds_read_b64_tr_b16 v[94:95], v14 offset:21504
    v_mfma_f32_16x16x32_bf16 v[20:23], v[128:131], v[48:51], v[20:23]
    v_mfma_f32_16x16x32_bf16 v[32:35], v[128:131], v[80:83], v[32:35]
    ds_read_b64_tr_b16 v[96:97], v15 offset:20480
    ds_read_b64_tr_b16 v[98:99], v15 offset:21504
    v_mfma_f32_16x16x32_bf16 v[24:27], v[132:135], v[48:51], v[24:27]
    v_mfma_f32_16x16x32_bf16 v[36:39], v[132:135], v[80:83], v[36:39]
    s_waitcnt lgkmcnt(8)
    v_mfma_f32_16x16x32_bf16 v[16:19], v[136:139], v[84:87], v[16:19]
    v_mfma_f32_16x16x32_bf16 v[28:31], v[136:139], v[2:5], v[28:31]
    ds_read_b64_tr_b16 v[52:53], v14 offset:22528
    ds_read_b64_tr_b16 v[54:55], v14 offset:23552
    v_mfma_f32_16x16x32_bf16 v[20:23], v[140:143], v[84:87], v[20:23]
    v_mfma_f32_16x16x32_bf16 v[32:35], v[140:143], v[2:5], v[32:35]
    ds_read_b64_tr_b16 v[56:57], v15 offset:22528
    ds_read_b64_tr_b16 v[58:59], v15 offset:23552
    v_mfma_f32_16x16x32_bf16 v[24:27], v[144:147], v[84:87], v[24:27]
    v_mfma_f32_16x16x32_bf16 v[36:39], v[144:147], v[2:5], v[36:39]
    s_waitcnt lgkmcnt(8)
    v_mfma_f32_16x16x32_bf16 v[16:19], v[148:151], v[6:9], v[16:19]
    v_mfma_f32_16x16x32_bf16 v[28:31], v[148:151], v[88:91], v[28:31]
    ds_read_b64_tr_b16 v[100:101], v14 offset:24576
    ds_read_b64_tr_b16 v[102:103], v14 offset:25600
    v_mfma_f32_16x16x32_bf16 v[20:23], v[152:155], v[6:9], v[20:23]
    v_mfma_f32_16x16x32_bf16 v[32:35], v[152:155], v[88:91], v[32:35]
    ds_read_b64_tr_b16 v[104:105], v15 offset:24576
    ds_read_b64_tr_b16 v[106:107], v15 offset:25600
    v_mfma_f32_16x16x32_bf16 v[24:27], v[156:159], v[6:9], v[24:27]
    v_mfma_f32_16x16x32_bf16 v[36:39], v[156:159], v[88:91], v[36:39]
    s_waitcnt lgkmcnt(8)
    v_mfma_f32_16x16x32_bf16 v[16:19], v[160:163], v[92:95], v[16:19]
    v_mfma_f32_16x16x32_bf16 v[28:31], v[160:163], v[96:99], v[28:31]
    ds_read_b64_tr_b16 v[108:109], v14 offset:26624
    ds_read_b64_tr_b16 v[110:111], v14 offset:27648
    v_mfma_f32_16x16x32_bf16 v[20:23], v[164:167], v[92:95], v[20:23]
    v_mfma_f32_16x16x32_bf16 v[32:35], v[164:167], v[96:99], v[32:35]
    ds_read_b64_tr_b16 v[60:61], v15 offset:26624
    ds_read_b64_tr_b16 v[62:63], v15 offset:27648
    v_mfma_f32_16x16x32_bf16 v[24:27], v[168:171], v[92:95], v[24:27]
    v_mfma_f32_16x16x32_bf16 v[36:39], v[168:171], v[96:99], v[36:39]
    s_waitcnt lgkmcnt(8)
    v_mfma_f32_16x16x32_bf16 v[16:19], v[172:175], v[52:55], v[16:19]
    v_mfma_f32_16x16x32_bf16 v[28:31], v[172:175], v[56:59], v[28:31]
    ds_read_b64_tr_b16 v[10:11], v14 offset:28672
    ds_read_b64_tr_b16 v[12:13], v14 offset:29696
    v_mfma_f32_16x16x32_bf16 v[20:23], v[176:179], v[52:55], v[20:23]
    v_mfma_f32_16x16x32_bf16 v[32:35], v[176:179], v[56:59], v[32:35]
    ds_read_b64_tr_b16 v[112:113], v15 offset:28672
    ds_read_b64_tr_b16 v[114:115], v15 offset:29696
    v_mfma_f32_16x16x32_bf16 v[24:27], v[180:183], v[52:55], v[24:27]
    v_mfma_f32_16x16x32_bf16 v[36:39], v[180:183], v[56:59], v[36:39]
    s_waitcnt lgkmcnt(8)
    v_mfma_f32_16x16x32_bf16 v[16:19], v[184:187], v[100:103], v[16:19]
    v_mfma_f32_16x16x32_bf16 v[28:31], v[184:187], v[104:107], v[28:31]
    ds_read_b64_tr_b16 v[116:117], v14 offset:30720
    ds_read_b64_tr_b16 v[118:119], v14 offset:31744
    v_mfma_f32_16x16x32_bf16 v[20:23], v[188:191], v[100:103], v[20:23]
    v_mfma_f32_16x16x32_bf16 v[32:35], v[188:191], v[104:107], v[32:35]
    ds_read_b64_tr_b16 v[120:121], v15 offset:30720
    ds_read_b64_tr_b16 v[122:123], v15 offset:31744
    v_mfma_f32_16x16x32_bf16 v[24:27], v[192:195], v[100:103], v[24:27]
    v_mfma_f32_16x16x32_bf16 v[36:39], v[192:195], v[104:107], v[36:39]
    s_waitcnt lgkmcnt(8)
    v_mfma_f32_16x16x32_bf16 v[16:19], v[196:199], v[108:111], v[16:19]
    v_mfma_f32_16x16x32_bf16 v[28:31], v[196:199], v[60:63], v[28:31]
    ds_read_b64_tr_b16 v[40:41], v14 offset:32768
    ds_read_b64_tr_b16 v[42:43], v14 offset:33792
    v_mfma_f32_16x16x32_bf16 v[20:23], v[200:203], v[108:111], v[20:23]
    v_mfma_f32_16x16x32_bf16 v[32:35], v[200:203], v[60:63], v[32:35]
    ds_read_b64_tr_b16 v[44:45], v15 offset:32768
    ds_read_b64_tr_b16 v[46:47], v15 offset:33792
    v_mfma_f32_16x16x32_bf16 v[24:27], v[204:207], v[108:111], v[24:27]
    v_mfma_f32_16x16x32_bf16 v[36:39], v[204:207], v[60:63], v[36:39]
    s_waitcnt lgkmcnt(8)
    v_mfma_f32_16x16x32_bf16 v[16:19], v[208:211], v[10:13], v[16:19]
    v_mfma_f32_16x16x32_bf16 v[28:31], v[208:211], v[112:115], v[28:31]
    ds_read_b64_tr_b16 v[124:125], v14 offset:34816
    ds_read_b64_tr_b16 v[126:127], v14 offset:35840
    v_mfma_f32_16x16x32_bf16 v[20:23], v[212:215], v[10:13], v[20:23]
    v_mfma_f32_16x16x32_bf16 v[32:35], v[212:215], v[112:115], v[32:35]
    ds_read_b64_tr_b16 v[128:129], v15 offset:34816
    ds_read_b64_tr_b16 v[130:131], v15 offset:35840
    v_mfma_f32_16x16x32_bf16 v[24:27], v[216:219], v[10:13], v[24:27]
    v_mfma_f32_16x16x32_bf16 v[36:39], v[216:219], v[112:115], v[36:39]
    s_waitcnt lgkmcnt(8)
    v_mfma_f32_16x16x32_bf16 v[16:19], v[220:223], v[116:119], v[16:19]
    v_mfma_f32_16x16x32_bf16 v[28:31], v[220:223], v[120:123], v[28:31]
    v_mfma_f32_16x16x32_bf16 v[20:23], v[224:227], v[116:119], v[20:23]
    v_mfma_f32_16x16x32_bf16 v[32:35], v[224:227], v[120:123], v[32:35]
    v_mfma_f32_16x16x32_bf16 v[24:27], v[228:231], v[116:119], v[24:27]
    v_mfma_f32_16x16x32_bf16 v[36:39], v[228:231], v[120:123], v[36:39]
    s_waitcnt lgkmcnt(4)
    v_mfma_f32_16x16x32_bf16 v[16:19], v[232:235], v[40:43], v[16:19]
    v_mfma_f32_16x16x32_bf16 v[28:31], v[232:235], v[44:47], v[28:31]
    v_mfma_f32_16x16x32_bf16 v[20:23], v[236:239], v[40:43], v[20:23]
    v_mfma_f32_16x16x32_bf16 v[32:35], v[236:239], v[44:47], v[32:35]
    v_mfma_f32_16x16x32_bf16 v[24:27], v[240:243], v[40:43], v[24:27]
    v_mfma_f32_16x16x32_bf16 v[36:39], v[240:243], v[44:47], v[36:39]
    s_waitcnt lgkmcnt(0)
    v_mfma_f32_16x16x32_bf16 v[16:19], v[244:247], v[124:127], v[16:19]
    v_mfma_f32_16x16x32_bf16 v[28:31], v[244:247], v[128:131], v[28:31]
    v_mfma_f32_16x16x32_bf16 v[20:23], v[248:251], v[124:127], v[20:23]
    v_mfma_f32_16x16x32_bf16 v[32:35], v[248:251], v[128:131], v[32:35]
    v_mfma_f32_16x16x32_bf16 v[24:27], v[252:255], v[124:127], v[24:27]
    v_mfma_f32_16x16x32_bf16 v[36:39], v[252:255], v[128:131], v[36:39]
    s_waitcnt vmcnt(0)
    v_lshlrev_b32 v72, 16, v72
    v_mul_f32 v72, v72, v69
    v_fma_f32 v16, v16, v68, v72
    v_fma_f32 v17, v17, v68, v72
    v_fma_f32 v18, v18, v68, v72
    v_fma_f32 v19, v19, v68, v72
    v_fma_f32 v20, v20, v68, v72
    v_fma_f32 v21, v21, v68, v72
    v_fma_f32 v22, v22, v68, v72
    v_fma_f32 v23, v23, v68, v72
    v_fma_f32 v24, v24, v68, v72
    v_fma_f32 v25, v25, v68, v72
    v_fma_f32 v26, v26, v68, v72
    v_fma_f32 v27, v27, v68, v72
    v_lshlrev_b32 v73, 16, v73
    v_mul_f32 v73, v73, v71
    v_fma_f32 v28, v28, v70, v73
    v_fma_f32 v29, v29, v70, v73
    v_fma_f32 v30, v30, v70, v73
    v_fma_f32 v31, v31, v70, v73
    v_fma_f32 v32, v32, v70, v73
    v_fma_f32 v33, v33, v70, v73
    v_fma_f32 v34, v34, v70, v73
    v_fma_f32 v35, v35, v70, v73
    v_fma_f32 v36, v36, v70, v73
    v_fma_f32 v37, v37, v70, v73
    v_fma_f32 v38, v38, v70, v73
    v_fma_f32 v39, v39, v70, v73
    s_mov_b32 s3, 0x40000
.poll_22:
    buffer_load_dwordx2 v[78:79], v74, s[8:11], s44 offen sc1
    s_sub_u32 s3, s3, 1
    s_cbranch_scc1 .got_23
    s_waitcnt vmcnt(0)
    v_cmp_ne_u64 vcc, s[96:97], v[78:79]
    s_cbranch_vccnz .poll_22
.got_23:
    buffer_load_dwordx4 v[96:99], v1, s[24:27], s48 offen offset:0 sc1
    buffer_load_dwordx4 v[100:103], v1, s[24:27], s48 offen offset:1024 sc1
    buffer_load_dwordx4 v[104:107], v1, s[24:27], s48 offen offset:2048 sc1
    buffer_load_dwordx4 v[108:111], v1, s[24:27], s49 offen offset:0 sc1
    buffer_load_dwordx4 v[112:115], v1, s[24:27], s49 offen offset:1024 sc1
    buffer_load_dwordx4 v[116:119], v1, s[24:27], s49 offen offset:2048 sc1
    buffer_load_dwordx4 v[120:123], v1, s[24:27], s50 offen offset:0 sc1
    buffer_load_dwordx4 v[124:127], v1, s[24:27], s50 offen offset:1024 sc1
    buffer_load_dwordx4 v[128:131], v1, s[24:27], s50 offen offset:2048 sc1
    ds_read_b128 v[144:147], v77 offset:0
    ds_read_b128 v[156:159], v77 offset:1024
    ds_read_b128 v[148:151], v77 offset:2048
    ds_read_b128 v[160:163], v77 offset:3072
    ds_read_b128 v[152:155], v77 offset:4096
    ds_read_b128 v[164:167], v77 offset:5120
    s_waitcnt lgkmcnt(0)
    s_waitcnt vmcnt(6)
    v_lshlrev_b32 v78, 16, v96
    v_and_b32 v79, 0xffff0000, v96
    v_pk_add_f32 v[144:145], v[144:145], v[78:79]
    v_lshlrev_b32 v78, 16, v97
    v_and_b32 v79, 0xffff0000, v97
    v_pk_add_f32 v[146:147], v[146:147], v[78:79]
    v_lshlrev_b32 v78, 16, v98
    v_and_b32 v79, 0xffff0000, v98
    v_pk_add_f32 v[148:149], v[148:149], v[78:79]
    v_lshlrev_b32 v78, 16, v99
    v_and_b32 v79, 0xffff0000, v99
    v_pk_add_f32 v[150:151], v[150:151], v[78:79]
    v_lshlrev_b32 v78, 16, v100
    v_and_b32 v79, 0xffff0000, v100
    v_pk_add_f32 v[152:153], v[152:153], v[78:79]
    v_lshlrev_b32 v78, 16, v101
    v_and_b32 v79, 0xffff0000, v101
    v_pk_add_f32 v[154:155], v[154:155], v[78:79]
    v_lshlrev_b32 v78, 16, v102
    v_and_b32 v79, 0xffff0000, v102
    v_pk_add_f32 v[156:157], v[156:157], v[78:79]
    v_lshlrev_b32 v78, 16, v103
    v_and_b32 v79, 0xffff0000, v103
    v_pk_add_f32 v[158:159], v[158:159], v[78:79]
    v_lshlrev_b32 v78, 16, v104
    v_and_b32 v79, 0xffff0000, v104
    v_pk_add_f32 v[160:161], v[160:161], v[78:79]
    v_lshlrev_b32 v78, 16, v105
    v_and_b32 v79, 0xffff0000, v105
    v_pk_add_f32 v[162:163], v[162:163], v[78:79]
    v_lshlrev_b32 v78, 16, v106
    v_and_b32 v79, 0xffff0000, v106
    v_pk_add_f32 v[164:165], v[164:165], v[78:79]
    v_lshlrev_b32 v78, 16, v107
    v_and_b32 v79, 0xffff0000, v107
    v_pk_add_f32 v[166:167], v[166:167], v[78:79]
    s_waitcnt vmcnt(3)
    v_lshlrev_b32 v78, 16, v108
    v_and_b32 v79, 0xffff0000, v108
    v_pk_add_f32 v[144:145], v[144:145], v[78:79]
    v_lshlrev_b32 v78, 16, v109
    v_and_b32 v79, 0xffff0000, v109
    v_pk_add_f32 v[146:147], v[146:147], v[78:79]
    v_lshlrev_b32 v78, 16, v110
    v_and_b32 v79, 0xffff0000, v110
    v_pk_add_f32 v[148:149], v[148:149], v[78:79]
    v_lshlrev_b32 v78, 16, v111
    v_and_b32 v79, 0xffff0000, v111
    v_pk_add_f32 v[150:151], v[150:151], v[78:79]
    v_lshlrev_b32 v78, 16, v112
    v_and_b32 v79, 0xffff0000, v112
    v_pk_add_f32 v[152:153], v[152:153], v[78:79]
    v_lshlrev_b32 v78, 16, v113
    v_and_b32 v79, 0xffff0000, v113
    v_pk_add_f32 v[154:155], v[154:155], v[78:79]
    v_lshlrev_b32 v78, 16, v114
    v_and_b32 v79, 0xffff0000, v114
    v_pk_add_f32 v[156:157], v[156:157], v[78:79]
    v_lshlrev_b32 v78, 16, v115
    v_and_b32 v79, 0xffff0000, v115
    v_pk_add_f32 v[158:159], v[158:159], v[78:79]
    v_lshlrev_b32 v78, 16, v116
    v_and_b32 v79, 0xffff0000, v116
    v_pk_add_f32 v[160:161], v[160:161], v[78:79]
    v_lshlrev_b32 v78, 16, v117
    v_and_b32 v79, 0xffff0000, v117
    v_pk_add_f32 v[162:163], v[162:163], v[78:79]
    v_lshlrev_b32 v78, 16, v118
    v_and_b32 v79, 0xffff0000, v118
    v_pk_add_f32 v[164:165], v[164:165], v[78:79]
    v_lshlrev_b32 v78, 16, v119
    v_and_b32 v79, 0xffff0000, v119
    v_pk_add_f32 v[166:167], v[166:167], v[78:79]
    s_waitcnt vmcnt(0)
    v_lshlrev_b32 v78, 16, v120
    v_and_b32 v79, 0xffff0000, v120
    v_pk_add_f32 v[144:145], v[144:145], v[78:79]
    v_lshlrev_b32 v78, 16, v121
    v_and_b32 v79, 0xffff0000, v121
    v_pk_add_f32 v[146:147], v[146:147], v[78:79]
    v_lshlrev_b32 v78, 16, v122
    v_and_b32 v79, 0xffff0000, v122
    v_pk_add_f32 v[148:149], v[148:149], v[78:79]
    v_lshlrev_b32 v78, 16, v123
    v_and_b32 v79, 0xffff0000, v123
    v_pk_add_f32 v[150:151], v[150:151], v[78:79]
    v_lshlrev_b32 v78, 16, v124
    v_and_b32 v79, 0xffff0000, v124
    v_pk_add_f32 v[152:153], v[152:153], v[78:79]
    v_lshlrev_b32 v78, 16, v125
    v_and_b32 v79, 0xffff0000, v125
    v_pk_add_f32 v[154:155], v[154:155], v[78:79]
    v_lshlrev_b32 v78, 16, v126
    v_and_b32 v79, 0xffff0000, v126
    v_pk_add_f32 v[156:157], v[156:157], v[78:79]
    v_lshlrev_b32 v78, 16, v127
    v_and_b32 v79, 0xffff0000, v127
    v_pk_add_f32 v[158:159], v[158:159], v[78:79]
    v_lshlrev_b32 v78, 16, v128
    v_and_b32 v79, 0xffff0000, v128
    v_pk_add_f32 v[160:161], v[160:161], v[78:79]
    v_lshlrev_b32 v78, 16, v129
    v_and_b32 v79, 0xffff0000, v129
    v_pk_add_f32 v[162:163], v[162:163], v[78:79]
    v_lshlrev_b32 v78, 16, v130
    v_and_b32 v79, 0xffff0000, v130
    v_pk_add_f32 v[164:165], v[164:165], v[78:79]
    v_lshlrev_b32 v78, 16, v131
    v_and_b32 v79, 0xffff0000, v131
    v_pk_add_f32 v[166:167], v[166:167], v[78:79]
    v_fma_f32 v16, v144, v69, v16
    v_fma_f32 v17, v145, v69, v17
    v_fma_f32 v18, v146, v69, v18
    v_fma_f32 v19, v147, v69, v19
    v_fma_f32 v20, v148, v69, v20
    v_fma_f32 v21, v149, v69, v21
    v_fma_f32 v22, v150, v69, v22
    v_fma_f32 v23, v151, v69, v23
    v_fma_f32 v24, v152, v69, v24
    v_fma_f32 v25, v153, v69, v25
    v_fma_f32 v26, v154, v69, v26
    v_fma_f32 v27, v155, v69, v27
    v_cvt_pk_bf16_f32 v96, v16, v17
    v_cvt_pk_bf16_f32 v97, v18, v19
    v_cvt_pk_bf16_f32 v98, v20, v21
    v_cvt_pk_bf16_f32 v100, v22, v23
    v_cvt_pk_bf16_f32 v101, v24, v25
    v_cvt_pk_bf16_f32 v102, v26, v27
    buffer_store_dwordx3 v[96:98], v75, s[20:23], s46 offen offset:0
    buffer_store_dwordx3 v[100:102], v75, s[20:23], s46 offen offset:12
    v_fma_f32 v28, v156, v71, v28
    v_fma_f32 v29, v157, v71, v29
    v_fma_f32 v30, v158, v71, v30
    v_fma_f32 v31, v159, v71, v31
    v_fma_f32 v32, v160, v71, v32
    v_fma_f32 v33, v161, v71, v33
    v_fma_f32 v34, v162, v71, v34
    v_fma_f32 v35, v163, v71, v35
    v_fma_f32 v36, v164, v71, v36
    v_fma_f32 v37, v165, v71, v37
    v_fma_f32 v38, v166, v71, v38
    v_fma_f32 v39, v167, v71, v39
    v_cvt_pk_bf16_f32 v104, v28, v29
    v_cvt_pk_bf16_f32 v105, v30, v31
    v_cvt_pk_bf16_f32 v106, v32, v33
    v_cvt_pk_bf16_f32 v108, v34, v35
    v_cvt_pk_bf16_f32 v109, v36, v37
    v_cvt_pk_bf16_f32 v110, v38, v39
    buffer_store_dwordx3 v[104:106], v75, s[20:23], s47 offen offset:0
    buffer_store_dwordx3 v[108:110], v75, s[20:23], s47 offen offset:12
    s_add_u32 s3, s2, s35
    s_cmp_lg_u32 s3, 0
    s_cbranch_scc1 .fin_24
    s_mov_b64 exec, 1
    v_mov_b64 v[2:3], s[96:97]
    buffer_store_dwordx2 v[2:3], off, s[8:11], s3 sc1
    s_mov_b64 exec, -1
.fin_24:
    s_endpgm
.g2w7_17:
    s_mov_b32 s37, s41
    s_add_u32 s40, s41, 4718592
    s_lshl_b32 s3, s51, 17
    s_add_u32 s41, s41, s3
    v_xor_b32 v38, 128, v32
    v_add_u32 v34, 65536, v32
    v_add_u32 v35, 80896, v38
    v_add_u32 v36, 96256, v32
    v_add_u32 v37, 111616, v38
    v_add_u32 v32, 49152, v38
    s_waitcnt vmcnt(8)
    s_barrier
    s_mov_b32 m0, s39
    s_add_u32 s42, s39, 1024
    buffer_load_dwordx4 v32, s[12:15], s41 offen lds
    s_mov_b32 m0, s42
    s_add_u32 s39, s39, 8192
    buffer_load_dwordx4 v34, s[12:15], s41 offen offset:0 lds
    buffer_load_dwordx4 v35, s[12:15], s41 offen offset:1024 lds
    buffer_load_dwordx4 v36, s[12:15], s41 offen offset:2048 lds
    buffer_load_dwordx4 v37, s[12:15], s41 offen offset:3072 lds
    s_add_u32 s41, s41, 131072
    s_cmp_eq_u32 s41, s40
    s_cselect_b32 s41, s37, s41
    s_cmp_eq_u32 s39, s47
    s_cselect_b32 s39, s48, s39
    s_mov_b32 m0, s39
    s_add_u32 s42, s39, 1024
    buffer_load_dwordx4 v32, s[12:15], s41 offen lds
    s_mov_b32 m0, s42
    s_add_u32 s39, s39, 8192
    buffer_load_dwordx4 v34, s[12:15], s41 offen offset:0 lds
    buffer_load_dwordx4 v35, s[12:15], s41 offen offset:1024 lds
    buffer_load_dwordx4 v36, s[12:15], s41 offen offset:2048 lds
    buffer_load_dwordx4 v37, s[12:15], s41 offen offset:3072 lds
    s_add_u32 s41, s41, 131072
    s_cmp_eq_u32 s41, s40
    s_cselect_b32 s41, s37, s41
    s_cmp_eq_u32 s39, s47
    s_cselect_b32 s39, s48, s39
    s_mov_b32 m0, s39
    s_add_u32 s42, s39, 1024
    buffer_load_dwordx4 v32, s[12:15], s41 offen lds
    s_mov_b32 m0, s42
    s_add_u32 s39, s39, 8192
    buffer_load_dwordx4 v34, s[12:15], s41 offen offset:0 lds
    buffer_load_dwordx4 v35, s[12:15], s41 offen offset:1024 lds
    buffer_load_dwordx4 v36, s[12:15], s41 offen offset:2048 lds
    buffer_load_dwordx4 v37, s[12:15], s41 offen offset:3072 lds
    s_add_u32 s41, s41, 131072
    s_cmp_eq_u32 s41, s40
    s_cselect_b32 s41, s37, s41
    s_cmp_eq_u32 s39, s47
    s_cselect_b32 s39, s48, s39
    s_mov_b32 m0, s39
    s_add_u32 s42, s39, 1024
    buffer_load_dwordx4 v32, s[12:15], s41 offen lds
    s_mov_b32 m0, s42
    s_add_u32 s39, s39, 8192
    buffer_load_dwordx4 v34, s[12:15], s41 offen offset:0 lds
    buffer_load_dwordx4 v35, s[12:15], s41 offen offset:1024 lds
    buffer_load_dwordx4 v36, s[12:15], s41 offen offset:2048 lds
    buffer_load_dwordx4 v37, s[12:15], s41 offen offset:3072 lds
    s_add_u32 s41, s41, 131072
    s_cmp_eq_u32 s41, s40
    s_cselect_b32 s41, s37, s41
    s_cmp_eq_u32 s39, s47
    s_cselect_b32 s39, s48, s39
    s_waitcnt vmcnt(24)
    s_barrier
    s_mov_b32 m0, s39
    s_add_u32 s42, s39, 1024
    buffer_load_dwordx4 v32, s[12:15], s41 offen lds
    s_mov_b32 m0, s42
    s_add_u32 s39, s39, 8192
    buffer_load_dwordx4 v34, s[12:15], s41 offen offset:0 lds
    buffer_load_dwordx4 v35, s[12:15], s41 offen offset:1024 lds
    buffer_load_dwordx4 v36, s[12:15], s41 offen offset:2048 lds
    buffer_load_dwordx4 v37, s[12:15], s41 offen offset:3072 lds
    s_add_u32 s41, s41, 131072
    s_cmp_eq_u32 s41, s40
    s_cselect_b32 s41, s37, s41
    s_cmp_eq_u32 s39, s47
    s_cselect_b32 s39, s48, s39
    s_mov_b32 m0, s39
    s_add_u32 s42, s39, 1024
    buffer_load_dwordx4 v32, s[12:15], s41 offen lds
    s_mov_b32 m0, s42
    s_add_u32 s39, s39, 8192
    buffer_load_dwordx4 v34, s[12:15], s41 offen offset:0 lds
    buffer_load_dwordx4 v35, s[12:15], s41 offen offset:1024 lds
    buffer_load_dwordx4 v36, s[12:15], s41 offen offset:2048 lds
    buffer_load_dwordx4 v37, s[12:15], s41 offen offset:3072 lds
    s_add_u32 s41, s41, 131072
    s_cmp_eq_u32 s41, s40
    s_cselect_b32 s41, s37, s41
    s_cmp_eq_u32 s39, s47
    s_cselect_b32 s39, s48, s39
    s_waitcnt vmcnt(30)
    s_barrier
    s_mov_b32 m0, s39
    s_add_u32 s42, s39, 1024
    buffer_load_dwordx4 v32, s[12:15], s41 offen lds
    s_mov_b32 m0, s42
    s_add_u32 s39, s39, 8192
    buffer_load_dwordx4 v34, s[12:15], s41 offen offset:0 lds
    buffer_load_dwordx4 v35, s[12:15], s41 offen offset:1024 lds
    buffer_load_dwordx4 v36, s[12:15], s41 offen offset:2048 lds
    buffer_load_dwordx4 v37, s[12:15], s41 offen offset:3072 lds
    s_add_u32 s41, s41, 131072
    s_cmp_eq_u32 s41, s40
    s_cselect_b32 s41, s37, s41
    s_cmp_eq_u32 s39, s47
    s_cselect_b32 s39, s48, s39
    s_mov_b32 m0, s39
    s_add_u32 s42, s39, 1024
    buffer_load_dwordx4 v32, s[12:15], s41 offen lds
    s_mov_b32 m0, s42
    s_add_u32 s39, s39, 8192
    buffer_load_dwordx4 v34, s[12:15], s41 offen offset:0 lds
    buffer_load_dwordx4 v35, s[12:15], s41 offen offset:1024 lds
    buffer_load_dwordx4 v36, s[12:15], s41 offen offset:2048 lds
    buffer_load_dwordx4 v37, s[12:15], s41 offen offset:3072 lds
    s_add_u32 s41, s41, 131072
    s_cmp_eq_u32 s41, s40
    s_cselect_b32 s41, s37, s41
    s_cmp_eq_u32 s39, s47
    s_cselect_b32 s39, s48, s39
    s_barrier
    s_mov_b32 m0, s39
    s_add_u32 s42, s39, 1024
    buffer_load_dwordx4 v32, s[12:15], s41 offen lds
    s_mov_b32 m0, s42
    s_add_u32 s39, s39, 8192
    buffer_load_dwordx4 v34, s[12:15], s41 offen offset:0 lds
    buffer_load_dwordx4 v35, s[12:15], s41 offen offset:1024 lds
    buffer_load_dwordx4 v36, s[12:15], s41 offen offset:2048 lds
    buffer_load_dwordx4 v37, s[12:15], s41 offen offset:3072 lds
    s_add_u32 s41, s41, 131072
    s_cmp_eq_u32 s41, s40
    s_cselect_b32 s41, s37, s41
    s_cmp_eq_u32 s39, s47
    s_cselect_b32 s39, s48, s39
    s_mov_b32 m0, s39
    s_add_u32 s42, s39, 1024
    buffer_load_dwordx4 v32, s[12:15], s41 offen lds
    s_mov_b32 m0, s42
    s_add_u32 s39, s39, 8192
    buffer_load_dwordx4 v34, s[12:15], s41 offen offset:0 lds
    buffer_load_dwordx4 v35, s[12:15], s41 offen offset:1024 lds
    buffer_load_dwordx4 v36, s[12:15], s41 offen offset:2048 lds
    buffer_load_dwordx4 v37, s[12:15], s41 offen offset:3072 lds
    s_add_u32 s41, s41, 131072
    s_cmp_eq_u32 s41, s40
    s_cselect_b32 s41, s37, s41
    s_cmp_eq_u32 s39, s47
    s_cselect_b32 s39, s48, s39
    s_barrier
    s_mov_b32 m0, s39
    s_add_u32 s42, s39, 1024
    buffer_load_dwordx4 v32, s[12:15], s41 offen lds
    s_mov_b32 m0, s42
    s_add_u32 s39, s39, 8192
    buffer_load_dwordx4 v34, s[12:15], s41 offen offset:0 lds
    buffer_load_dwordx4 v35, s[12:15], s41 offen offset:1024 lds
    buffer_load_dwordx4 v36, s[12:15], s41 offen offset:2048 lds
    buffer_load_dwordx4 v37, s[12:15], s41 offen offset:3072 lds
    s_add_u32 s41, s41, 131072
    s_cmp_eq_u32 s41, s40
    s_cselect_b32 s41, s37, s41
    s_cmp_eq_u32 s39, s47
    s_cselect_b32 s39, s48, s39
    s_mov_b32 m0, s39
    s_add_u32 s42, s39, 1024
    buffer_load_dwordx4 v32, s[12:15], s41 offen lds
    s_mov_b32 m0, s42
    s_add_u32 s39, s39, 8192
    buffer_load_dwordx4 v34, s[12:15], s41 offen offset:0 lds
    buffer_load_dwordx4 v35, s[12:15], s41 offen offset:1024 lds
    buffer_load_dwordx4 v36, s[12:15], s41 offen offset:2048 lds
    buffer_load_dwordx4 v37, s[12:15], s41 offen offset:3072 lds
    s_add_u32 s41, s41, 131072
    s_cmp_eq_u32 s41, s40
    s_cselect_b32 s41, s37, s41
    s_cmp_eq_u32 s39, s47
    s_cselect_b32 s39, s48, s39
    s_barrier
    s_waitcnt vmcnt(55)
    s_barrier
    s_waitcnt vmcnt(45)
    s_barrier
    s_mov_b32 m0, s39
    s_add_u32 s42, s39, 1024
    buffer_load_dwordx4 v32, s[12:15], s41 offen lds
    s_mov_b32 m0, s42
    s_add_u32 s39, s39, 8192
    buffer_load_dwordx4 v34, s[12:15], s41 offen offset:0 lds
    buffer_load_dwordx4 v35, s[12:15], s41 offen offset:1024 lds
    buffer_load_dwordx4 v36, s[12:15], s41 offen offset:2048 lds
    buffer_load_dwordx4 v37, s[12:15], s41 offen offset:3072 lds
    s_add_u32 s41, s41, 131072
    s_cmp_eq_u32 s41, s40
    s_cselect_b32 s41, s37, s41
    s_cmp_eq_u32 s39, s47
    s_cselect_b32 s39, s48, s39
    s_mov_b32 s46, 11
.g2l_25:
    s_waitcnt vmcnt(40)
    s_barrier
    s_mov_b32 m0, s39
    s_add_u32 s42, s39, 1024
    buffer_load_dwordx4 v32, s[12:15], s41 offen lds
    s_mov_b32 m0, s42
    s_add_u32 s39, s39, 8192
    buffer_load_dwordx4 v34, s[12:15], s41 offen offset:0 lds
    buffer_load_dwordx4 v35, s[12:15], s41 offen offset:1024 lds
    buffer_load_dwordx4 v36, s[12:15], s41 offen offset:2048 lds
    buffer_load_dwordx4 v37, s[12:15], s41 offen offset:3072 lds
    s_add_u32 s41, s41, 131072
    s_cmp_eq_u32 s41, s40
    s_cselect_b32 s41, s37, s41
    s_cmp_eq_u32 s39, s47
    s_cselect_b32 s39, s48, s39
    s_mov_b32 m0, s39
    s_add_u32 s42, s39, 1024
    buffer_load_dwordx4 v32, s[12:15], s41 offen lds
    s_mov_b32 m0, s42
    s_add_u32 s39, s39, 8192
    buffer_load_dwordx4 v34, s[12:15], s41 offen offset:0 lds
    buffer_load_dwordx4 v35, s[12:15], s41 offen offset:1024 lds
    buffer_load_dwordx4 v36, s[12:15], s41 offen offset:2048 lds
    buffer_load_dwordx4 v37, s[12:15], s41 offen offset:3072 lds
    s_add_u32 s41, s41, 131072
    s_cmp_eq_u32 s41, s40
    s_cselect_b32 s41, s37, s41
    s_cmp_eq_u32 s39, s47
    s_cselect_b32 s39, s48, s39
    s_sub_u32 s46, s46, 1
    s_cmp_lg_u32 s46, 0
    s_cbranch_scc1 .g2l_25
    s_waitcnt vmcnt(40)
    s_barrier
    s_mov_b32 m0, s39
    s_add_u32 s42, s39, 1024
    buffer_load_dwordx4 v32, s[12:15], s41 offen lds
    s_mov_b32 m0, s42
    s_add_u32 s39, s39, 8192
    buffer_load_dwordx4 v34, s[12:15], s41 offen offset:0 lds
    buffer_load_dwordx4 v35, s[12:15], s41 offen offset:1024 lds
    buffer_load_dwordx4 v36, s[12:15], s41 offen offset:2048 lds
    buffer_load_dwordx4 v37, s[12:15], s41 offen offset:3072 lds
    s_add_u32 s41, s41, 131072
    s_cmp_eq_u32 s41, s40
    s_cselect_b32 s41, s37, s41
    s_cmp_eq_u32 s39, s47
    s_cselect_b32 s39, s48, s39
    s_mov_b32 m0, s45
    s_add_u32 s45, s45, 4096
    buffer_load_dwordx4 v33, s[20:23], s44 offen sc1 lds
    s_add_u32 s44, s44, 262144
    s_mov_b32 m0, s45
    s_add_u32 s45, s45, 4096
    buffer_load_dwordx4 v33, s[20:23], s44 offen sc1 lds
    s_add_u32 s44, s44, 262144
    s_waitcnt vmcnt(37)
    s_barrier
    s_mov_b32 m0, s45
    s_add_u32 s45, s45, 4096
    buffer_load_dwordx4 v33, s[20:23], s44 offen sc1 lds
    s_add_u32 s44, s44, 262144
    s_mov_b32 m0, s45
    s_add_u32 s45, s45, 4096
    buffer_load_dwordx4 v33, s[20:23], s44 offen sc1 lds
    s_add_u32 s44, s44, 262144
    s_mov_b32 m0, s45
    s_add_u32 s45, s45, 4096
    buffer_load_dwordx4 v33, s[20:23], s44 offen sc1 lds
    s_add_u32 s44, s44, 262144
    s_mov_b32 m0, s45
    s_add_u32 s45, s45, 4096
    buffer_load_dwordx4 v33, s[20:23], s44 offen sc1 lds
    s_add_u32 s44, s44, 262144
    s_waitcnt vmcnt(31)
    s_barrier
    s_mov_b32 m0, s45
    s_add_u32 s45, s45, 4096
    buffer_load_dwordx4 v33, s[20:23], s44 offen sc1 lds
    s_add_u32 s44, s44, 262144
    s_mov_b32 m0, s45
    s_add_u32 s45, s45, 4096
    buffer_load_dwordx4 v33, s[20:23], s44 offen sc1 lds
    s_add_u32 s44, s44, 262144
    s_mov_b32 m0, s45
    s_add_u32 s45, s45, 4096
    buffer_load_dwordx4 v33, s[20:23], s44 offen sc1 lds
    s_add_u32 s44, s44, 262144
    s_waitcnt vmcnt(24)
    s_barrier
    s_waitcnt vmcnt(14)
    s_barrier
    s_waitcnt vmcnt(0)
    s_barrier
    s_endpgm
.hlp_3:
    s_cmp_lg_u32 s30, 3
    s_cbranch_scc1 .dft_26
    s_and_b32 s31, s2, 3
    s_bfe_u32 s32, s2, 0x10002
    s_bfe_u32 s33, s2, 0x20005
    s_bfe_u32 s34, s2, 0x10007
    v_lshlrev_b32 v6, 4, v0
    v_add_u32 v7, 1024, v6
    v_subrev_u32 v8, 128, v6
    v_cmp_gt_u32 vcc, 8, v0
    s_nop 1
    v_cndmask_b32 v7, v8, v7, vcc
    v_and_b32 v2, 7, v0
    v_lshrrev_b32 v3, 3, v0
    v_mul_u32_u24 v4, 578, v2
    v_mul_u32_u24 v5, 18, v3
    v_add_u32 v4, v4, v5
    v_mul_u32_u24 v5, 73728, v3
    v_lshl_add_u32 v5, v2, 4, v5
    s_lshl_b32 s35, s33, 2
    s_add_u32 s35, s35, s32
    s_lshl_b32 s35, s35, 4
    s_add_u32 s35, s35, s31
    s_mul_i32 s35, s35, 4624
    s_mul_i32 s3, s29, 144
    s_add_u32 s35, s35, s3
    s_lshl_b32 s36, s33, 1
    s_add_u32 s36, s36, s34
    s_lshl_b32 s36, s36, 1
    s_add_u32 s36, s36, s32
    s_lshl_b32 s36, s36, 2
    s_add_u32 s36, s36, s31
    s_lshl_b32 s36, s36, 7
    s_mul_i32 s3, s29, 589824
    s_add_u32 s36, s36, s3
    v_mov_b32 v8, 57344
    v_mov_b64 v[12:13], 0
    v_mov_b64 v[14:15], 0
    s_mov_b32 m0, 58368
    s_cmp_eq_u32 s34, 0
    s_waitcnt lgkmcnt(0)
    s_cselect_b32 s12, s54, s56
    s_cselect_b32 s13, s55, s57
    s_mov_b32 s14, 1183744
    s_mov_b32 s15, 0x20000
    s_mov_b32 s16, s68
    s_mov_b32 s17, s69
    s_mov_b32 s18, 1152
    s_mov_b32 s19, 0x20000
    buffer_load_dwordx4 v6, s[16:19], 0 offen lds
    s_mov_b32 m0, 59392
    ds_write_b128 v8, v[12:15]
    buffer_load_dwordx4 v7, s[16:19], 0 offen lds
    s_load_dwordx2 s[96:97], s[74:75], 0
    s_mov_b32 s8, s74
    s_mov_b32 s9, s75
    s_mov_b32 s10, 262144
    s_mov_b32 s11, 0x20000
    buffer_load_dwordx4 v[160:163], v4, s[12:15], s35 offen
    buffer_load_dword v164, v4, s[12:15], s35 offen offset:16
    s_add_u32 s35, s35, 18496
    buffer_load_dwordx4 v[166:169], v4, s[12:15], s35 offen
    buffer_load_dword v170, v4, s[12:15], s35 offen offset:16
    s_add_u32 s35, s35, 18496
    buffer_load_dwordx4 v[172:175], v4, s[12:15], s35 offen
    buffer_load_dword v176, v4, s[12:15], s35 offen offset:16
    s_add_u32 s35, s35, 18496
    buffer_load_dwordx4 v[178:181], v4, s[12:15], s35 offen
    buffer_load_dword v182, v4, s[12:15], s35 offen offset:16
    s_add_u32 s35, s35, 92480
    buffer_load_dwordx4 v[184:187], v4, s[12:15], s35 offen
    buffer_load_dword v188, v4, s[12:15], s35 offen offset:16
    s_add_u32 s35, s35, 18496
    buffer_load_dwordx4 v[190:193], v4, s[12:15], s35 offen
    buffer_load_dword v194, v4, s[12:15], s35 offen offset:16
    s_add_u32 s35, s35, 18496
    buffer_load_dwordx4 v[196:199], v4, s[12:15], s35 offen
    buffer_load_dword v200, v4, s[12:15], s35 offen offset:16
    s_add_u32 s35, s35, 18496
    buffer_load_dwordx4 v[202:205], v4, s[12:15], s35 offen
    buffer_load_dword v206, v4, s[12:15], s35 offen offset:16
    s_mov_b32 s44, s60
    s_mov_b32 s45, s61
    s_mov_b32 s46, 18874368
    s_mov_b32 s47, 0x20000
    s_and_b32 s48, s2, 7
    s_mul_i32 s48, s48, 9
    s_lshr_b32 s48, s48, 1
    s_lshl_b32 s48, s48, 8
    s_lshr_b32 s3, s2, 3
    s_mul_i32 s3, s3, 589824
    s_add_u32 s48, s48, s3
    s_add_u32 s16, s74, 22102016
    s_addc_u32 s17, s75, 0
    s_mov_b32 s18, 2367488
    s_mov_b32 s19, 0x20000
    s_mov_b32 s40, 0x05040100
    s_mov_b32 s41, 0x07060302
    s_waitcnt vmcnt(16) lgkmcnt(0)
    s_mul_i32 s96, s96, 0x41c64e6d
    s_mul_i32 s97, s97, 0x2c9277b5
    s_add_u32 s96, s96, 0x3c6ef35f
    s_add_u32 s97, s97, 0x1b873593
    s_barrier
    s_waitcnt vmcnt(0)
    v_perm_b32 v208, v166, v160, s40
    v_perm_b32 v209, v178, v172, s40
    v_perm_b32 v210, v190, v184, s40
    v_perm_b32 v211, v202, v196, s40
    buffer_store_dwordx4 v[208:211], v5, s[16:19], s36 offen sc1
    s_add_u32 s36, s36, 8192
    v_perm_b32 v212, v166, v160, s41
    v_perm_b32 v213, v178, v172, s41
    v_perm_b32 v214, v190, v184, s41
    v_perm_b32 v215, v202, v196, s41
    buffer_store_dwordx4 v[212:215], v5, s[16:19], s36 offen sc1
    s_add_u32 s36, s36, 8192
    v_perm_b32 v216, v167, v161, s40
    v_perm_b32 v217, v179, v173, s40
    v_perm_b32 v218, v191, v185, s40
    v_perm_b32 v219, v203, v197, s40
    buffer_store_dwordx4 v[216:219], v5, s[16:19], s36 offen sc1
    s_add_u32 s36, s36, 8192
    v_perm_b32 v220, v167, v161, s41
    v_perm_b32 v221, v179, v173, s41
    v_perm_b32 v222, v191, v185, s41
    v_perm_b32 v223, v203, v197, s41
    buffer_store_dwordx4 v[220:223], v5, s[16:19], s36 offen sc1
    s_add_u32 s36, s36, 8192
    v_perm_b32 v224, v168, v162, s40
    v_perm_b32 v225, v180, v174, s40
    v_perm_b32 v226, v192, v186, s40
    v_perm_b32 v227, v204, v198, s40
    buffer_store_dwordx4 v[224:227], v5, s[16:19], s36 offen sc1
    s_add_u32 s36, s36, 8192
    v_perm_b32 v228, v168, v162, s41
    v_perm_b32 v229, v180, v174, s41
    v_perm_b32 v230, v192, v186, s41
    v_perm_b32 v231, v204, v198, s41
    buffer_store_dwordx4 v[228:231], v5, s[16:19], s36 offen sc1
    s_add_u32 s36, s36, 8192
    v_perm_b32 v232, v169, v163, s40
    v_perm_b32 v233, v181, v175, s40
    v_perm_b32 v234, v193, v187, s40
    v_perm_b32 v235, v205, v199, s40
    buffer_store_dwordx4 v[232:235], v5, s[16:19], s36 offen sc1
    s_add_u32 s36, s36, 8192
    v_perm_b32 v236, v169, v163, s41
    v_perm_b32 v237, v181, v175, s41
    v_perm_b32 v238, v193, v187, s41
    v_perm_b32 v239, v205, v199, s41
    buffer_store_dwordx4 v[236:239], v5, s[16:19], s36 offen sc1
    s_add_u32 s36, s36, 8192
    v_perm_b32 v240, v170, v164, s40
    v_perm_b32 v241, v182, v176, s40
    v_perm_b32 v242, v194, v188, s40
    v_perm_b32 v243, v206, v200, s40
    buffer_store_dwordx4 v[240:243], v5, s[16:19], s36 offen sc1
    s_add_u32 s36, s36, 8192
    s_cmp_lg_u32 s29, 3
    s_cbranch_scc1 .p1c_4
    s_mov_b32 exec_lo, 0
    s_mov_b32 exec_hi, 0xff000000
    v_perm_b32 v244, v170, v164, s41
    v_perm_b32 v245, v182, v176, s41
    v_perm_b32 v246, v194, v188, s41
    v_perm_b32 v247, v206, v200, s41
    buffer_store_dwordx4 v[244:247], v5, s[16:19], s36 offen sc1
    s_add_u32 s36, s36, 8192
    s_mov_b64 exec, -1
    s_branch .p1c_4
.dft_26:
    v_lshrrev_b32 v4, 4, v0
    v_and_b32 v5, 15, v0
    v_lshrrev_b32 v6, 3, v5
    v_mul_u32_u24 v6, 9216, v6
    v_and_b32 v7, 7, v5
    v_lshl_add_u32 v6, v7, 7, v6
    v_lshrrev_b32 v7, 1, v5
    v_xor_b32 v7, v7, v4
    v_lshl_add_u32 v6, v7, 4, v6
    v_xor_b32 v7, 64, v6
    v_add_u32 v6, 61440, v6
    v_add_u32 v7, 61440, v7
    s_mul_i32 s3, s29, 9
    s_mul_i32 s33, s30, 3
    s_add_u32 s3, s3, s33
    s_lshl_b32 s33, s3, 3
    v_lshrrev_b32 v8, 1, v5
    v_add_u32 v8, s33, v8
    v_and_b32 v9, 1, v5
    v_cvt_f32_u32 v10, v9
    v_mul_f32 v10, 0x3e800000, v10
    v_lshlrev_b32 v11, 3, v4
    v_cvt_f32_u32 v11, v11
    v_lshlrev_b32 v16, 13, v8
    v_lshl_add_u32 v16, v9, 6, v16
    v_lshl_add_u32 v16, v4, 4, v16
    s_lshl_b32 s34, s28, 7
    v_and_b32 v17, 1, v8
    v_cvt_f32_u32 v17, v17
    v_fma_f32 v17, v17, -2.0, 1.0
    v_lshl_add_u32 v12, v8, 1, v9
    v_cmp_eq_u32 vcc, 1, v12
    v_mov_b32 v13, 288
    s_nop 0
    v_cndmask_b32 v13, v8, v13, vcc
    v_cndmask_b32 v14, v10, 0, vcc
    v_cvt_f32_u32 v18, v13
    v_mul_f32 v18, 0x3ae38e39, v18
    v_fma_f32 v19, v18, v11, v14
    v_mul_f32 v20, 0x42000000, v18
    v_cos_f32 v20, v20
    v_mov_b32 v32, v19
    v_fmamk_f32 v33, v18, 0x3f800000, v19
    v_fmamk_f32 v34, v18, 0x40000000, v19
    v_fmamk_f32 v35, v18, 0x40400000, v19
    v_fmamk_f32 v36, v18, 0x40800000, v19
    v_fmamk_f32 v37, v18, 0x40a00000, v19
    v_fmamk_f32 v38, v18, 0x40c00000, v19
    v_fmamk_f32 v39, v18, 0x40e00000, v19
    v_cos_f32 v32, v32
    v_cos_f32 v33, v33
    v_cos_f32 v34, v34
    v_cos_f32 v35, v35
    v_cos_f32 v36, v36
    v_cos_f32 v37, v37
    v_cos_f32 v38, v38
    v_cos_f32 v39, v39
    v_add_f32 v20, v20, v20
    v_fmamk_f32 v40, v18, 0x42000000, v19
    v_fmamk_f32 v41, v18, 0x42040000, v19
    v_fmamk_f32 v42, v18, 0x42080000, v19
    v_fmamk_f32 v43, v18, 0x420c0000, v19
    v_fmamk_f32 v44, v18, 0x42100000, v19
    v_fmamk_f32 v45, v18, 0x42140000, v19
    v_fmamk_f32 v46, v18, 0x42180000, v19
    v_fmamk_f32 v47, v18, 0x421c0000, v19
    v_cos_f32 v40, v40
    v_cos_f32 v41, v41
    v_cos_f32 v42, v42
    v_cos_f32 v43, v43
    v_cos_f32 v44, v44
    v_cos_f32 v45, v45
    v_cos_f32 v46, v46
    v_cos_f32 v47, v47
    v_cvt_pk_bf16_f32 v64, v32, v33
    v_cvt_pk_bf16_f32 v65, v34, v35
    v_cvt_pk_bf16_f32 v66, v36, v37
    v_cvt_pk_bf16_f32 v67, v38, v39
    v_cvt_pk_bf16_f32 v68, v40, v41
    v_cvt_pk_bf16_f32 v69, v42, v43
    v_cvt_pk_bf16_f32 v70, v44, v45
    v_cvt_pk_bf16_f32 v71, v46, v47
    v_pk_fma_f32 v[32:33], v[20:21], v[40:41], v[32:33] op_sel_hi:[0,1,1] neg_lo:[0,0,1] neg_hi:[0,0,1]
    v_pk_fma_f32 v[34:35], v[20:21], v[42:43], v[34:35] op_sel_hi:[0,1,1] neg_lo:[0,0,1] neg_hi:[0,0,1]
    v_pk_fma_f32 v[36:37], v[20:21], v[44:45], v[36:37] op_sel_hi:[0,1,1] neg_lo:[0,0,1] neg_hi:[0,0,1]
    v_pk_fma_f32 v[38:39], v[20:21], v[46:47], v[38:39] op_sel_hi:[0,1,1] neg_lo:[0,0,1] neg_hi:[0,0,1]
    v_cvt_pk_bf16_f32 v72, v32, v33
    v_cvt_pk_bf16_f32 v73, v34, v35
    v_cvt_pk_bf16_f32 v74, v36, v37
    v_cvt_pk_bf16_f32 v75, v38, v39
    v_pk_fma_f32 v[40:41], v[20:21], v[32:33], v[40:41] op_sel_hi:[0,1,1] neg_lo:[0,0,1] neg_hi:[0,0,1]
    v_pk_fma_f32 v[42:43], v[20:21], v[34:35], v[42:43] op_sel_hi:[0,1,1] neg_lo:[0,0,1] neg_hi:[0,0,1]
    v_pk_fma_f32 v[44:45], v[20:21], v[36:37], v[44:45] op_sel_hi:[0,1,1] neg_lo:[0,0,1] neg_hi:[0,0,1]
    v_pk_fma_f32 v[46:47], v[20:21], v[38:39], v[46:47] op_sel_hi:[0,1,1] neg_lo:[0,0,1] neg_hi:[0,0,1]
    v_cvt_pk_bf16_f32 v76, v40, v41
    v_cvt_pk_bf16_f32 v77, v42, v43
    v_cvt_pk_bf16_f32 v78, v44, v45
    v_cvt_pk_bf16_f32 v79, v46, v47
    v_pk_fma_f32 v[32:33], v[20:21], v[40:41], v[32:33] op_sel_hi:[0,1,1] neg_lo:[0,0,1] neg_hi:[0,0,1]
    v_pk_fma_f32 v[34:35], v[20:21], v[42:43], v[34:35] op_sel_hi:[0,1,1] neg_lo:[0,0,1] neg_hi:[0,0,1]
    v_pk_fma_f32 v[36:37], v[20:21], v[44:45], v[36:37] op_sel_hi:[0,1,1] neg_lo:[0,0,1] neg_hi:[0,0,1]
    v_pk_fma_f32 v[38:39], v[20:21], v[46:47], v[38:39] op_sel_hi:[0,1,1] neg_lo:[0,0,1] neg_hi:[0,0,1]
    v_cvt_pk_bf16_f32 v80, v32, v33
    v_cvt_pk_bf16_f32 v81, v34, v35
    v_cvt_pk_bf16_f32 v82, v36, v37
    v_cvt_pk_bf16_f32 v83, v38, v39
    v_pk_fma_f32 v[40:41], v[20:21], v[32:33], v[40:41] op_sel_hi:[0,1,1] neg_lo:[0,0,1] neg_hi:[0,0,1]
    v_pk_fma_f32 v[42:43], v[20:21], v[34:35], v[42:43] op_sel_hi:[0,1,1] neg_lo:[0,0,1] neg_hi:[0,0,1]
    v_pk_fma_f32 v[44:45], v[20:21], v[36:37], v[44:45] op_sel_hi:[0,1,1] neg_lo:[0,0,1] neg_hi:[0,0,1]
    v_pk_fma_f32 v[46:47], v[20:21], v[38:39], v[46:47] op_sel_hi:[0,1,1] neg_lo:[0,0,1] neg_hi:[0,0,1]
    v_cvt_pk_bf16_f32 v84, v40, v41
    v_cvt_pk_bf16_f32 v85, v42, v43
    v_cvt_pk_bf16_f32 v86, v44, v45
    v_cvt_pk_bf16_f32 v87, v46, v47
    v_pk_fma_f32 v[32:33], v[20:21], v[40:41], v[32:33] op_sel_hi:[0,1,1] neg_lo:[0,0,1] neg_hi:[0,0,1]
    v_pk_fma_f32 v[34:35], v[20:21], v[42:43], v[34:35] op_sel_hi:[0,1,1] neg_lo:[0,0,1] neg_hi:[0,0,1]
    v_pk_fma_f32 v[36:37], v[20:21], v[44:45], v[36:37] op_sel_hi:[0,1,1] neg_lo:[0,0,1] neg_hi:[0,0,1]
    v_pk_fma_f32 v[38:39], v[20:21], v[46:47], v[38:39] op_sel_hi:[0,1,1] neg_lo:[0,0,1] neg_hi:[0,0,1]
    v_cvt_pk_bf16_f32 v88, v32, v33
    v_cvt_pk_bf16_f32 v89, v34, v35
    v_cvt_pk_bf16_f32 v90, v36, v37
    v_cvt_pk_bf16_f32 v91, v38, v39
    v_pk_fma_f32 v[40:41], v[20:21], v[32:33], v[40:41] op_sel_hi:[0,1,1] neg_lo:[0,0,1] neg_hi:[0,0,1]
    v_pk_fma_f32 v[42:43], v[20:21], v[34:35], v[42:43] op_sel_hi:[0,1,1] neg_lo:[0,0,1] neg_hi:[0,0,1]
    v_pk_fma_f32 v[44:45], v[20:21], v[36:37], v[44:45] op_sel_hi:[0,1,1] neg_lo:[0,0,1] neg_hi:[0,0,1]
    v_pk_fma_f32 v[46:47], v[20:21], v[38:39], v[46:47] op_sel_hi:[0,1,1] neg_lo:[0,0,1] neg_hi:[0,0,1]
    v_cvt_pk_bf16_f32 v92, v40, v41
    v_cvt_pk_bf16_f32 v93, v42, v43
    v_cvt_pk_bf16_f32 v94, v44, v45
    v_cvt_pk_bf16_f32 v95, v46, v47
    v_pk_fma_f32 v[32:33], v[20:21], v[40:41], v[32:33] op_sel_hi:[0,1,1] neg_lo:[0,0,1] neg_hi:[0,0,1]
    v_pk_fma_f32 v[34:35], v[20:21], v[42:43], v[34:35] op_sel_hi:[0,1,1] neg_lo:[0,0,1] neg_hi:[0,0,1]
    v_pk_fma_f32 v[36:37], v[20:21], v[44:45], v[36:37] op_sel_hi:[0,1,1] neg_lo:[0,0,1] neg_hi:[0,0,1]
    v_pk_fma_f32 v[38:39], v[20:21], v[46:47], v[38:39] op_sel_hi:[0,1,1] neg_lo:[0,0,1] neg_hi:[0,0,1]
    v_cvt_pk_bf16_f32 v96, v32, v33
    v_cvt_pk_bf16_f32 v97, v34, v35
    v_cvt_pk_bf16_f32 v98, v36, v37
    v_cvt_pk_bf16_f32 v99, v38, v39
    s_waitcnt lgkmcnt(0)
    s_load_dwordx2 s[96:97], s[74:75], 0
    s_mov_b32 s8, s74
    s_mov_b32 s9, s75
    s_mov_b32 s10, 262144
    s_mov_b32 s11, 0x20000
    s_mov_b32 s44, s60
    s_mov_b32 s45, s61
    s_mov_b32 s46, 18874368
    s_mov_b32 s47, 0x20000
    s_and_b32 s48, s2, 7
    s_mul_i32 s48, s48, 9
    s_lshr_b32 s48, s48, 1
    s_lshl_b32 s48, s48, 8
    s_lshr_b32 s3, s2, 3
    s_mul_i32 s3, s3, 589824
    s_add_u32 s48, s48, s3
    v_add_u32 v18, 8, v8
    v_cvt_f32_u32 v18, v18
    v_mul_f32 v18, 0x3ae38e39, v18
    v_fma_f32 v19, v18, v11, v10
    v_mul_f32 v20, 0x42000000, v18
    v_cos_f32 v20, v20
    v_mov_b32 v32, v19
    v_fmamk_f32 v33, v18, 0x3f800000, v19
    v_fmamk_f32 v34, v18, 0x40000000, v19
    v_fmamk_f32 v35, v18, 0x40400000, v19
    v_fmamk_f32 v36, v18, 0x40800000, v19
    v_fmamk_f32 v37, v18, 0x40a00000, v19
    v_fmamk_f32 v38, v18, 0x40c00000, v19
    v_fmamk_f32 v39, v18, 0x40e00000, v19
    v_cos_f32 v32, v32
    v_cos_f32 v33, v33
    v_cos_f32 v34, v34
    v_cos_f32 v35, v35
    v_cos_f32 v36, v36
    v_cos_f32 v37, v37
    v_cos_f32 v38, v38
    v_cos_f32 v39, v39
    v_add_f32 v20, v20, v20
    v_fmamk_f32 v40, v18, 0x42000000, v19
    v_fmamk_f32 v41, v18, 0x42040000, v19
    v_fmamk_f32 v42, v18, 0x42080000, v19
    v_fmamk_f32 v43, v18, 0x420c0000, v19
    v_fmamk_f32 v44, v18, 0x42100000, v19
    v_fmamk_f32 v45, v18, 0x42140000, v19
    v_fmamk_f32 v46, v18, 0x42180000, v19
    v_fmamk_f32 v47, v18, 0x421c0000, v19
    v_cos_f32 v40, v40
    v_cos_f32 v41, v41
    v_cos_f32 v42, v42
    v_cos_f32 v43, v43
    v_cos_f32 v44, v44
    v_cos_f32 v45, v45
    v_cos_f32 v46, v46
    v_cos_f32 v47, v47
    v_cvt_pk_bf16_f32 v100, v32, v33
    v_cvt_pk_bf16_f32 v101, v34, v35
    v_cvt_pk_bf16_f32 v102, v36, v37
    v_cvt_pk_bf16_f32 v103, v38, v39
    v_cvt_pk_bf16_f32 v104, v40, v41
    v_cvt_pk_bf16_f32 v105, v42, v43
    v_cvt_pk_bf16_f32 v106, v44, v45
    v_cvt_pk_bf16_f32 v107, v46, v47
    v_pk_fma_f32 v[32:33], v[20:21], v[40:41], v[32:33] op_sel_hi:[0,1,1] neg_lo:[0,0,1] neg_hi:[0,0,1]
    v_pk_fma_f32 v[34:35], v[20:21], v[42:43], v[34:35] op_sel_hi:[0,1,1] neg_lo:[0,0,1] neg_hi:[0,0,1]
    v_pk_fma_f32 v[36:37], v[20:21], v[44:45], v[36:37] op_sel_hi:[0,1,1] neg_lo:[0,0,1] neg_hi:[0,0,1]
    v_pk_fma_f32 v[38:39], v[20:21], v[46:47], v[38:39] op_sel_hi:[0,1,1] neg_lo:[0,0,1] neg_hi:[0,0,1]
    v_cvt_pk_bf16_f32 v108, v32, v33
    v_cvt_pk_bf16_f32 v109, v34, v35
    v_cvt_pk_bf16_f32 v110, v36, v37
    v_cvt_pk_bf16_f32 v111, v38, v39
    v_pk_fma_f32 v[40:41], v[20:21], v[32:33], v[40:41] op_sel_hi:[0,1,1] neg_lo:[0,0,1] neg_hi:[0,0,1]
    v_pk_fma_f32 v[42:43], v[20:21], v[34:35], v[42:43] op_sel_hi:[0,1,1] neg_lo:[0,0,1] neg_hi:[0,0,1]
    v_pk_fma_f32 v[44:45], v[20:21], v[36:37], v[44:45] op_sel_hi:[0,1,1] neg_lo:[0,0,1] neg_hi:[0,0,1]
    v_pk_fma_f32 v[46:47], v[20:21], v[38:39], v[46:47] op_sel_hi:[0,1,1] neg_lo:[0,0,1] neg_hi:[0,0,1]
    v_cvt_pk_bf16_f32 v112, v40, v41
    v_cvt_pk_bf16_f32 v113, v42, v43
    v_cvt_pk_bf16_f32 v114, v44, v45
    v_cvt_pk_bf16_f32 v115, v46, v47
    v_pk_fma_f32 v[32:33], v[20:21], v[40:41], v[32:33] op_sel_hi:[0,1,1] neg_lo:[0,0,1] neg_hi:[0,0,1]
    v_pk_fma_f32 v[34:35], v[20:21], v[42:43], v[34:35] op_sel_hi:[0,1,1] neg_lo:[0,0,1] neg_hi:[0,0,1]
    v_pk_fma_f32 v[36:37], v[20:21], v[44:45], v[36:37] op_sel_hi:[0,1,1] neg_lo:[0,0,1] neg_hi:[0,0,1]
    v_pk_fma_f32 v[38:39], v[20:21], v[46:47], v[38:39] op_sel_hi:[0,1,1] neg_lo:[0,0,1] neg_hi:[0,0,1]
    v_cvt_pk_bf16_f32 v116, v32, v33
    v_cvt_pk_bf16_f32 v117, v34, v35
    v_cvt_pk_bf16_f32 v118, v36, v37
    v_cvt_pk_bf16_f32 v119, v38, v39
    v_pk_fma_f32 v[40:41], v[20:21], v[32:33], v[40:41] op_sel_hi:[0,1,1] neg_lo:[0,0,1] neg_hi:[0,0,1]
    v_pk_fma_f32 v[42:43], v[20:21], v[34:35], v[42:43] op_sel_hi:[0,1,1] neg_lo:[0,0,1] neg_hi:[0,0,1]
    v_pk_fma_f32 v[44:45], v[20:21], v[36:37], v[44:45] op_sel_hi:[0,1,1] neg_lo:[0,0,1] neg_hi:[0,0,1]
    v_pk_fma_f32 v[46:47], v[20:21], v[38:39], v[46:47] op_sel_hi:[0,1,1] neg_lo:[0,0,1] neg_hi:[0,0,1]
    v_cvt_pk_bf16_f32 v120, v40, v41
    v_cvt_pk_bf16_f32 v121, v42, v43
    v_cvt_pk_bf16_f32 v122, v44, v45
    v_cvt_pk_bf16_f32 v123, v46, v47
    v_pk_fma_f32 v[32:33], v[20:21], v[40:41], v[32:33] op_sel_hi:[0,1,1] neg_lo:[0,0,1] neg_hi:[0,0,1]
    v_pk_fma_f32 v[34:35], v[20:21], v[42:43], v[34:35] op_sel_hi:[0,1,1] neg_lo:[0,0,1] neg_hi:[0,0,1]
    v_pk_fma_f32 v[36:37], v[20:21], v[44:45], v[36:37] op_sel_hi:[0,1,1] neg_lo:[0,0,1] neg_hi:[0,0,1]
    v_pk_fma_f32 v[38:39], v[20:21], v[46:47], v[38:39] op_sel_hi:[0,1,1] neg_lo:[0,0,1] neg_hi:[0,0,1]
    v_cvt_pk_bf16_f32 v124, v32, v33
    v_cvt_pk_bf16_f32 v125, v34, v35
    v_cvt_pk_bf16_f32 v126, v36, v37
    v_cvt_pk_bf16_f32 v127, v38, v39
    v_pk_fma_f32 v[40:41], v[20:21], v[32:33], v[40:41] op_sel_hi:[0,1,1] neg_lo:[0,0,1] neg_hi:[0,0,1]
    v_pk_fma_f32 v[42:43], v[20:21], v[34:35], v[42:43] op_sel_hi:[0,1,1] neg_lo:[0,0,1] neg_hi:[0,0,1]
    v_pk_fma_f32 v[44:45], v[20:21], v[36:37], v[44:45] op_sel_hi:[0,1,1] neg_lo:[0,0,1] neg_hi:[0,0,1]
    v_pk_fma_f32 v[46:47], v[20:21], v[38:39], v[46:47] op_sel_hi:[0,1,1] neg_lo:[0,0,1] neg_hi:[0,0,1]
    v_cvt_pk_bf16_f32 v128, v40, v41
    v_cvt_pk_bf16_f32 v129, v42, v43
    v_cvt_pk_bf16_f32 v130, v44, v45
    v_cvt_pk_bf16_f32 v131, v46, v47
    v_pk_fma_f32 v[32:33], v[20:21], v[40:41], v[32:33] op_sel_hi:[0,1,1] neg_lo:[0,0,1] neg_hi:[0,0,1]
    v_pk_fma_f32 v[34:35], v[20:21], v[42:43], v[34:35] op_sel_hi:[0,1,1] neg_lo:[0,0,1] neg_hi:[0,0,1]
    v_pk_fma_f32 v[36:37], v[20:21], v[44:45], v[36:37] op_sel_hi:[0,1,1] neg_lo:[0,0,1] neg_hi:[0,0,1]
    v_pk_fma_f32 v[38:39], v[20:21], v[46:47], v[38:39] op_sel_hi:[0,1,1] neg_lo:[0,0,1] neg_hi:[0,0,1]
    v_cvt_pk_bf16_f32 v132, v32, v33
    v_cvt_pk_bf16_f32 v133, v34, v35
    v_cvt_pk_bf16_f32 v134, v36, v37
    v_cvt_pk_bf16_f32 v135, v38, v39
    v_add_u32 v18, 16, v8
    v_cvt_f32_u32 v18, v18
    v_mul_f32 v18, 0x3ae38e39, v18
    v_fma_f32 v19, v18, v11, v10
    v_mul_f32 v20, 0x42000000, v18
    v_cos_f32 v20, v20
    v_mov_b32 v32, v19
    v_fmamk_f32 v33, v18, 0x3f800000, v19
    v_fmamk_f32 v34, v18, 0x40000000, v19
    v_fmamk_f32 v35, v18, 0x40400000, v19
    v_fmamk_f32 v36, v18, 0x40800000, v19
    v_fmamk_f32 v37, v18, 0x40a00000, v19
    v_fmamk_f32 v38, v18, 0x40c00000, v19
    v_fmamk_f32 v39, v18, 0x40e00000, v19
    v_cos_f32 v32, v32
    v_cos_f32 v33, v33
    v_cos_f32 v34, v34
    v_cos_f32 v35, v35
    v_cos_f32 v36, v36
    v_cos_f32 v37, v37
    v_cos_f32 v38, v38
    v_cos_f32 v39, v39
    v_add_f32 v20, v20, v20
    v_fmamk_f32 v40, v18, 0x42000000, v19
    v_fmamk_f32 v41, v18, 0x42040000, v19
    v_fmamk_f32 v42, v18, 0x42080000, v19
    v_fmamk_f32 v43, v18, 0x420c0000, v19
    v_fmamk_f32 v44, v18, 0x42100000, v19
    v_fmamk_f32 v45, v18, 0x42140000, v19
    v_fmamk_f32 v46, v18, 0x42180000, v19
    v_fmamk_f32 v47, v18, 0x421c0000, v19
    v_cos_f32 v40, v40
    v_cos_f32 v41, v41
    v_cos_f32 v42, v42
    v_cos_f32 v43, v43
    v_cos_f32 v44, v44
    v_cos_f32 v45, v45
    v_cos_f32 v46, v46
    v_cos_f32 v47, v47
    v_cvt_pk_bf16_f32 v136, v32, v33
    v_cvt_pk_bf16_f32 v137, v34, v35
    v_cvt_pk_bf16_f32 v138, v36, v37
    v_cvt_pk_bf16_f32 v139, v38, v39
    v_cvt_pk_bf16_f32 v140, v40, v41
    v_cvt_pk_bf16_f32 v141, v42, v43
    v_cvt_pk_bf16_f32 v142, v44, v45
    v_cvt_pk_bf16_f32 v143, v46, v47
    v_pk_fma_f32 v[32:33], v[20:21], v[40:41], v[32:33] op_sel_hi:[0,1,1] neg_lo:[0,0,1] neg_hi:[0,0,1]
    v_pk_fma_f32 v[34:35], v[20:21], v[42:43], v[34:35] op_sel_hi:[0,1,1] neg_lo:[0,0,1] neg_hi:[0,0,1]
    v_pk_fma_f32 v[36:37], v[20:21], v[44:45], v[36:37] op_sel_hi:[0,1,1] neg_lo:[0,0,1] neg_hi:[0,0,1]
    v_pk_fma_f32 v[38:39], v[20:21], v[46:47], v[38:39] op_sel_hi:[0,1,1] neg_lo:[0,0,1] neg_hi:[0,0,1]
    v_cvt_pk_bf16_f32 v144, v32, v33
    v_cvt_pk_bf16_f32 v145, v34, v35
    v_cvt_pk_bf16_f32 v146, v36, v37
    v_cvt_pk_bf16_f32 v147, v38, v39
    v_pk_fma_f32 v[40:41], v[20:21], v[32:33], v[40:41] op_sel_hi:[0,1,1] neg_lo:[0,0,1] neg_hi:[0,0,1]
    v_pk_fma_f32 v[42:43], v[20:21], v[34:35], v[42:43] op_sel_hi:[0,1,1] neg_lo:[0,0,1] neg_hi:[0,0,1]
    v_pk_fma_f32 v[44:45], v[20:21], v[36:37], v[44:45] op_sel_hi:[0,1,1] neg_lo:[0,0,1] neg_hi:[0,0,1]
    v_pk_fma_f32 v[46:47], v[20:21], v[38:39], v[46:47] op_sel_hi:[0,1,1] neg_lo:[0,0,1] neg_hi:[0,0,1]
    v_cvt_pk_bf16_f32 v148, v40, v41
    v_cvt_pk_bf16_f32 v149, v42, v43
    v_cvt_pk_bf16_f32 v150, v44, v45
    v_cvt_pk_bf16_f32 v151, v46, v47
    v_pk_fma_f32 v[32:33], v[20:21], v[40:41], v[32:33] op_sel_hi:[0,1,1] neg_lo:[0,0,1] neg_hi:[0,0,1]
    v_pk_fma_f32 v[34:35], v[20:21], v[42:43], v[34:35] op_sel_hi:[0,1,1] neg_lo:[0,0,1] neg_hi:[0,0,1]
    v_pk_fma_f32 v[36:37], v[20:21], v[44:45], v[36:37] op_sel_hi:[0,1,1] neg_lo:[0,0,1] neg_hi:[0,0,1]
    v_pk_fma_f32 v[38:39], v[20:21], v[46:47], v[38:39] op_sel_hi:[0,1,1] neg_lo:[0,0,1] neg_hi:[0,0,1]
    v_cvt_pk_bf16_f32 v152, v32, v33
    v_cvt_pk_bf16_f32 v153, v34, v35
    v_cvt_pk_bf16_f32 v154, v36, v37
    v_cvt_pk_bf16_f32 v155, v38, v39
    v_pk_fma_f32 v[40:41], v[20:21], v[32:33], v[40:41] op_sel_hi:[0,1,1] neg_lo:[0,0,1] neg_hi:[0,0,1]
    v_pk_fma_f32 v[42:43], v[20:21], v[34:35], v[42:43] op_sel_hi:[0,1,1] neg_lo:[0,0,1] neg_hi:[0,0,1]
    v_pk_fma_f32 v[44:45], v[20:21], v[36:37], v[44:45] op_sel_hi:[0,1,1] neg_lo:[0,0,1] neg_hi:[0,0,1]
    v_pk_fma_f32 v[46:47], v[20:21], v[38:39], v[46:47] op_sel_hi:[0,1,1] neg_lo:[0,0,1] neg_hi:[0,0,1]
    v_cvt_pk_bf16_f32 v156, v40, v41
    v_cvt_pk_bf16_f32 v157, v42, v43
    v_cvt_pk_bf16_f32 v158, v44, v45
    v_cvt_pk_bf16_f32 v159, v46, v47
    v_pk_fma_f32 v[32:33], v[20:21], v[40:41], v[32:33] op_sel_hi:[0,1,1] neg_lo:[0,0,1] neg_hi:[0,0,1]
    v_pk_fma_f32 v[34:35], v[20:21], v[42:43], v[34:35] op_sel_hi:[0,1,1] neg_lo:[0,0,1] neg_hi:[0,0,1]
    v_pk_fma_f32 v[36:37], v[20:21], v[44:45], v[36:37] op_sel_hi:[0,1,1] neg_lo:[0,0,1] neg_hi:[0,0,1]
    v_pk_fma_f32 v[38:39], v[20:21], v[46:47], v[38:39] op_sel_hi:[0,1,1] neg_lo:[0,0,1] neg_hi:[0,0,1]
    v_cvt_pk_bf16_f32 v160, v32, v33
    v_cvt_pk_bf16_f32 v161, v34, v35
    v_cvt_pk_bf16_f32 v162, v36, v37
    v_cvt_pk_bf16_f32 v163, v38, v39
    v_pk_fma_f32 v[40:41], v[20:21], v[32:33], v[40:41] op_sel_hi:[0,1,1] neg_lo:[0,0,1] neg_hi:[0,0,1]
    v_pk_fma_f32 v[42:43], v[20:21], v[34:35], v[42:43] op_sel_hi:[0,1,1] neg_lo:[0,0,1] neg_hi:[0,0,1]
    v_pk_fma_f32 v[44:45], v[20:21], v[36:37], v[44:45] op_sel_hi:[0,1,1] neg_lo:[0,0,1] neg_hi:[0,0,1]
    v_pk_fma_f32 v[46:47], v[20:21], v[38:39], v[46:47] op_sel_hi:[0,1,1] neg_lo:[0,0,1] neg_hi:[0,0,1]
    v_cvt_pk_bf16_f32 v164, v40, v41
    v_cvt_pk_bf16_f32 v165, v42, v43
    v_cvt_pk_bf16_f32 v166, v44, v45
    v_cvt_pk_bf16_f32 v167, v46, v47
    v_pk_fma_f32 v[32:33], v[20:21], v[40:41], v[32:33] op_sel_hi:[0,1,1] neg_lo:[0,0,1] neg_hi:[0,0,1]
    v_pk_fma_f32 v[34:35], v[20:21], v[42:43], v[34:35] op_sel_hi:[0,1,1] neg_lo:[0,0,1] neg_hi:[0,0,1]
    v_pk_fma_f32 v[36:37], v[20:21], v[44:45], v[36:37] op_sel_hi:[0,1,1] neg_lo:[0,0,1] neg_hi:[0,0,1]
    v_pk_fma_f32 v[38:39], v[20:21], v[46:47], v[38:39] op_sel_hi:[0,1,1] neg_lo:[0,0,1] neg_hi:[0,0,1]
    v_cvt_pk_bf16_f32 v168, v32, v33
    v_cvt_pk_bf16_f32 v169, v34, v35
    v_cvt_pk_bf16_f32 v170, v36, v37
    v_cvt_pk_bf16_f32 v171, v38, v39
    s_add_u32 s20, s74, 2621440
    s_addc_u32 s21, s75, 0
    s_mov_b32 s22, 2359296
    s_mov_b32 s23, 0x20000
    s_waitcnt lgkmcnt(0)
    s_mul_i32 s96, s96, 0x41c64e6d
    s_mul_i32 s97, s97, 0x2c9277b5
    s_add_u32 s96, s96, 0x3c6ef35f
    s_add_u32 s97, s97, 0x1b873593
    s_barrier
    ds_read_b128 v[220:223], v6 offset:0
    ds_read_b128 v[224:227], v6 offset:18432
    ds_read_b128 v[228:231], v7 offset:0
    ds_read_b128 v[232:235], v7 offset:18432
    ds_read_b128 v[236:239], v6 offset:1024
    ds_read_b128 v[240:243], v6 offset:19456
    ds_read_b128 v[244:247], v7 offset:1024
    ds_read_b128 v[248:251], v7 offset:19456
    s_waitcnt lgkmcnt(6)
    v_mfma_f32_16x16x32_bf16 v[172:175], v[220:223], v[64:67], 0
    v_mfma_f32_16x16x32_bf16 v[180:183], v[224:227], v[64:67], 0
    v_mfma_f32_16x16x32_bf16 v[188:191], v[220:223], v[100:103], 0
    v_mfma_f32_16x16x32_bf16 v[196:199], v[224:227], v[100:103], 0
    v_mfma_f32_16x16x32_bf16 v[204:207], v[220:223], v[136:139], 0
    v_mfma_f32_16x16x32_bf16 v[212:215], v[224:227], v[136:139], 0
    ds_read_b128 v[220:223], v6 offset:2048
    ds_read_b128 v[224:227], v6 offset:20480
    s_waitcnt lgkmcnt(6)
    v_mfma_f32_16x16x32_bf16 v[172:175], v[228:231], v[68:71], v[172:175]
    v_mfma_f32_16x16x32_bf16 v[180:183], v[232:235], v[68:71], v[180:183]
    v_mfma_f32_16x16x32_bf16 v[188:191], v[228:231], v[104:107], v[188:191]
    v_mfma_f32_16x16x32_bf16 v[196:199], v[232:235], v[104:107], v[196:199]
    v_mfma_f32_16x16x32_bf16 v[204:207], v[228:231], v[140:143], v[204:207]
    v_mfma_f32_16x16x32_bf16 v[212:215], v[232:235], v[140:143], v[212:215]
    ds_read_b128 v[228:231], v7 offset:2048
    ds_read_b128 v[232:235], v7 offset:20480
    s_waitcnt lgkmcnt(6)
    v_mfma_f32_16x16x32_bf16 v[172:175], v[236:239], v[72:75], v[172:175]
    v_mfma_f32_16x16x32_bf16 v[180:183], v[240:243], v[72:75], v[180:183]
    v_mfma_f32_16x16x32_bf16 v[188:191], v[236:239], v[108:111], v[188:191]
    v_mfma_f32_16x16x32_bf16 v[196:199], v[240:243], v[108:111], v[196:199]
    v_mfma_f32_16x16x32_bf16 v[204:207], v[236:239], v[144:147], v[204:207]
    v_mfma_f32_16x16x32_bf16 v[212:215], v[240:243], v[144:147], v[212:215]
    ds_read_b128 v[236:239], v6 offset:3072
    ds_read_b128 v[240:243], v6 offset:21504
    s_waitcnt lgkmcnt(6)
    v_mfma_f32_16x16x32_bf16 v[172:175], v[244:247], v[76:79], v[172:175]
    v_mfma_f32_16x16x32_bf16 v[180:183], v[248:251], v[76:79], v[180:183]
    v_mfma_f32_16x16x32_bf16 v[188:191], v[244:247], v[112:115], v[188:191]
    v_mfma_f32_16x16x32_bf16 v[196:199], v[248:251], v[112:115], v[196:199]
    v_mfma_f32_16x16x32_bf16 v[204:207], v[244:247], v[148:151], v[204:207]
    v_mfma_f32_16x16x32_bf16 v[212:215], v[248:251], v[148:151], v[212:215]
    ds_read_b128 v[244:247], v7 offset:3072
    ds_read_b128 v[248:251], v7 offset:21504
    s_waitcnt lgkmcnt(6)
    v_mfma_f32_16x16x32_bf16 v[172:175], v[220:223], v[80:83], v[172:175]
    v_mfma_f32_16x16x32_bf16 v[180:183], v[224:227], v[80:83], v[180:183]
    v_mfma_f32_16x16x32_bf16 v[188:191], v[220:223], v[116:119], v[188:191]
    v_mfma_f32_16x16x32_bf16 v[196:199], v[224:227], v[116:119], v[196:199]
    v_mfma_f32_16x16x32_bf16 v[204:207], v[220:223], v[152:155], v[204:207]
    v_mfma_f32_16x16x32_bf16 v[212:215], v[224:227], v[152:155], v[212:215]
    ds_read_b128 v[220:223], v6 offset:4096
    ds_read_b128 v[224:227], v6 offset:22528
    s_waitcnt lgkmcnt(6)
    v_mfma_f32_16x16x32_bf16 v[172:175], v[228:231], v[84:87], v[172:175]
    v_mfma_f32_16x16x32_bf16 v[180:183], v[232:235], v[84:87], v[180:183]
    v_mfma_f32_16x16x32_bf16 v[188:191], v[228:231], v[120:123], v[188:191]
    v_mfma_f32_16x16x32_bf16 v[196:199], v[232:235], v[120:123], v[196:199]
    v_mfma_f32_16x16x32_bf16 v[204:207], v[228:231], v[156:159], v[204:207]
    v_mfma_f32_16x16x32_bf16 v[212:215], v[232:235], v[156:159], v[212:215]
    ds_read_b128 v[228:231], v7 offset:4096
    ds_read_b128 v[232:235], v7 offset:22528
    s_waitcnt lgkmcnt(6)
    v_mfma_f32_16x16x32_bf16 v[172:175], v[236:239], v[88:91], v[172:175]
    v_mfma_f32_16x16x32_bf16 v[180:183], v[240:243], v[88:91], v[180:183]
    v_mfma_f32_16x16x32_bf16 v[188:191], v[236:239], v[124:127], v[188:191]
    v_mfma_f32_16x16x32_bf16 v[196:199], v[240:243], v[124:127], v[196:199]
    v_mfma_f32_16x16x32_bf16 v[204:207], v[236:239], v[160:163], v[204:207]
    v_mfma_f32_16x16x32_bf16 v[212:215], v[240:243], v[160:163], v[212:215]
    ds_read_b128 v[236:239], v6 offset:5120
    ds_read_b128 v[240:243], v6 offset:23552
    s_waitcnt lgkmcnt(6)
    v_mfma_f32_16x16x32_bf16 v[172:175], v[244:247], v[92:95], v[172:175]
    v_mfma_f32_16x16x32_bf16 v[180:183], v[248:251], v[92:95], v[180:183]
    v_mfma_f32_16x16x32_bf16 v[188:191], v[244:247], v[128:131], v[188:191]
    v_mfma_f32_16x16x32_bf16 v[196:199], v[248:251], v[128:131], v[196:199]
    v_mfma_f32_16x16x32_bf16 v[204:207], v[244:247], v[164:167], v[204:207]
    v_mfma_f32_16x16x32_bf16 v[212:215], v[248:251], v[164:167], v[212:215]
    ds_read_b128 v[244:247], v7 offset:5120
    ds_read_b128 v[248:251], v7 offset:23552
    s_waitcnt lgkmcnt(6)
    v_mfma_f32_16x16x32_bf16 v[172:175], v[220:223], v[96:99], v[172:175]
    v_mfma_f32_16x16x32_bf16 v[180:183], v[224:227], v[96:99], v[180:183]
    v_mfma_f32_16x16x32_bf16 v[188:191], v[220:223], v[132:135], v[188:191]
    v_mfma_f32_16x16x32_bf16 v[196:199], v[224:227], v[132:135], v[196:199]
    v_mfma_f32_16x16x32_bf16 v[204:207], v[220:223], v[168:171], v[204:207]
    v_mfma_f32_16x16x32_bf16 v[212:215], v[224:227], v[168:171], v[212:215]
    ds_read_b128 v[220:223], v6 offset:6144
    ds_read_b128 v[224:227], v6 offset:24576
    s_waitcnt lgkmcnt(6)
    v_mfma_f32_16x16x32_bf16 v[176:179], v[228:231], v[64:67], 0
    v_mfma_f32_16x16x32_bf16 v[184:187], v[232:235], v[64:67], 0
    v_mfma_f32_16x16x32_bf16 v[192:195], v[228:231], v[100:103], 0
    v_mfma_f32_16x16x32_bf16 v[200:203], v[232:235], v[100:103], 0
    v_mfma_f32_16x16x32_bf16 v[208:211], v[228:231], v[136:139], 0
    v_mfma_f32_16x16x32_bf16 v[216:219], v[232:235], v[136:139], 0
    ds_read_b128 v[228:231], v7 offset:6144
    ds_read_b128 v[232:235], v7 offset:24576
    s_waitcnt lgkmcnt(6)
    v_mfma_f32_16x16x32_bf16 v[176:179], v[236:239], v[68:71], v[176:179]
    v_mfma_f32_16x16x32_bf16 v[184:187], v[240:243], v[68:71], v[184:187]
    v_mfma_f32_16x16x32_bf16 v[192:195], v[236:239], v[104:107], v[192:195]
    v_mfma_f32_16x16x32_bf16 v[200:203], v[240:243], v[104:107], v[200:203]
    v_mfma_f32_16x16x32_bf16 v[208:211], v[236:239], v[140:143], v[208:211]
    v_mfma_f32_16x16x32_bf16 v[216:219], v[240:243], v[140:143], v[216:219]
    ds_read_b128 v[236:239], v6 offset:7168
    ds_read_b128 v[240:243], v6 offset:25600
    s_waitcnt lgkmcnt(6)
    v_mfma_f32_16x16x32_bf16 v[176:179], v[244:247], v[72:75], v[176:179]
    v_mfma_f32_16x16x32_bf16 v[184:187], v[248:251], v[72:75], v[184:187]
    v_mfma_f32_16x16x32_bf16 v[192:195], v[244:247], v[108:111], v[192:195]
    v_mfma_f32_16x16x32_bf16 v[200:203], v[248:251], v[108:111], v[200:203]
    v_mfma_f32_16x16x32_bf16 v[208:211], v[244:247], v[144:147], v[208:211]
    v_mfma_f32_16x16x32_bf16 v[216:219], v[248:251], v[144:147], v[216:219]
    ds_read_b128 v[244:247], v7 offset:7168
    ds_read_b128 v[248:251], v7 offset:25600
    s_waitcnt lgkmcnt(6)
    v_mfma_f32_16x16x32_bf16 v[176:179], v[220:223], v[76:79], v[176:179]
    v_mfma_f32_16x16x32_bf16 v[184:187], v[224:227], v[76:79], v[184:187]
    v_mfma_f32_16x16x32_bf16 v[192:195], v[220:223], v[112:115], v[192:195]
    v_mfma_f32_16x16x32_bf16 v[200:203], v[224:227], v[112:115], v[200:203]
    v_mfma_f32_16x16x32_bf16 v[208:211], v[220:223], v[148:151], v[208:211]
    v_mfma_f32_16x16x32_bf16 v[216:219], v[224:227], v[148:151], v[216:219]
    ds_read_b128 v[220:223], v6 offset:8192
    ds_read_b128 v[224:227], v6 offset:26624
    s_waitcnt lgkmcnt(6)
    v_mfma_f32_16x16x32_bf16 v[176:179], v[228:231], v[80:83], v[176:179]
    v_mfma_f32_16x16x32_bf16 v[184:187], v[232:235], v[80:83], v[184:187]
    v_mfma_f32_16x16x32_bf16 v[192:195], v[228:231], v[116:119], v[192:195]
    v_mfma_f32_16x16x32_bf16 v[200:203], v[232:235], v[116:119], v[200:203]
    v_mfma_f32_16x16x32_bf16 v[208:211], v[228:231], v[152:155], v[208:211]
    v_mfma_f32_16x16x32_bf16 v[216:219], v[232:235], v[152:155], v[216:219]
    ds_read_b128 v[228:231], v7 offset:8192
    ds_read_b128 v[232:235], v7 offset:26624
    s_waitcnt lgkmcnt(6)
    v_mfma_f32_16x16x32_bf16 v[176:179], v[236:239], v[84:87], v[176:179]
    v_mfma_f32_16x16x32_bf16 v[184:187], v[240:243], v[84:87], v[184:187]
    v_mfma_f32_16x16x32_bf16 v[192:195], v[236:239], v[120:123], v[192:195]
    v_mfma_f32_16x16x32_bf16 v[200:203], v[240:243], v[120:123], v[200:203]
    v_mfma_f32_16x16x32_bf16 v[208:211], v[236:239], v[156:159], v[208:211]
    v_mfma_f32_16x16x32_bf16 v[216:219], v[240:243], v[156:159], v[216:219]
    s_waitcnt lgkmcnt(4)
    v_mfma_f32_16x16x32_bf16 v[176:179], v[244:247], v[88:91], v[176:179]
    v_mfma_f32_16x16x32_bf16 v[184:187], v[248:251], v[88:91], v[184:187]
    v_mfma_f32_16x16x32_bf16 v[192:195], v[244:247], v[124:127], v[192:195]
    v_mfma_f32_16x16x32_bf16 v[200:203], v[248:251], v[124:127], v[200:203]
    v_mfma_f32_16x16x32_bf16 v[208:211], v[244:247], v[160:163], v[208:211]
    v_mfma_f32_16x16x32_bf16 v[216:219], v[248:251], v[160:163], v[216:219]
    s_waitcnt lgkmcnt(2)
    v_mfma_f32_16x16x32_bf16 v[176:179], v[220:223], v[92:95], v[176:179]
    v_mfma_f32_16x16x32_bf16 v[184:187], v[224:227], v[92:95], v[184:187]
    v_mfma_f32_16x16x32_bf16 v[192:195], v[220:223], v[128:131], v[192:195]
    v_mfma_f32_16x16x32_bf16 v[200:203], v[224:227], v[128:131], v[200:203]
    v_mfma_f32_16x16x32_bf16 v[208:211], v[220:223], v[164:167], v[208:211]
    v_mfma_f32_16x16x32_bf16 v[216:219], v[224:227], v[164:167], v[216:219]
    s_waitcnt lgkmcnt(0)
    v_mfma_f32_16x16x32_bf16 v[176:179], v[228:231], v[96:99], v[176:179]
    v_mfma_f32_16x16x32_bf16 v[184:187], v[232:235], v[96:99], v[184:187]
    v_mfma_f32_16x16x32_bf16 v[192:195], v[228:231], v[132:135], v[192:195]
    v_mfma_f32_16x16x32_bf16 v[200:203], v[232:235], v[132:135], v[200:203]
    v_mfma_f32_16x16x32_bf16 v[208:211], v[228:231], v[168:171], v[208:211]
    v_mfma_f32_16x16x32_bf16 v[216:219], v[232:235], v[168:171], v[216:219]
    s_nop 2
    v_fma_f32 v172, v176, v17, v172
    v_fma_f32 v173, v177, v17, v173
    v_fma_f32 v174, v178, v17, v174
    v_fma_f32 v175, v179, v17, v175
    v_fma_f32 v180, v184, v17, v180
    v_fma_f32 v181, v185, v17, v181
    v_fma_f32 v182, v186, v17, v182
    v_fma_f32 v183, v187, v17, v183
    v_cvt_pk_bf16_f32 v140, v172, v173
    v_cvt_pk_bf16_f32 v141, v174, v175
    v_cvt_pk_bf16_f32 v142, v180, v181
    v_cvt_pk_bf16_f32 v143, v182, v183
    buffer_store_dwordx4 v[140:143], v16, s[20:23], s34 offen sc1
    s_add_u32 s34, s34, 65536
    v_fma_f32 v188, v192, v17, v188
    v_fma_f32 v189, v193, v17, v189
    v_fma_f32 v190, v194, v17, v190
    v_fma_f32 v191, v195, v17, v191
    v_fma_f32 v196, v200, v17, v196
    v_fma_f32 v197, v201, v17, v197
    v_fma_f32 v198, v202, v17, v198
    v_fma_f32 v199, v203, v17, v199
    v_cvt_pk_bf16_f32 v144, v188, v189
    v_cvt_pk_bf16_f32 v145, v190, v191
    v_cvt_pk_bf16_f32 v146, v196, v197
    v_cvt_pk_bf16_f32 v147, v198, v199
    buffer_store_dwordx4 v[144:147], v16, s[20:23], s34 offen sc1
    s_add_u32 s34, s34, 65536
    v_fma_f32 v204, v208, v17, v204
    v_fma_f32 v205, v209, v17, v205
    v_fma_f32 v206, v210, v17, v206
    v_fma_f32 v207, v211, v17, v207
    v_fma_f32 v212, v216, v17, v212
    v_fma_f32 v213, v217, v17, v213
    v_fma_f32 v214, v218, v17, v214
    v_fma_f32 v215, v219, v17, v215
    v_cvt_pk_bf16_f32 v148, v204, v205
    v_cvt_pk_bf16_f32 v149, v206, v207
    v_cvt_pk_bf16_f32 v150, v212, v213
    v_cvt_pk_bf16_f32 v151, v214, v215
    buffer_store_dwordx4 v[148:151], v16, s[20:23], s34 offen sc1
.p1c_4:
    s_cmp_lt_u32 s2, 40
    s_cbranch_scc1 .fft_5
    s_and_b32 s3, s2, 7
    s_mul_i32 s3, s3, 27
    s_lshr_b32 s33, s2, 3
    s_add_u32 s33, s33, s3
    s_sub_u32 s33, s33, 5
    s_mul_i32 s34, s33, 171
    s_lshr_b32 s34, s34, 10
    s_mul_i32 s3, s34, 6
    s_sub_u32 s33, s33, s3
    s_and_b32 s36, s30, 1
    s_lshr_b32 s37, s30, 1
    v_and_b32 v5, 15, v0
    v_lshrrev_b32 v4, 4, v0
    s_lshl_b32 s3, s33, 1
    s_add_u32 s38, s3, s36
    s_mul_i32 s39, s38, 196608
    s_mul_i32 s3, s37, 98304
    s_add_u32 s48, s39, s3
    s_add_u32 s49, s48, 24576
    v_lshlrev_b32 v1, 4, v0
    v_lshrrev_b32 v6, 2, v5
    v_lshl_add_u32 v6, v4, 2, v6
    v_and_b32 v7, 7, v6
    s_lshl_b32 s3, s37, 2
    s_xor_b32 s3, s3, 4
    v_xor_b32 v7, s3, v7
    v_lshlrev_b32 v6, 8, v6
    v_lshl_add_u32 v6, v7, 5, v6
    v_and_b32 v7, 3, v5
    v_lshl_add_u32 v6, v7, 3, v6
    s_mul_i32 s3, s37, 98304
    v_add_u32 v16, s3, v6
    s_mul_i32 s39, s33, 5
    s_lshr_b32 s39, 239113312, s39
    s_mul_i32 s3, s34, 0
    s_add_u32 s39, s39, s3
    s_and_b32 s39, s39, 7
    s_mul_i32 s39, s39, 3072
    s_add_u32 s39, s39, s48
    v_xor_b32 v17, 32, v16
    v_xor_b32 v18, 64, v16
    v_xor_b32 v19, 96, v16
    v_xor_b32 v20, 128, v16
    v_xor_b32 v21, 160, v16
    v_xor_b32 v22, 192, v16
    v_xor_b32 v23, 224, v16
    v_mov_b64 v[32:33], 0
    v_mov_b64 v[34:35], 0
    v_mov_b64 v[36:37], 0
    v_mov_b64 v[38:39], 0
    v_mov_b64 v[40:41], 0
    v_mov_b64 v[42:43], 0
    v_mov_b64 v[44:45], 0
    v_mov_b64 v[46:47], 0
    v_mov_b64 v[48:49], 0
    v_mov_b64 v[50:51], 0
    v_mov_b64 v[52:53], 0
    v_mov_b64 v[54:55], 0
    v_mov_b64 v[56:57], 0
    v_mov_b64 v[58:59], 0
    v_mov_b64 v[60:61], 0
    v_mov_b64 v[62:63], 0
    v_mov_b64 v[64:65], 0
    v_mov_b64 v[66:67], 0
    v_mov_b64 v[68:69], 0
    v_mov_b64 v[70:71], 0
    v_mov_b64 v[72:73], 0
    v_mov_b64 v[74:75], 0
    v_mov_b64 v[76:77], 0
    v_mov_b64 v[78:79], 0
    v_mov_b64 v[80:81], 0
    v_mov_b64 v[82:83], 0
    v_mov_b64 v[84:85], 0
    v_mov_b64 v[86:87], 0
    v_mov_b64 v[88:89], 0
    v_mov_b64 v[90:91], 0
    v_mov_b64 v[92:93], 0
    v_mov_b64 v[94:95], 0
    v_mov_b64 v[96:97], 0
    v_mov_b64 v[98:99], 0
    v_mov_b64 v[100:101], 0
    v_mov_b64 v[102:103], 0
    v_mov_b64 v[104:105], 0
    v_mov_b64 v[106:107], 0
    v_mov_b64 v[108:109], 0
    v_mov_b64 v[110:111], 0
    v_mov_b64 v[112:113], 0
    v_mov_b64 v[114:115], 0
    v_mov_b64 v[116:117], 0
    v_mov_b64 v[118:119], 0
    v_mov_b64 v[120:121], 0
    v_mov_b64 v[122:123], 0
    v_mov_b64 v[124:125], 0
    v_mov_b64 v[126:127], 0
    s_add_u32 s12, s74, 262144
    s_addc_u32 s13, s75, 0
    s_mov_b32 s14, 2359296
    s_mov_b32 s15, 0x20000
    s_add_u32 s20, s74, 4980736
    s_addc_u32 s21, s75, 0
    s_mov_b32 s22, 5308416
    s_mov_b32 s23, 0x20000
    s_mov_b32 s16, s62
    s_mov_b32 s17, s63
    s_mov_b32 s18, 9216
    s_mov_b32 s19, 0x20000
    s_mov_b32 s41, 3
    s_lshl_b32 s28, s34, 1
    s_add_u32 s28, s28, s37
    s_mul_i32 s47, s38, 72
    s_add_u32 s47, s47, s28
    s_lshl_b32 s47, s47, 7
    s_add_u32 s47, s47, 73728
    s_lshl_b32 s28, s28, 1
    s_lshl_b32 s40, s28, 6
    v_lshlrev_b32 v8, 3, v4
    s_mul_i32 s3, s30, 12288
    v_add_u32 v2, s3, v1
    s_xor_b32 s3, s30, 2
    s_mul_i32 s3, s3, 12288
    v_add_u32 v3, s3, v1
    s_mov_b32 s44, 0xbdd2d3e8
    s_mov_b32 s45, 0xbdd2d3e8
    v_mov_b32 v14, 0xc0135761
    v_mov_b32 v15, 0xc0135761
    s_mul_i32 s42, s38, 442368
    s_mul_i32 s3, s28, 3072
    s_add_u32 s42, s42, s3
    s_mul_i32 s46, s38, 11
    s_lshr_b32 s46, s46, 5
    s_lshl_b32 s46, s46, 1
    s_add_u32 s46, s46, s37
    s_lshl_b32 s46, s46, 12
    s_add_u32 s46, s46, 8192
    v_and_b32 v9, 31, v0
    v_lshlrev_b32 v9, 7, v9
    s_waitcnt vmcnt(0)
    s_mov_b64 exec, 1
    v_mov_b32 v10, s98
    v_mov_b32 v11, 1
    ds_add_rtn_u32 v11, v10, v11
    v_mov_b64 v[12:13], s[96:97]
    s_waitcnt lgkmcnt(0)
    v_readfirstlane_b32 s3, v11
    s_cmp_lg_u32 s3, s99
    s_cbranch_scc1 .nf_27
    buffer_store_dwordx2 v[12:13], off, s[8:11], s51 sc1
.nf_27:
    s_mov_b64 exec, -1
    s_mov_b32 s3, 0x40000
.poll_28:
    buffer_load_dwordx2 v[10:11], v9, s[8:11], s46 offen sc1
    s_sub_u32 s3, s3, 1
    s_cbranch_scc1 .got_29
    s_waitcnt vmcnt(0)
    v_cmp_ne_u64 vcc, s[96:97], v[10:11]
    s_cbranch_vccnz .poll_28
.got_29:
    buffer_load_dwordx4 v[160:163], v1, s[12:15], s39 offen offset:0 sc1
    buffer_load_dwordx4 v[164:167], v1, s[12:15], s39 offen offset:1024 sc1
    buffer_load_dwordx4 v[168:171], v1, s[12:15], s39 offen offset:2048 sc1
    s_add_u32 s39, s39, 3072
    s_cmp_eq_u32 s39, s49
    s_cselect_b32 s39, s48, s39
    buffer_load_dwordx4 v[172:175], v1, s[12:15], s39 offen offset:0 sc1
    buffer_load_dwordx4 v[176:179], v1, s[12:15], s39 offen offset:1024 sc1
    buffer_load_dwordx4 v[180:183], v1, s[12:15], s39 offen offset:2048 sc1
    s_add_u32 s39, s39, 3072
    s_cmp_eq_u32 s39, s49
    s_cselect_b32 s39, s48, s39
    buffer_load_dwordx4 v[184:187], v1, s[12:15], s39 offen offset:0 sc1
    buffer_load_dwordx4 v[188:191], v1, s[12:15], s39 offen offset:1024 sc1
    buffer_load_dwordx4 v[192:195], v1, s[12:15], s39 offen offset:2048 sc1
    s_add_u32 s39, s39, 3072
    s_cmp_eq_u32 s39, s49
    s_cselect_b32 s39, s48, s39
    buffer_load_dwordx4 v[196:199], v1, s[12:15], s39 offen offset:0 sc1
    buffer_load_dwordx4 v[200:203], v1, s[12:15], s39 offen offset:1024 sc1
    buffer_load_dwordx4 v[204:207], v1, s[12:15], s39 offen offset:2048 sc1
    s_add_u32 s39, s39, 3072
    s_cmp_eq_u32 s39, s49
    s_cselect_b32 s39, s48, s39
    s_barrier
    ds_read_b64_tr_b16 v[128:129], v16 offset:0
    ds_read_b64_tr_b16 v[130:131], v16 offset:4096
    ds_read_b64_tr_b16 v[132:133], v17 offset:0
    ds_read_b64_tr_b16 v[134:135], v17 offset:4096
    ds_read_b64_tr_b16 v[136:137], v18 offset:0
    ds_read_b64_tr_b16 v[138:139], v18 offset:4096
    ds_read_b64_tr_b16 v[140:141], v19 offset:0
    ds_read_b64_tr_b16 v[142:143], v19 offset:4096
    ds_read_b64_tr_b16 v[144:145], v20 offset:0
    ds_read_b64_tr_b16 v[146:147], v20 offset:4096
    ds_read_b64_tr_b16 v[148:149], v21 offset:0
    ds_read_b64_tr_b16 v[150:151], v21 offset:4096
    ds_read_b64_tr_b16 v[152:153], v22 offset:0
    ds_read_b64_tr_b16 v[154:155], v22 offset:4096
.g1loop_30:
    s_waitcnt vmcnt(9)
    s_barrier
    s_waitcnt lgkmcnt(12)
    v_mfma_f32_16x16x32_bf16 v[32:35], v[128:131], v[160:163], v[32:35]
    ds_read_b64_tr_b16 v[156:157], v23 offset:0
    v_mfma_f32_16x16x32_bf16 v[36:39], v[128:131], v[164:167], v[36:39]
    ds_read_b64_tr_b16 v[158:159], v23 offset:4096
    v_mfma_f32_16x16x32_bf16 v[40:43], v[128:131], v[168:171], v[40:43]
    s_waitcnt lgkmcnt(12)
    v_mfma_f32_16x16x32_bf16 v[44:47], v[132:135], v[160:163], v[44:47]
    ds_read_b64_tr_b16 v[128:129], v16 offset:8192
    v_mfma_f32_16x16x32_bf16 v[48:51], v[132:135], v[164:167], v[48:51]
    ds_read_b64_tr_b16 v[130:131], v16 offset:12288
    v_mfma_f32_16x16x32_bf16 v[52:55], v[132:135], v[168:171], v[52:55]
    buffer_load_dwordx4 v[208:211], v1, s[12:15], s39 offen offset:0 sc1
    s_waitcnt lgkmcnt(12)
    v_mfma_f32_16x16x32_bf16 v[56:59], v[136:139], v[160:163], v[56:59]
    ds_read_b64_tr_b16 v[132:133], v17 offset:8192
    v_mfma_f32_16x16x32_bf16 v[60:63], v[136:139], v[164:167], v[60:63]
    ds_read_b64_tr_b16 v[134:135], v17 offset:12288
    v_mfma_f32_16x16x32_bf16 v[64:67], v[136:139], v[168:171], v[64:67]
    s_waitcnt lgkmcnt(12)
    v_mfma_f32_16x16x32_bf16 v[68:71], v[140:143], v[160:163], v[68:71]
    ds_read_b64_tr_b16 v[136:137], v18 offset:8192
    v_mfma_f32_16x16x32_bf16 v[72:75], v[140:143], v[164:167], v[72:75]
    ds_read_b64_tr_b16 v[138:139], v18 offset:12288
    v_mfma_f32_16x16x32_bf16 v[76:79], v[140:143], v[168:171], v[76:79]
    buffer_load_dwordx4 v[212:215], v1, s[12:15], s39 offen offset:1024 sc1
    s_waitcnt lgkmcnt(12)
    v_mfma_f32_16x16x32_bf16 v[80:83], v[144:147], v[160:163], v[80:83]
    ds_read_b64_tr_b16 v[140:141], v19 offset:8192
    v_mfma_f32_16x16x32_bf16 v[84:87], v[144:147], v[164:167], v[84:87]
    ds_read_b64_tr_b16 v[142:143], v19 offset:12288
    v_mfma_f32_16x16x32_bf16 v[88:91], v[144:147], v[168:171], v[88:91]
    s_waitcnt lgkmcnt(12)
    v_mfma_f32_16x16x32_bf16 v[92:95], v[148:151], v[160:163], v[92:95]
    ds_read_b64_tr_b16 v[144:145], v20 offset:8192
    v_mfma_f32_16x16x32_bf16 v[96:99], v[148:151], v[164:167], v[96:99]
    ds_read_b64_tr_b16 v[146:147], v20 offset:12288
    v_mfma_f32_16x16x32_bf16 v[100:103], v[148:151], v[168:171], v[100:103]
    buffer_load_dwordx4 v[216:219], v1, s[12:15], s39 offen offset:2048 sc1
    s_waitcnt lgkmcnt(12)
    v_mfma_f32_16x16x32_bf16 v[104:107], v[152:155], v[160:163], v[104:107]
    ds_read_b64_tr_b16 v[148:149], v21 offset:8192
    v_mfma_f32_16x16x32_bf16 v[108:111], v[152:155], v[164:167], v[108:111]
    ds_read_b64_tr_b16 v[150:151], v21 offset:12288
    v_mfma_f32_16x16x32_bf16 v[112:115], v[152:155], v[168:171], v[112:115]
    s_add_u32 s39, s39, 3072
    s_waitcnt lgkmcnt(12)
    v_mfma_f32_16x16x32_bf16 v[116:119], v[156:159], v[160:163], v[116:119]
    ds_read_b64_tr_b16 v[152:153], v22 offset:8192
    v_mfma_f32_16x16x32_bf16 v[120:123], v[156:159], v[164:167], v[120:123]
    ds_read_b64_tr_b16 v[154:155], v22 offset:12288
    v_mfma_f32_16x16x32_bf16 v[124:127], v[156:159], v[168:171], v[124:127]
    s_cmp_eq_u32 s39, s49
    s_cselect_b32 s39, s48, s39
    s_waitcnt vmcnt(9)
    s_barrier
    s_waitcnt lgkmcnt(12)
    v_mfma_f32_16x16x32_bf16 v[32:35], v[128:131], v[172:175], v[32:35]
    ds_read_b64_tr_b16 v[156:157], v23 offset:8192
    v_mfma_f32_16x16x32_bf16 v[36:39], v[128:131], v[176:179], v[36:39]
    ds_read_b64_tr_b16 v[158:159], v23 offset:12288
    v_mfma_f32_16x16x32_bf16 v[40:43], v[128:131], v[180:183], v[40:43]
    s_waitcnt lgkmcnt(12)
    v_mfma_f32_16x16x32_bf16 v[44:47], v[132:135], v[172:175], v[44:47]
    ds_read_b64_tr_b16 v[128:129], v16 offset:16384
    v_mfma_f32_16x16x32_bf16 v[48:51], v[132:135], v[176:179], v[48:51]
    ds_read_b64_tr_b16 v[130:131], v16 offset:20480
    v_mfma_f32_16x16x32_bf16 v[52:55], v[132:135], v[180:183], v[52:55]
    buffer_load_dwordx4 v[220:223], v1, s[12:15], s39 offen offset:0 sc1
    s_waitcnt lgkmcnt(12)
    v_mfma_f32_16x16x32_bf16 v[56:59], v[136:139], v[172:175], v[56:59]
    ds_read_b64_tr_b16 v[132:133], v17 offset:16384
    v_mfma_f32_16x16x32_bf16 v[60:63], v[136:139], v[176:179], v[60:63]
    ds_read_b64_tr_b16 v[134:135], v17 offset:20480
    v_mfma_f32_16x16x32_bf16 v[64:67], v[136:139], v[180:183], v[64:67]
    s_waitcnt lgkmcnt(12)
    v_mfma_f32_16x16x32_bf16 v[68:71], v[140:143], v[172:175], v[68:71]
    ds_read_b64_tr_b16 v[136:137], v18 offset:16384
    v_mfma_f32_16x16x32_bf16 v[72:75], v[140:143], v[176:179], v[72:75]
    ds_read_b64_tr_b16 v[138:139], v18 offset:20480
    v_mfma_f32_16x16x32_bf16 v[76:79], v[140:143], v[180:183], v[76:79]
    buffer_load_dwordx4 v[224:227], v1, s[12:15], s39 offen offset:1024 sc1
    s_waitcnt lgkmcnt(12)
    v_mfma_f32_16x16x32_bf16 v[80:83], v[144:147], v[172:175], v[80:83]
    ds_read_b64_tr_b16 v[140:141], v19 offset:16384
    v_mfma_f32_16x16x32_bf16 v[84:87], v[144:147], v[176:179], v[84:87]
    ds_read_b64_tr_b16 v[142:143], v19 offset:20480
    v_mfma_f32_16x16x32_bf16 v[88:91], v[144:147], v[180:183], v[88:91]
    s_waitcnt lgkmcnt(12)
    v_mfma_f32_16x16x32_bf16 v[92:95], v[148:151], v[172:175], v[92:95]
    ds_read_b64_tr_b16 v[144:145], v20 offset:16384
    v_mfma_f32_16x16x32_bf16 v[96:99], v[148:151], v[176:179], v[96:99]
    ds_read_b64_tr_b16 v[146:147], v20 offset:20480
    v_mfma_f32_16x16x32_bf16 v[100:103], v[148:151], v[180:183], v[100:103]
    buffer_load_dwordx4 v[228:231], v1, s[12:15], s39 offen offset:2048 sc1
    s_waitcnt lgkmcnt(12)
    v_mfma_f32_16x16x32_bf16 v[104:107], v[152:155], v[172:175], v[104:107]
    ds_read_b64_tr_b16 v[148:149], v21 offset:16384
    v_mfma_f32_16x16x32_bf16 v[108:111], v[152:155], v[176:179], v[108:111]
    ds_read_b64_tr_b16 v[150:151], v21 offset:20480
    v_mfma_f32_16x16x32_bf16 v[112:115], v[152:155], v[180:183], v[112:115]
    s_add_u32 s39, s39, 3072
    s_waitcnt lgkmcnt(12)
    v_mfma_f32_16x16x32_bf16 v[116:119], v[156:159], v[172:175], v[116:119]
    ds_read_b64_tr_b16 v[152:153], v22 offset:16384
    v_mfma_f32_16x16x32_bf16 v[120:123], v[156:159], v[176:179], v[120:123]
    ds_read_b64_tr_b16 v[154:155], v22 offset:20480
    v_mfma_f32_16x16x32_bf16 v[124:127], v[156:159], v[180:183], v[124:127]
    s_cmp_eq_u32 s39, s49
    s_cselect_b32 s39, s48, s39
    s_waitcnt vmcnt(9)
    s_barrier
    s_waitcnt lgkmcnt(12)
    v_mfma_f32_16x16x32_bf16 v[32:35], v[128:131], v[184:187], v[32:35]
    ds_read_b64_tr_b16 v[156:157], v23 offset:16384
    v_mfma_f32_16x16x32_bf16 v[36:39], v[128:131], v[188:191], v[36:39]
    ds_read_b64_tr_b16 v[158:159], v23 offset:20480
    v_mfma_f32_16x16x32_bf16 v[40:43], v[128:131], v[192:195], v[40:43]
    s_waitcnt lgkmcnt(12)
    v_mfma_f32_16x16x32_bf16 v[44:47], v[132:135], v[184:187], v[44:47]
    ds_read_b64_tr_b16 v[128:129], v16 offset:24576
    v_mfma_f32_16x16x32_bf16 v[48:51], v[132:135], v[188:191], v[48:51]
    ds_read_b64_tr_b16 v[130:131], v16 offset:28672
    v_mfma_f32_16x16x32_bf16 v[52:55], v[132:135], v[192:195], v[52:55]
    buffer_load_dwordx4 v[232:235], v1, s[12:15], s39 offen offset:0 sc1
    s_waitcnt lgkmcnt(12)
    v_mfma_f32_16x16x32_bf16 v[56:59], v[136:139], v[184:187], v[56:59]
    ds_read_b64_tr_b16 v[132:133], v17 offset:24576
    v_mfma_f32_16x16x32_bf16 v[60:63], v[136:139], v[188:191], v[60:63]
    ds_read_b64_tr_b16 v[134:135], v17 offset:28672
    v_mfma_f32_16x16x32_bf16 v[64:67], v[136:139], v[192:195], v[64:67]
    s_waitcnt lgkmcnt(12)
    v_mfma_f32_16x16x32_bf16 v[68:71], v[140:143], v[184:187], v[68:71]
    ds_read_b64_tr_b16 v[136:137], v18 offset:24576
    v_mfma_f32_16x16x32_bf16 v[72:75], v[140:143], v[188:191], v[72:75]
    ds_read_b64_tr_b16 v[138:139], v18 offset:28672
    v_mfma_f32_16x16x32_bf16 v[76:79], v[140:143], v[192:195], v[76:79]
    buffer_load_dwordx4 v[236:239], v1, s[12:15], s39 offen offset:1024 sc1
    s_waitcnt lgkmcnt(12)
    v_mfma_f32_16x16x32_bf16 v[80:83], v[144:147], v[184:187], v[80:83]
    ds_read_b64_tr_b16 v[140:141], v19 offset:24576
    v_mfma_f32_16x16x32_bf16 v[84:87], v[144:147], v[188:191], v[84:87]
    ds_read_b64_tr_b16 v[142:143], v19 offset:28672
    v_mfma_f32_16x16x32_bf16 v[88:91], v[144:147], v[192:195], v[88:91]
    s_waitcnt lgkmcnt(12)
    v_mfma_f32_16x16x32_bf16 v[92:95], v[148:151], v[184:187], v[92:95]
    ds_read_b64_tr_b16 v[144:145], v20 offset:24576
    v_mfma_f32_16x16x32_bf16 v[96:99], v[148:151], v[188:191], v[96:99]
    ds_read_b64_tr_b16 v[146:147], v20 offset:28672
    v_mfma_f32_16x16x32_bf16 v[100:103], v[148:151], v[192:195], v[100:103]
    buffer_load_dwordx4 v[240:243], v1, s[12:15], s39 offen offset:2048 sc1
    s_waitcnt lgkmcnt(12)
    v_mfma_f32_16x16x32_bf16 v[104:107], v[152:155], v[184:187], v[104:107]
    ds_read_b64_tr_b16 v[148:149], v21 offset:24576
    v_mfma_f32_16x16x32_bf16 v[108:111], v[152:155], v[188:191], v[108:111]
    ds_read_b64_tr_b16 v[150:151], v21 offset:28672
    v_mfma_f32_16x16x32_bf16 v[112:115], v[152:155], v[192:195], v[112:115]
    s_add_u32 s39, s39, 3072
    s_waitcnt lgkmcnt(12)
    v_mfma_f32_16x16x32_bf16 v[116:119], v[156:159], v[184:187], v[116:119]
    ds_read_b64_tr_b16 v[152:153], v22 offset:24576
    v_mfma_f32_16x16x32_bf16 v[120:123], v[156:159], v[188:191], v[120:123]
    ds_read_b64_tr_b16 v[154:155], v22 offset:28672
    v_mfma_f32_16x16x32_bf16 v[124:127], v[156:159], v[192:195], v[124:127]
    s_cmp_eq_u32 s39, s49
    s_cselect_b32 s39, s48, s39
    s_waitcnt vmcnt(9)
    s_barrier
    s_waitcnt lgkmcnt(12)
    v_mfma_f32_16x16x32_bf16 v[32:35], v[128:131], v[196:199], v[32:35]
    ds_read_b64_tr_b16 v[156:157], v23 offset:24576
    v_mfma_f32_16x16x32_bf16 v[36:39], v[128:131], v[200:203], v[36:39]
    ds_read_b64_tr_b16 v[158:159], v23 offset:28672
    v_mfma_f32_16x16x32_bf16 v[40:43], v[128:131], v[204:207], v[40:43]
    s_waitcnt lgkmcnt(12)
    v_mfma_f32_16x16x32_bf16 v[44:47], v[132:135], v[196:199], v[44:47]
    ds_read_b64_tr_b16 v[128:129], v16 offset:32768
    v_mfma_f32_16x16x32_bf16 v[48:51], v[132:135], v[200:203], v[48:51]
    ds_read_b64_tr_b16 v[130:131], v16 offset:36864
    v_mfma_f32_16x16x32_bf16 v[52:55], v[132:135], v[204:207], v[52:55]
    buffer_load_dwordx4 v[244:247], v1, s[12:15], s39 offen offset:0 sc1
    s_waitcnt lgkmcnt(12)
    v_mfma_f32_16x16x32_bf16 v[56:59], v[136:139], v[196:199], v[56:59]
    ds_read_b64_tr_b16 v[132:133], v17 offset:32768
    v_mfma_f32_16x16x32_bf16 v[60:63], v[136:139], v[200:203], v[60:63]
    ds_read_b64_tr_b16 v[134:135], v17 offset:36864
    v_mfma_f32_16x16x32_bf16 v[64:67], v[136:139], v[204:207], v[64:67]
    s_waitcnt lgkmcnt(12)
    v_mfma_f32_16x16x32_bf16 v[68:71], v[140:143], v[196:199], v[68:71]
    ds_read_b64_tr_b16 v[136:137], v18 offset:32768
    v_mfma_f32_16x16x32_bf16 v[72:75], v[140:143], v[200:203], v[72:75]
    ds_read_b64_tr_b16 v[138:139], v18 offset:36864
    v_mfma_f32_16x16x32_bf16 v[76:79], v[140:143], v[204:207], v[76:79]
    buffer_load_dwordx4 v[248:251], v1, s[12:15], s39 offen offset:1024 sc1
    s_waitcnt lgkmcnt(12)
    v_mfma_f32_16x16x32_bf16 v[80:83], v[144:147], v[196:199], v[80:83]
    ds_read_b64_tr_b16 v[140:141], v19 offset:32768
    v_mfma_f32_16x16x32_bf16 v[84:87], v[144:147], v[200:203], v[84:87]
    ds_read_b64_tr_b16 v[142:143], v19 offset:36864
    v_mfma_f32_16x16x32_bf16 v[88:91], v[144:147], v[204:207], v[88:91]
    s_waitcnt lgkmcnt(12)
    v_mfma_f32_16x16x32_bf16 v[92:95], v[148:151], v[196:199], v[92:95]
    ds_read_b64_tr_b16 v[144:145], v20 offset:32768
    v_mfma_f32_16x16x32_bf16 v[96:99], v[148:151], v[200:203], v[96:99]
    ds_read_b64_tr_b16 v[146:147], v20 offset:36864
    v_mfma_f32_16x16x32_bf16 v[100:103], v[148:151], v[204:207], v[100:103]
    buffer_load_dwordx4 v[252:255], v1, s[12:15], s39 offen offset:2048 sc1
    s_waitcnt lgkmcnt(12)
    v_mfma_f32_16x16x32_bf16 v[104:107], v[152:155], v[196:199], v[104:107]
    ds_read_b64_tr_b16 v[148:149], v21 offset:32768
    v_mfma_f32_16x16x32_bf16 v[108:111], v[152:155], v[200:203], v[108:111]
    ds_read_b64_tr_b16 v[150:151], v21 offset:36864
    v_mfma_f32_16x16x32_bf16 v[112:115], v[152:155], v[204:207], v[112:115]
    s_add_u32 s39, s39, 3072
    s_waitcnt lgkmcnt(12)
    v_mfma_f32_16x16x32_bf16 v[116:119], v[156:159], v[196:199], v[116:119]
    ds_read_b64_tr_b16 v[152:153], v22 offset:32768
    v_mfma_f32_16x16x32_bf16 v[120:123], v[156:159], v[200:203], v[120:123]
    ds_read_b64_tr_b16 v[154:155], v22 offset:36864
    v_mfma_f32_16x16x32_bf16 v[124:127], v[156:159], v[204:207], v[124:127]
    s_cmp_eq_u32 s39, s49
    s_cselect_b32 s39, s48, s39
    s_waitcnt vmcnt(9)
    s_barrier
    s_waitcnt lgkmcnt(12)
    v_mfma_f32_16x16x32_bf16 v[32:35], v[128:131], v[208:211], v[32:35]
    ds_read_b64_tr_b16 v[156:157], v23 offset:32768
    v_mfma_f32_16x16x32_bf16 v[36:39], v[128:131], v[212:215], v[36:39]
    ds_read_b64_tr_b16 v[158:159], v23 offset:36864
    v_mfma_f32_16x16x32_bf16 v[40:43], v[128:131], v[216:219], v[40:43]
    s_add_u32 s39, s39, 24576
    s_add_u32 s48, s48, 24576
    s_add_u32 s49, s49, 24576
    s_waitcnt lgkmcnt(12)
    v_mfma_f32_16x16x32_bf16 v[44:47], v[132:135], v[208:211], v[44:47]
    ds_read_b64_tr_b16 v[128:129], v16 offset:40960
    v_mfma_f32_16x16x32_bf16 v[48:51], v[132:135], v[212:215], v[48:51]
    ds_read_b64_tr_b16 v[130:131], v16 offset:45056
    v_mfma_f32_16x16x32_bf16 v[52:55], v[132:135], v[216:219], v[52:55]
    buffer_load_dwordx4 v[160:163], v1, s[12:15], s39 offen offset:0 sc1
    s_waitcnt lgkmcnt(12)
    v_mfma_f32_16x16x32_bf16 v[56:59], v[136:139], v[208:211], v[56:59]
    ds_read_b64_tr_b16 v[132:133], v17 offset:40960
    v_mfma_f32_16x16x32_bf16 v[60:63], v[136:139], v[212:215], v[60:63]
    ds_read_b64_tr_b16 v[134:135], v17 offset:45056
    v_mfma_f32_16x16x32_bf16 v[64:67], v[136:139], v[216:219], v[64:67]
    s_waitcnt lgkmcnt(12)
    v_mfma_f32_16x16x32_bf16 v[68:71], v[140:143], v[208:211], v[68:71]
    ds_read_b64_tr_b16 v[136:137], v18 offset:40960
    v_mfma_f32_16x16x32_bf16 v[72:75], v[140:143], v[212:215], v[72:75]
    ds_read_b64_tr_b16 v[138:139], v18 offset:45056
    v_mfma_f32_16x16x32_bf16 v[76:79], v[140:143], v[216:219], v[76:79]
    buffer_load_dwordx4 v[164:167], v1, s[12:15], s39 offen offset:1024 sc1
    s_waitcnt lgkmcnt(12)
    v_mfma_f32_16x16x32_bf16 v[80:83], v[144:147], v[208:211], v[80:83]
    ds_read_b64_tr_b16 v[140:141], v19 offset:40960
    v_mfma_f32_16x16x32_bf16 v[84:87], v[144:147], v[212:215], v[84:87]
    ds_read_b64_tr_b16 v[142:143], v19 offset:45056
    v_mfma_f32_16x16x32_bf16 v[88:91], v[144:147], v[216:219], v[88:91]
    s_waitcnt lgkmcnt(12)
    v_mfma_f32_16x16x32_bf16 v[92:95], v[148:151], v[208:211], v[92:95]
    ds_read_b64_tr_b16 v[144:145], v20 offset:40960
    v_mfma_f32_16x16x32_bf16 v[96:99], v[148:151], v[212:215], v[96:99]
    ds_read_b64_tr_b16 v[146:147], v20 offset:45056
    v_mfma_f32_16x16x32_bf16 v[100:103], v[148:151], v[216:219], v[100:103]
    buffer_load_dwordx4 v[168:171], v1, s[12:15], s39 offen offset:2048 sc1
    s_waitcnt lgkmcnt(12)
    v_mfma_f32_16x16x32_bf16 v[104:107], v[152:155], v[208:211], v[104:107]
    ds_read_b64_tr_b16 v[148:149], v21 offset:40960
    v_mfma_f32_16x16x32_bf16 v[108:111], v[152:155], v[212:215], v[108:111]
    ds_read_b64_tr_b16 v[150:151], v21 offset:45056
    v_mfma_f32_16x16x32_bf16 v[112:115], v[152:155], v[216:219], v[112:115]
    s_add_u32 s39, s39, 3072
    s_waitcnt lgkmcnt(12)
    v_mfma_f32_16x16x32_bf16 v[116:119], v[156:159], v[208:211], v[116:119]
    ds_read_b64_tr_b16 v[152:153], v22 offset:40960
    v_mfma_f32_16x16x32_bf16 v[120:123], v[156:159], v[212:215], v[120:123]
    ds_read_b64_tr_b16 v[154:155], v22 offset:45056
    v_mfma_f32_16x16x32_bf16 v[124:127], v[156:159], v[216:219], v[124:127]
    s_cmp_eq_u32 s39, s49
    s_cselect_b32 s39, s48, s39
    s_waitcnt vmcnt(9)
    s_barrier
    s_waitcnt lgkmcnt(12)
    v_mfma_f32_16x16x32_bf16 v[32:35], v[128:131], v[220:223], v[32:35]
    ds_read_b64_tr_b16 v[156:157], v23 offset:40960
    v_mfma_f32_16x16x32_bf16 v[36:39], v[128:131], v[224:227], v[36:39]
    ds_read_b64_tr_b16 v[158:159], v23 offset:45056
    v_mfma_f32_16x16x32_bf16 v[40:43], v[128:131], v[228:231], v[40:43]
    s_waitcnt lgkmcnt(12)
    v_mfma_f32_16x16x32_bf16 v[44:47], v[132:135], v[220:223], v[44:47]
    ds_read_b64_tr_b16 v[128:129], v16 offset:49152
    v_mfma_f32_16x16x32_bf16 v[48:51], v[132:135], v[224:227], v[48:51]
    ds_read_b64_tr_b16 v[130:131], v16 offset:53248
    v_mfma_f32_16x16x32_bf16 v[52:55], v[132:135], v[228:231], v[52:55]
    buffer_load_dwordx4 v[172:175], v1, s[12:15], s39 offen offset:0 sc1
    s_waitcnt lgkmcnt(12)
    v_mfma_f32_16x16x32_bf16 v[56:59], v[136:139], v[220:223], v[56:59]
    ds_read_b64_tr_b16 v[132:133], v17 offset:49152
    v_mfma_f32_16x16x32_bf16 v[60:63], v[136:139], v[224:227], v[60:63]
    ds_read_b64_tr_b16 v[134:135], v17 offset:53248
    v_mfma_f32_16x16x32_bf16 v[64:67], v[136:139], v[228:231], v[64:67]
    s_waitcnt lgkmcnt(12)
    v_mfma_f32_16x16x32_bf16 v[68:71], v[140:143], v[220:223], v[68:71]
    ds_read_b64_tr_b16 v[136:137], v18 offset:49152
    v_mfma_f32_16x16x32_bf16 v[72:75], v[140:143], v[224:227], v[72:75]
    ds_read_b64_tr_b16 v[138:139], v18 offset:53248
    v_mfma_f32_16x16x32_bf16 v[76:79], v[140:143], v[228:231], v[76:79]
    buffer_load_dwordx4 v[176:179], v1, s[12:15], s39 offen offset:1024 sc1
    s_waitcnt lgkmcnt(12)
    v_mfma_f32_16x16x32_bf16 v[80:83], v[144:147], v[220:223], v[80:83]
    ds_read_b64_tr_b16 v[140:141], v19 offset:49152
    v_mfma_f32_16x16x32_bf16 v[84:87], v[144:147], v[224:227], v[84:87]
    ds_read_b64_tr_b16 v[142:143], v19 offset:53248
    v_mfma_f32_16x16x32_bf16 v[88:91], v[144:147], v[228:231], v[88:91]
    s_waitcnt lgkmcnt(12)
    v_mfma_f32_16x16x32_bf16 v[92:95], v[148:151], v[220:223], v[92:95]
    ds_read_b64_tr_b16 v[144:145], v20 offset:49152
    v_mfma_f32_16x16x32_bf16 v[96:99], v[148:151], v[224:227], v[96:99]
    ds_read_b64_tr_b16 v[146:147], v20 offset:53248
    v_mfma_f32_16x16x32_bf16 v[100:103], v[148:151], v[228:231], v[100:103]
    buffer_load_dwordx4 v[180:183], v1, s[12:15], s39 offen offset:2048 sc1
    s_waitcnt lgkmcnt(12)
    v_mfma_f32_16x16x32_bf16 v[104:107], v[152:155], v[220:223], v[104:107]
    ds_read_b64_tr_b16 v[148:149], v21 offset:49152
    v_mfma_f32_16x16x32_bf16 v[108:111], v[152:155], v[224:227], v[108:111]
    ds_read_b64_tr_b16 v[150:151], v21 offset:53248
    v_mfma_f32_16x16x32_bf16 v[112:115], v[152:155], v[228:231], v[112:115]
    s_add_u32 s39, s39, 3072
    s_waitcnt lgkmcnt(12)
    v_mfma_f32_16x16x32_bf16 v[116:119], v[156:159], v[220:223], v[116:119]
    ds_read_b64_tr_b16 v[152:153], v22 offset:49152
    v_mfma_f32_16x16x32_bf16 v[120:123], v[156:159], v[224:227], v[120:123]
    ds_read_b64_tr_b16 v[154:155], v22 offset:53248
    v_mfma_f32_16x16x32_bf16 v[124:127], v[156:159], v[228:231], v[124:127]
    s_cmp_eq_u32 s39, s49
    s_cselect_b32 s39, s48, s39
    s_waitcnt vmcnt(9)
    s_barrier
    s_waitcnt lgkmcnt(12)
    v_mfma_f32_16x16x32_bf16 v[32:35], v[128:131], v[232:235], v[32:35]
    ds_read_b64_tr_b16 v[156:157], v23 offset:49152
    v_mfma_f32_16x16x32_bf16 v[36:39], v[128:131], v[236:239], v[36:39]
    ds_read_b64_tr_b16 v[158:159], v23 offset:53248
    v_mfma_f32_16x16x32_bf16 v[40:43], v[128:131], v[240:243], v[40:43]
    s_waitcnt lgkmcnt(12)
    v_mfma_f32_16x16x32_bf16 v[44:47], v[132:135], v[232:235], v[44:47]
    ds_read_b64_tr_b16 v[128:129], v16 offset:57344
    v_mfma_f32_16x16x32_bf16 v[48:51], v[132:135], v[236:239], v[48:51]
    ds_read_b64_tr_b16 v[130:131], v16 offset:61440
    v_mfma_f32_16x16x32_bf16 v[52:55], v[132:135], v[240:243], v[52:55]
    buffer_load_dwordx4 v[184:187], v1, s[12:15], s39 offen offset:0 sc1
    s_waitcnt lgkmcnt(12)
    v_mfma_f32_16x16x32_bf16 v[56:59], v[136:139], v[232:235], v[56:59]
    ds_read_b64_tr_b16 v[132:133], v17 offset:57344
    v_mfma_f32_16x16x32_bf16 v[60:63], v[136:139], v[236:239], v[60:63]
    ds_read_b64_tr_b16 v[134:135], v17 offset:61440
    v_mfma_f32_16x16x32_bf16 v[64:67], v[136:139], v[240:243], v[64:67]
    s_waitcnt lgkmcnt(12)
    v_mfma_f32_16x16x32_bf16 v[68:71], v[140:143], v[232:235], v[68:71]
    ds_read_b64_tr_b16 v[136:137], v18 offset:57344
    v_mfma_f32_16x16x32_bf16 v[72:75], v[140:143], v[236:239], v[72:75]
    ds_read_b64_tr_b16 v[138:139], v18 offset:61440
    v_mfma_f32_16x16x32_bf16 v[76:79], v[140:143], v[240:243], v[76:79]
    buffer_load_dwordx4 v[188:191], v1, s[12:15], s39 offen offset:1024 sc1
    s_waitcnt lgkmcnt(12)
    v_mfma_f32_16x16x32_bf16 v[80:83], v[144:147], v[232:235], v[80:83]
    ds_read_b64_tr_b16 v[140:141], v19 offset:57344
    v_mfma_f32_16x16x32_bf16 v[84:87], v[144:147], v[236:239], v[84:87]
    ds_read_b64_tr_b16 v[142:143], v19 offset:61440
    v_mfma_f32_16x16x32_bf16 v[88:91], v[144:147], v[240:243], v[88:91]
    s_waitcnt lgkmcnt(12)
    v_mfma_f32_16x16x32_bf16 v[92:95], v[148:151], v[232:235], v[92:95]
    ds_read_b64_tr_b16 v[144:145], v20 offset:57344
    v_mfma_f32_16x16x32_bf16 v[96:99], v[148:151], v[236:239], v[96:99]
    ds_read_b64_tr_b16 v[146:147], v20 offset:61440
    v_mfma_f32_16x16x32_bf16 v[100:103], v[148:151], v[240:243], v[100:103]
    buffer_load_dwordx4 v[192:195], v1, s[12:15], s39 offen offset:2048 sc1
    s_waitcnt lgkmcnt(12)
    v_mfma_f32_16x16x32_bf16 v[104:107], v[152:155], v[232:235], v[104:107]
    ds_read_b64_tr_b16 v[148:149], v21 offset:57344
    v_mfma_f32_16x16x32_bf16 v[108:111], v[152:155], v[236:239], v[108:111]
    ds_read_b64_tr_b16 v[150:151], v21 offset:61440
    v_mfma_f32_16x16x32_bf16 v[112:115], v[152:155], v[240:243], v[112:115]
    s_add_u32 s39, s39, 3072
    s_waitcnt lgkmcnt(12)
    v_mfma_f32_16x16x32_bf16 v[116:119], v[156:159], v[232:235], v[116:119]
    ds_read_b64_tr_b16 v[152:153], v22 offset:57344
    v_mfma_f32_16x16x32_bf16 v[120:123], v[156:159], v[236:239], v[120:123]
    ds_read_b64_tr_b16 v[154:155], v22 offset:61440
    v_mfma_f32_16x16x32_bf16 v[124:127], v[156:159], v[240:243], v[124:127]
    s_cmp_eq_u32 s39, s49
    s_cselect_b32 s39, s48, s39
    s_waitcnt vmcnt(9)
    s_barrier
    s_waitcnt lgkmcnt(12)
    v_mfma_f32_16x16x32_bf16 v[32:35], v[128:131], v[244:247], v[32:35]
    ds_read_b64_tr_b16 v[156:157], v23 offset:57344
    v_mfma_f32_16x16x32_bf16 v[36:39], v[128:131], v[248:251], v[36:39]
    ds_read_b64_tr_b16 v[158:159], v23 offset:61440
    v_mfma_f32_16x16x32_bf16 v[40:43], v[128:131], v[252:255], v[40:43]
    s_waitcnt lgkmcnt(12)
    v_mfma_f32_16x16x32_bf16 v[44:47], v[132:135], v[244:247], v[44:47]
    ds_read_b64_tr_b16 v[128:129], v16 offset:0
    v_mfma_f32_16x16x32_bf16 v[48:51], v[132:135], v[248:251], v[48:51]
    ds_read_b64_tr_b16 v[130:131], v16 offset:4096
    v_mfma_f32_16x16x32_bf16 v[52:55], v[132:135], v[252:255], v[52:55]
    buffer_load_dwordx4 v[196:199], v1, s[12:15], s39 offen offset:0 sc1
    s_waitcnt lgkmcnt(12)
    v_mfma_f32_16x16x32_bf16 v[56:59], v[136:139], v[244:247], v[56:59]
    ds_read_b64_tr_b16 v[132:133], v17 offset:0
    v_mfma_f32_16x16x32_bf16 v[60:63], v[136:139], v[248:251], v[60:63]
    ds_read_b64_tr_b16 v[134:135], v17 offset:4096
    v_mfma_f32_16x16x32_bf16 v[64:67], v[136:139], v[252:255], v[64:67]
    s_waitcnt lgkmcnt(12)
    v_mfma_f32_16x16x32_bf16 v[68:71], v[140:143], v[244:247], v[68:71]
    ds_read_b64_tr_b16 v[136:137], v18 offset:0
    v_mfma_f32_16x16x32_bf16 v[72:75], v[140:143], v[248:251], v[72:75]
    ds_read_b64_tr_b16 v[138:139], v18 offset:4096
    v_mfma_f32_16x16x32_bf16 v[76:79], v[140:143], v[252:255], v[76:79]
    buffer_load_dwordx4 v[200:203], v1, s[12:15], s39 offen offset:1024 sc1
    s_waitcnt lgkmcnt(12)
    v_mfma_f32_16x16x32_bf16 v[80:83], v[144:147], v[244:247], v[80:83]
    ds_read_b64_tr_b16 v[140:141], v19 offset:0
    v_mfma_f32_16x16x32_bf16 v[84:87], v[144:147], v[248:251], v[84:87]
    ds_read_b64_tr_b16 v[142:143], v19 offset:4096
    v_mfma_f32_16x16x32_bf16 v[88:91], v[144:147], v[252:255], v[88:91]
    s_waitcnt lgkmcnt(12)
    v_mfma_f32_16x16x32_bf16 v[92:95], v[148:151], v[244:247], v[92:95]
    ds_read_b64_tr_b16 v[144:145], v20 offset:0
    v_mfma_f32_16x16x32_bf16 v[96:99], v[148:151], v[248:251], v[96:99]
    ds_read_b64_tr_b16 v[146:147], v20 offset:4096
    v_mfma_f32_16x16x32_bf16 v[100:103], v[148:151], v[252:255], v[100:103]
    buffer_load_dwordx4 v[204:207], v1, s[12:15], s39 offen offset:2048 sc1
    s_waitcnt lgkmcnt(12)
    v_mfma_f32_16x16x32_bf16 v[104:107], v[152:155], v[244:247], v[104:107]
    ds_read_b64_tr_b16 v[148:149], v21 offset:0
    v_mfma_f32_16x16x32_bf16 v[108:111], v[152:155], v[248:251], v[108:111]
    ds_read_b64_tr_b16 v[150:151], v21 offset:4096
    v_mfma_f32_16x16x32_bf16 v[112:115], v[152:155], v[252:255], v[112:115]
    s_add_u32 s39, s39, 3072
    s_waitcnt lgkmcnt(12)
    v_mfma_f32_16x16x32_bf16 v[116:119], v[156:159], v[244:247], v[116:119]
    ds_read_b64_tr_b16 v[152:153], v22 offset:0
    v_mfma_f32_16x16x32_bf16 v[120:123], v[156:159], v[248:251], v[120:123]
    ds_read_b64_tr_b16 v[154:155], v22 offset:4096
    v_mfma_f32_16x16x32_bf16 v[124:127], v[156:159], v[252:255], v[124:127]
    s_cmp_eq_u32 s39, s49
    s_cselect_b32 s39, s48, s39
    s_sub_u32 s41, s41, 1
    s_cmp_lg_u32 s41, 0
    s_cbranch_scc1 .g1loop_30
    s_waitcnt vmcnt(9)
    s_barrier
    s_waitcnt lgkmcnt(12)
    v_mfma_f32_16x16x32_bf16 v[32:35], v[128:131], v[160:163], v[32:35]
    ds_read_b64_tr_b16 v[156:157], v23 offset:0
    v_mfma_f32_16x16x32_bf16 v[36:39], v[128:131], v[164:167], v[36:39]
    ds_read_b64_tr_b16 v[158:159], v23 offset:4096
    v_mfma_f32_16x16x32_bf16 v[40:43], v[128:131], v[168:171], v[40:43]
    buffer_load_dwordx2 v[24:25], v8, s[16:19], s40 offen offset:0
    buffer_load_dwordx2 v[26:27], v8, s[16:19], s40 offen offset:32
    buffer_load_dwordx2 v[28:29], v8, s[16:19], s40 offen offset:64
    buffer_load_dwordx2 v[30:31], v8, s[16:19], s40 offen offset:96
    s_waitcnt lgkmcnt(12)
    v_mfma_f32_16x16x32_bf16 v[44:47], v[132:135], v[160:163], v[44:47]
    ds_read_b64_tr_b16 v[128:129], v16 offset:8192
    v_mfma_f32_16x16x32_bf16 v[48:51], v[132:135], v[164:167], v[48:51]
    ds_read_b64_tr_b16 v[130:131], v16 offset:12288
    v_mfma_f32_16x16x32_bf16 v[52:55], v[132:135], v[168:171], v[52:55]
    buffer_load_dwordx4 v[208:211], v1, s[12:15], s39 offen offset:0 sc1
    s_waitcnt lgkmcnt(12)
    v_mfma_f32_16x16x32_bf16 v[56:59], v[136:139], v[160:163], v[56:59]
    ds_read_b64_tr_b16 v[132:133], v17 offset:8192
    v_mfma_f32_16x16x32_bf16 v[60:63], v[136:139], v[164:167], v[60:63]
    ds_read_b64_tr_b16 v[134:135], v17 offset:12288
    v_mfma_f32_16x16x32_bf16 v[64:67], v[136:139], v[168:171], v[64:67]
    s_waitcnt lgkmcnt(12)
    v_mfma_f32_16x16x32_bf16 v[68:71], v[140:143], v[160:163], v[68:71]
    ds_read_b64_tr_b16 v[136:137], v18 offset:8192
    v_mfma_f32_16x16x32_bf16 v[72:75], v[140:143], v[164:167], v[72:75]
    ds_read_b64_tr_b16 v[138:139], v18 offset:12288
    v_mfma_f32_16x16x32_bf16 v[76:79], v[140:143], v[168:171], v[76:79]
    buffer_load_dwordx4 v[212:215], v1, s[12:15], s39 offen offset:1024 sc1
    s_waitcnt lgkmcnt(12)
    v_mfma_f32_16x16x32_bf16 v[80:83], v[144:147], v[160:163], v[80:83]
    ds_read_b64_tr_b16 v[140:141], v19 offset:8192
    v_mfma_f32_16x16x32_bf16 v[84:87], v[144:147], v[164:167], v[84:87]
    ds_read_b64_tr_b16 v[142:143], v19 offset:12288
    v_mfma_f32_16x16x32_bf16 v[88:91], v[144:147], v[168:171], v[88:91]
    s_waitcnt lgkmcnt(12)
    v_mfma_f32_16x16x32_bf16 v[92:95], v[148:151], v[160:163], v[92:95]
    ds_read_b64_tr_b16 v[144:145], v20 offset:8192
    v_mfma_f32_16x16x32_bf16 v[96:99], v[148:151], v[164:167], v[96:99]
    ds_read_b64_tr_b16 v[146:147], v20 offset:12288
    v_mfma_f32_16x16x32_bf16 v[100:103], v[148:151], v[168:171], v[100:103]
    buffer_load_dwordx4 v[216:219], v1, s[12:15], s39 offen offset:2048 sc1
    s_waitcnt lgkmcnt(12)
    v_mfma_f32_16x16x32_bf16 v[104:107], v[152:155], v[160:163], v[104:107]
    ds_read_b64_tr_b16 v[148:149], v21 offset:8192
    v_mfma_f32_16x16x32_bf16 v[108:111], v[152:155], v[164:167], v[108:111]
    ds_read_b64_tr_b16 v[150:151], v21 offset:12288
    v_mfma_f32_16x16x32_bf16 v[112:115], v[152:155], v[168:171], v[112:115]
    s_add_u32 s39, s39, 3072
    s_waitcnt lgkmcnt(12)
    v_mfma_f32_16x16x32_bf16 v[116:119], v[156:159], v[160:163], v[116:119]
    ds_read_b64_tr_b16 v[152:153], v22 offset:8192
    v_mfma_f32_16x16x32_bf16 v[120:123], v[156:159], v[164:167], v[120:123]
    ds_read_b64_tr_b16 v[154:155], v22 offset:12288
    v_mfma_f32_16x16x32_bf16 v[124:127], v[156:159], v[168:171], v[124:127]
    s_cmp_eq_u32 s39, s49
    s_cselect_b32 s39, s48, s39
    s_waitcnt vmcnt(13)
    s_barrier
    s_waitcnt lgkmcnt(12)
    v_mfma_f32_16x16x32_bf16 v[32:35], v[128:131], v[172:175], v[32:35]
    ds_read_b64_tr_b16 v[156:157], v23 offset:8192
    v_mfma_f32_16x16x32_bf16 v[36:39], v[128:131], v[176:179], v[36:39]
    ds_read_b64_tr_b16 v[158:159], v23 offset:12288
    v_mfma_f32_16x16x32_bf16 v[40:43], v[128:131], v[180:183], v[40:43]
    s_waitcnt lgkmcnt(12)
    v_mfma_f32_16x16x32_bf16 v[44:47], v[132:135], v[172:175], v[44:47]
    ds_read_b64_tr_b16 v[128:129], v16 offset:16384
    v_mfma_f32_16x16x32_bf16 v[48:51], v[132:135], v[176:179], v[48:51]
    ds_read_b64_tr_b16 v[130:131], v16 offset:20480
    v_mfma_f32_16x16x32_bf16 v[52:55], v[132:135], v[180:183], v[52:55]
    buffer_load_dwordx4 v[220:223], v1, s[12:15], s39 offen offset:0 sc1
    s_waitcnt lgkmcnt(12)
    v_mfma_f32_16x16x32_bf16 v[56:59], v[136:139], v[172:175], v[56:59]
    ds_read_b64_tr_b16 v[132:133], v17 offset:16384
    v_mfma_f32_16x16x32_bf16 v[60:63], v[136:139], v[176:179], v[60:63]
    ds_read_b64_tr_b16 v[134:135], v17 offset:20480
    v_mfma_f32_16x16x32_bf16 v[64:67], v[136:139], v[180:183], v[64:67]
    s_waitcnt lgkmcnt(12)
    v_mfma_f32_16x16x32_bf16 v[68:71], v[140:143], v[172:175], v[68:71]
    ds_read_b64_tr_b16 v[136:137], v18 offset:16384
    v_mfma_f32_16x16x32_bf16 v[72:75], v[140:143], v[176:179], v[72:75]
    ds_read_b64_tr_b16 v[138:139], v18 offset:20480
    v_mfma_f32_16x16x32_bf16 v[76:79], v[140:143], v[180:183], v[76:79]
    buffer_load_dwordx4 v[224:227], v1, s[12:15], s39 offen offset:1024 sc1
    s_waitcnt lgkmcnt(12)
    v_mfma_f32_16x16x32_bf16 v[80:83], v[144:147], v[172:175], v[80:83]
    ds_read_b64_tr_b16 v[140:141], v19 offset:16384
    v_mfma_f32_16x16x32_bf16 v[84:87], v[144:147], v[176:179], v[84:87]
    ds_read_b64_tr_b16 v[142:143], v19 offset:20480
    v_mfma_f32_16x16x32_bf16 v[88:91], v[144:147], v[180:183], v[88:91]
    s_waitcnt lgkmcnt(12)
    v_mfma_f32_16x16x32_bf16 v[92:95], v[148:151], v[172:175], v[92:95]
    ds_read_b64_tr_b16 v[144:145], v20 offset:16384
    v_mfma_f32_16x16x32_bf16 v[96:99], v[148:151], v[176:179], v[96:99]
    ds_read_b64_tr_b16 v[146:147], v20 offset:20480
    v_mfma_f32_16x16x32_bf16 v[100:103], v[148:151], v[180:183], v[100:103]
    buffer_load_dwordx4 v[228:231], v1, s[12:15], s39 offen offset:2048 sc1
    s_waitcnt lgkmcnt(12)
    v_mfma_f32_16x16x32_bf16 v[104:107], v[152:155], v[172:175], v[104:107]
    ds_read_b64_tr_b16 v[148:149], v21 offset:16384
    v_mfma_f32_16x16x32_bf16 v[108:111], v[152:155], v[176:179], v[108:111]
    ds_read_b64_tr_b16 v[150:151], v21 offset:20480
    v_mfma_f32_16x16x32_bf16 v[112:115], v[152:155], v[180:183], v[112:115]
    s_add_u32 s39, s39, 3072
    s_waitcnt lgkmcnt(12)
    v_mfma_f32_16x16x32_bf16 v[116:119], v[156:159], v[172:175], v[116:119]
    ds_read_b64_tr_b16 v[152:153], v22 offset:16384
    v_mfma_f32_16x16x32_bf16 v[120:123], v[156:159], v[176:179], v[120:123]
    ds_read_b64_tr_b16 v[154:155], v22 offset:20480
    v_mfma_f32_16x16x32_bf16 v[124:127], v[156:159], v[180:183], v[124:127]
    s_cmp_eq_u32 s39, s49
    s_cselect_b32 s39, s48, s39
    s_waitcnt vmcnt(13)
    s_barrier
    s_waitcnt lgkmcnt(12)
    v_mfma_f32_16x16x32_bf16 v[32:35], v[128:131], v[184:187], v[32:35]
    ds_read_b64_tr_b16 v[156:157], v23 offset:16384
    v_mfma_f32_16x16x32_bf16 v[36:39], v[128:131], v[188:191], v[36:39]
    ds_read_b64_tr_b16 v[158:159], v23 offset:20480
    v_mfma_f32_16x16x32_bf16 v[40:43], v[128:131], v[192:195], v[40:43]
    s_waitcnt lgkmcnt(12)
    v_mfma_f32_16x16x32_bf16 v[44:47], v[132:135], v[184:187], v[44:47]
    ds_read_b64_tr_b16 v[128:129], v16 offset:24576
    v_mfma_f32_16x16x32_bf16 v[48:51], v[132:135], v[188:191], v[48:51]
    ds_read_b64_tr_b16 v[130:131], v16 offset:28672
    v_mfma_f32_16x16x32_bf16 v[52:55], v[132:135], v[192:195], v[52:55]
    buffer_load_dwordx4 v[232:235], v1, s[12:15], s39 offen offset:0 sc1
    s_waitcnt lgkmcnt(12)
    v_mfma_f32_16x16x32_bf16 v[56:59], v[136:139], v[184:187], v[56:59]
    ds_read_b64_tr_b16 v[132:133], v17 offset:24576
    v_mfma_f32_16x16x32_bf16 v[60:63], v[136:139], v[188:191], v[60:63]
    ds_read_b64_tr_b16 v[134:135], v17 offset:28672
    v_mfma_f32_16x16x32_bf16 v[64:67], v[136:139], v[192:195], v[64:67]
    s_waitcnt lgkmcnt(12)
    v_mfma_f32_16x16x32_bf16 v[68:71], v[140:143], v[184:187], v[68:71]
    ds_read_b64_tr_b16 v[136:137], v18 offset:24576
    v_mfma_f32_16x16x32_bf16 v[72:75], v[140:143], v[188:191], v[72:75]
    ds_read_b64_tr_b16 v[138:139], v18 offset:28672
    v_mfma_f32_16x16x32_bf16 v[76:79], v[140:143], v[192:195], v[76:79]
    buffer_load_dwordx4 v[236:239], v1, s[12:15], s39 offen offset:1024 sc1
    s_waitcnt lgkmcnt(12)
    v_mfma_f32_16x16x32_bf16 v[80:83], v[144:147], v[184:187], v[80:83]
    ds_read_b64_tr_b16 v[140:141], v19 offset:24576
    v_mfma_f32_16x16x32_bf16 v[84:87], v[144:147], v[188:191], v[84:87]
    ds_read_b64_tr_b16 v[142:143], v19 offset:28672
    v_mfma_f32_16x16x32_bf16 v[88:91], v[144:147], v[192:195], v[88:91]
    s_waitcnt lgkmcnt(12)
    v_mfma_f32_16x16x32_bf16 v[92:95], v[148:151], v[184:187], v[92:95]
    ds_read_b64_tr_b16 v[144:145], v20 offset:24576
    v_mfma_f32_16x16x32_bf16 v[96:99], v[148:151], v[188:191], v[96:99]
    ds_read_b64_tr_b16 v[146:147], v20 offset:28672
    v_mfma_f32_16x16x32_bf16 v[100:103], v[148:151], v[192:195], v[100:103]
    buffer_load_dwordx4 v[240:243], v1, s[12:15], s39 offen offset:2048 sc1
    s_waitcnt lgkmcnt(12)
    v_mfma_f32_16x16x32_bf16 v[104:107], v[152:155], v[184:187], v[104:107]
    ds_read_b64_tr_b16 v[148:149], v21 offset:24576
    v_mfma_f32_16x16x32_bf16 v[108:111], v[152:155], v[188:191], v[108:111]
    ds_read_b64_tr_b16 v[150:151], v21 offset:28672
    v_mfma_f32_16x16x32_bf16 v[112:115], v[152:155], v[192:195], v[112:115]
    s_add_u32 s39, s39, 3072
    s_waitcnt lgkmcnt(12)
    v_mfma_f32_16x16x32_bf16 v[116:119], v[156:159], v[184:187], v[116:119]
    ds_read_b64_tr_b16 v[152:153], v22 offset:24576
    v_mfma_f32_16x16x32_bf16 v[120:123], v[156:159], v[188:191], v[120:123]
    ds_read_b64_tr_b16 v[154:155], v22 offset:28672
    v_mfma_f32_16x16x32_bf16 v[124:127], v[156:159], v[192:195], v[124:127]
    s_cmp_eq_u32 s39, s49
    s_cselect_b32 s39, s48, s39
    s_waitcnt vmcnt(13)
    s_barrier
    s_waitcnt lgkmcnt(12)
    v_mfma_f32_16x16x32_bf16 v[32:35], v[128:131], v[196:199], v[32:35]
    ds_read_b64_tr_b16 v[156:157], v23 offset:24576
    v_mfma_f32_16x16x32_bf16 v[36:39], v[128:131], v[200:203], v[36:39]
    ds_read_b64_tr_b16 v[158:159], v23 offset:28672
    v_mfma_f32_16x16x32_bf16 v[40:43], v[128:131], v[204:207], v[40:43]
    s_waitcnt lgkmcnt(12)
    v_mfma_f32_16x16x32_bf16 v[44:47], v[132:135], v[196:199], v[44:47]
    ds_read_b64_tr_b16 v[128:129], v16 offset:32768
    v_mfma_f32_16x16x32_bf16 v[48:51], v[132:135], v[200:203], v[48:51]
    ds_read_b64_tr_b16 v[130:131], v16 offset:36864
    v_mfma_f32_16x16x32_bf16 v[52:55], v[132:135], v[204:207], v[52:55]
    buffer_load_dwordx4 v[244:247], v1, s[12:15], s39 offen offset:0 sc1
    s_waitcnt lgkmcnt(12)
    v_mfma_f32_16x16x32_bf16 v[56:59], v[136:139], v[196:199], v[56:59]
    ds_read_b64_tr_b16 v[132:133], v17 offset:32768
    v_mfma_f32_16x16x32_bf16 v[60:63], v[136:139], v[200:203], v[60:63]
    ds_read_b64_tr_b16 v[134:135], v17 offset:36864
    v_mfma_f32_16x16x32_bf16 v[64:67], v[136:139], v[204:207], v[64:67]
    s_waitcnt lgkmcnt(12)
    v_mfma_f32_16x16x32_bf16 v[68:71], v[140:143], v[196:199], v[68:71]
    ds_read_b64_tr_b16 v[136:137], v18 offset:32768
    v_mfma_f32_16x16x32_bf16 v[72:75], v[140:143], v[200:203], v[72:75]
    ds_read_b64_tr_b16 v[138:139], v18 offset:36864
    v_mfma_f32_16x16x32_bf16 v[76:79], v[140:143], v[204:207], v[76:79]
    buffer_load_dwordx4 v[248:251], v1, s[12:15], s39 offen offset:1024 sc1
    s_waitcnt lgkmcnt(12)
    v_mfma_f32_16x16x32_bf16 v[80:83], v[144:147], v[196:199], v[80:83]
    ds_read_b64_tr_b16 v[140:141], v19 offset:32768
    v_mfma_f32_16x16x32_bf16 v[84:87], v[144:147], v[200:203], v[84:87]
    ds_read_b64_tr_b16 v[142:143], v19 offset:36864
    v_mfma_f32_16x16x32_bf16 v[88:91], v[144:147], v[204:207], v[88:91]
    s_waitcnt lgkmcnt(12)
    v_mfma_f32_16x16x32_bf16 v[92:95], v[148:151], v[196:199], v[92:95]
    ds_read_b64_tr_b16 v[144:145], v20 offset:32768
    v_mfma_f32_16x16x32_bf16 v[96:99], v[148:151], v[200:203], v[96:99]
    ds_read_b64_tr_b16 v[146:147], v20 offset:36864
    v_mfma_f32_16x16x32_bf16 v[100:103], v[148:151], v[204:207], v[100:103]
    buffer_load_dwordx4 v[252:255], v1, s[12:15], s39 offen offset:2048 sc1
    s_waitcnt lgkmcnt(12)
    v_mfma_f32_16x16x32_bf16 v[104:107], v[152:155], v[196:199], v[104:107]
    ds_read_b64_tr_b16 v[148:149], v21 offset:32768
    v_mfma_f32_16x16x32_bf16 v[108:111], v[152:155], v[200:203], v[108:111]
    ds_read_b64_tr_b16 v[150:151], v21 offset:36864
    v_mfma_f32_16x16x32_bf16 v[112:115], v[152:155], v[204:207], v[112:115]
    s_add_u32 s39, s39, 3072
    s_waitcnt lgkmcnt(12)
    v_mfma_f32_16x16x32_bf16 v[116:119], v[156:159], v[196:199], v[116:119]
    ds_read_b64_tr_b16 v[152:153], v22 offset:32768
    v_mfma_f32_16x16x32_bf16 v[120:123], v[156:159], v[200:203], v[120:123]
    ds_read_b64_tr_b16 v[154:155], v22 offset:36864
    v_mfma_f32_16x16x32_bf16 v[124:127], v[156:159], v[204:207], v[124:127]
    s_cmp_eq_u32 s39, s49
    s_cselect_b32 s39, s48, s39
    s_waitcnt vmcnt(9)
    s_barrier
    s_waitcnt lgkmcnt(12)
    v_mfma_f32_16x16x32_bf16 v[32:35], v[128:131], v[208:211], v[32:35]
    ds_read_b64_tr_b16 v[156:157], v23 offset:32768
    v_mfma_f32_16x16x32_bf16 v[36:39], v[128:131], v[212:215], v[36:39]
    ds_read_b64_tr_b16 v[158:159], v23 offset:36864
    v_mfma_f32_16x16x32_bf16 v[40:43], v[128:131], v[216:219], v[40:43]
    s_waitcnt lgkmcnt(12)
    v_mfma_f32_16x16x32_bf16 v[44:47], v[132:135], v[208:211], v[44:47]
    ds_read_b64_tr_b16 v[128:129], v16 offset:40960
    v_mfma_f32_16x16x32_bf16 v[48:51], v[132:135], v[212:215], v[48:51]
    ds_read_b64_tr_b16 v[130:131], v16 offset:45056
    v_mfma_f32_16x16x32_bf16 v[52:55], v[132:135], v[216:219], v[52:55]
    s_waitcnt lgkmcnt(12)
    v_mfma_f32_16x16x32_bf16 v[56:59], v[136:139], v[208:211], v[56:59]
    ds_read_b64_tr_b16 v[132:133], v17 offset:40960
    v_mfma_f32_16x16x32_bf16 v[60:63], v[136:139], v[212:215], v[60:63]
    ds_read_b64_tr_b16 v[134:135], v17 offset:45056
    v_mfma_f32_16x16x32_bf16 v[64:67], v[136:139], v[216:219], v[64:67]
    s_waitcnt lgkmcnt(12)
    v_mfma_f32_16x16x32_bf16 v[68:71], v[140:143], v[208:211], v[68:71]
    ds_read_b64_tr_b16 v[136:137], v18 offset:40960
    v_mfma_f32_16x16x32_bf16 v[72:75], v[140:143], v[212:215], v[72:75]
    ds_read_b64_tr_b16 v[138:139], v18 offset:45056
    v_mfma_f32_16x16x32_bf16 v[76:79], v[140:143], v[216:219], v[76:79]
    s_waitcnt lgkmcnt(12)
    v_mfma_f32_16x16x32_bf16 v[80:83], v[144:147], v[208:211], v[80:83]
    ds_read_b64_tr_b16 v[140:141], v19 offset:40960
    v_mfma_f32_16x16x32_bf16 v[84:87], v[144:147], v[212:215], v[84:87]
    ds_read_b64_tr_b16 v[142:143], v19 offset:45056
    v_mfma_f32_16x16x32_bf16 v[88:91], v[144:147], v[216:219], v[88:91]
    s_waitcnt lgkmcnt(12)
    v_mfma_f32_16x16x32_bf16 v[92:95], v[148:151], v[208:211], v[92:95]
    ds_read_b64_tr_b16 v[144:145], v20 offset:40960
    v_mfma_f32_16x16x32_bf16 v[96:99], v[148:151], v[212:215], v[96:99]
    ds_read_b64_tr_b16 v[146:147], v20 offset:45056
    v_mfma_f32_16x16x32_bf16 v[100:103], v[148:151], v[216:219], v[100:103]
    s_waitcnt lgkmcnt(12)
    v_mfma_f32_16x16x32_bf16 v[104:107], v[152:155], v[208:211], v[104:107]
    ds_read_b64_tr_b16 v[148:149], v21 offset:40960
    v_mfma_f32_16x16x32_bf16 v[108:111], v[152:155], v[212:215], v[108:111]
    ds_read_b64_tr_b16 v[150:151], v21 offset:45056
    v_mfma_f32_16x16x32_bf16 v[112:115], v[152:155], v[216:219], v[112:115]
    s_waitcnt lgkmcnt(12)
    v_mfma_f32_16x16x32_bf16 v[116:119], v[156:159], v[208:211], v[116:119]
    ds_read_b64_tr_b16 v[152:153], v22 offset:40960
    v_mfma_f32_16x16x32_bf16 v[120:123], v[156:159], v[212:215], v[120:123]
    ds_read_b64_tr_b16 v[154:155], v22 offset:45056
    v_mfma_f32_16x16x32_bf16 v[124:127], v[156:159], v[216:219], v[124:127]
    s_waitcnt vmcnt(6)
    s_barrier
    s_waitcnt lgkmcnt(12)
    v_mfma_f32_16x16x32_bf16 v[32:35], v[128:131], v[220:223], v[32:35]
    ds_read_b64_tr_b16 v[156:157], v23 offset:40960
    v_lshlrev_b32 v10, 16, v24
    v_and_b32 v11, 0xffff0000, v24
    v_lshlrev_b32 v12, 16, v25
    v_and_b32 v13, 0xffff0000, v25
    v_mfma_f32_16x16x32_bf16 v[36:39], v[128:131], v[224:227], v[36:39]
    ds_read_b64_tr_b16 v[158:159], v23 offset:45056
    v_pk_add_f32 v[80:81], v[80:81], v[10:11]
    v_pk_add_f32 v[82:83], v[82:83], v[12:13]
    v_pk_add_f32 v[84:85], v[84:85], v[10:11]
    v_mfma_f32_16x16x32_bf16 v[40:43], v[128:131], v[228:231], v[40:43]
    v_pk_add_f32 v[86:87], v[86:87], v[12:13]
    v_pk_add_f32 v[88:89], v[88:89], v[10:11]
    v_pk_add_f32 v[90:91], v[90:91], v[12:13]
    s_waitcnt lgkmcnt(12)
    v_mfma_f32_16x16x32_bf16 v[44:47], v[132:135], v[220:223], v[44:47]
    ds_read_b64_tr_b16 v[128:129], v16 offset:49152
    v_lshlrev_b32 v10, 16, v26
    v_and_b32 v11, 0xffff0000, v26
    v_lshlrev_b32 v12, 16, v27
    v_and_b32 v13, 0xffff0000, v27
    v_mfma_f32_16x16x32_bf16 v[48:51], v[132:135], v[224:227], v[48:51]
    ds_read_b64_tr_b16 v[130:131], v16 offset:53248
    v_pk_add_f32 v[92:93], v[92:93], v[10:11]
    v_pk_add_f32 v[94:95], v[94:95], v[12:13]
    v_pk_add_f32 v[96:97], v[96:97], v[10:11]
    v_mfma_f32_16x16x32_bf16 v[52:55], v[132:135], v[228:231], v[52:55]
    v_pk_add_f32 v[98:99], v[98:99], v[12:13]
    v_pk_add_f32 v[100:101], v[100:101], v[10:11]
    v_pk_add_f32 v[102:103], v[102:103], v[12:13]
    s_waitcnt lgkmcnt(12)
    v_mfma_f32_16x16x32_bf16 v[56:59], v[136:139], v[220:223], v[56:59]
    ds_read_b64_tr_b16 v[132:133], v17 offset:49152
    v_lshlrev_b32 v10, 16, v28
    v_and_b32 v11, 0xffff0000, v28
    v_lshlrev_b32 v12, 16, v29
    v_and_b32 v13, 0xffff0000, v29
    v_mfma_f32_16x16x32_bf16 v[60:63], v[136:139], v[224:227], v[60:63]
    ds_read_b64_tr_b16 v[134:135], v17 offset:53248
    v_pk_add_f32 v[104:105], v[104:105], v[10:11]
    v_pk_add_f32 v[106:107], v[106:107], v[12:13]
    v_pk_add_f32 v[108:109], v[108:109], v[10:11]
    v_mfma_f32_16x16x32_bf16 v[64:67], v[136:139], v[228:231], v[64:67]
    v_pk_add_f32 v[110:111], v[110:111], v[12:13]
    v_pk_add_f32 v[112:113], v[112:113], v[10:11]
    v_pk_add_f32 v[114:115], v[114:115], v[12:13]
    s_waitcnt lgkmcnt(12)
    v_mfma_f32_16x16x32_bf16 v[68:71], v[140:143], v[220:223], v[68:71]
    ds_read_b64_tr_b16 v[136:137], v18 offset:49152
    v_lshlrev_b32 v10, 16, v30
    v_and_b32 v11, 0xffff0000, v30
    v_lshlrev_b32 v12, 16, v31
    v_and_b32 v13, 0xffff0000, v31
    v_mfma_f32_16x16x32_bf16 v[72:75], v[140:143], v[224:227], v[72:75]
    ds_read_b64_tr_b16 v[138:139], v18 offset:53248
    v_pk_add_f32 v[116:117], v[116:117], v[10:11]
    v_pk_add_f32 v[118:119], v[118:119], v[12:13]
    v_pk_add_f32 v[120:121], v[120:121], v[10:11]
    v_mfma_f32_16x16x32_bf16 v[76:79], v[140:143], v[228:231], v[76:79]
    v_pk_add_f32 v[122:123], v[122:123], v[12:13]
    v_pk_add_f32 v[124:125], v[124:125], v[10:11]
    v_pk_add_f32 v[126:127], v[126:127], v[12:13]
    s_waitcnt lgkmcnt(12)
    v_mfma_f32_16x16x32_bf16 v[80:83], v[144:147], v[220:223], v[80:83]
    ds_read_b64_tr_b16 v[140:141], v19 offset:49152
    v_mfma_f32_16x16x32_bf16 v[84:87], v[144:147], v[224:227], v[84:87]
    ds_read_b64_tr_b16 v[142:143], v19 offset:53248
    v_mfma_f32_16x16x32_bf16 v[88:91], v[144:147], v[228:231], v[88:91]
    s_waitcnt lgkmcnt(12)
    v_mfma_f32_16x16x32_bf16 v[92:95], v[148:151], v[220:223], v[92:95]
    ds_read_b64_tr_b16 v[144:145], v20 offset:49152
    v_mfma_f32_16x16x32_bf16 v[96:99], v[148:151], v[224:227], v[96:99]
    ds_read_b64_tr_b16 v[146:147], v20 offset:53248
    v_mfma_f32_16x16x32_bf16 v[100:103], v[148:151], v[228:231], v[100:103]
    s_waitcnt lgkmcnt(12)
    v_mfma_f32_16x16x32_bf16 v[104:107], v[152:155], v[220:223], v[104:107]
    ds_read_b64_tr_b16 v[148:149], v21 offset:49152
    v_mfma_f32_16x16x32_bf16 v[108:111], v[152:155], v[224:227], v[108:111]
    ds_read_b64_tr_b16 v[150:151], v21 offset:53248
    v_mfma_f32_16x16x32_bf16 v[112:115], v[152:155], v[228:231], v[112:115]
    s_waitcnt lgkmcnt(12)
    v_mfma_f32_16x16x32_bf16 v[116:119], v[156:159], v[220:223], v[116:119]
    ds_read_b64_tr_b16 v[152:153], v22 offset:49152
    v_mfma_f32_16x16x32_bf16 v[120:123], v[156:159], v[224:227], v[120:123]
    ds_read_b64_tr_b16 v[154:155], v22 offset:53248
    v_mfma_f32_16x16x32_bf16 v[124:127], v[156:159], v[228:231], v[124:127]
    s_waitcnt vmcnt(3)
    s_barrier
    s_waitcnt lgkmcnt(12)
    v_mfma_f32_16x16x32_bf16 v[32:35], v[128:131], v[232:235], v[32:35]
    ds_read_b64_tr_b16 v[156:157], v23 offset:49152
    v_mfma_f32_16x16x32_bf16 v[36:39], v[128:131], v[236:239], v[36:39]
    ds_read_b64_tr_b16 v[158:159], v23 offset:53248
    v_mfma_f32_16x16x32_bf16 v[40:43], v[128:131], v[240:243], v[40:43]
    s_waitcnt lgkmcnt(12)
    v_mfma_f32_16x16x32_bf16 v[44:47], v[132:135], v[232:235], v[44:47]
    ds_read_b64_tr_b16 v[128:129], v16 offset:57344
    v_mfma_f32_16x16x32_bf16 v[48:51], v[132:135], v[236:239], v[48:51]
    ds_read_b64_tr_b16 v[130:131], v16 offset:61440
    v_mfma_f32_16x16x32_bf16 v[52:55], v[132:135], v[240:243], v[52:55]
    s_waitcnt lgkmcnt(12)
    v_mfma_f32_16x16x32_bf16 v[56:59], v[136:139], v[232:235], v[56:59]
    ds_read_b64_tr_b16 v[132:133], v17 offset:57344
    v_mfma_f32_16x16x32_bf16 v[60:63], v[136:139], v[236:239], v[60:63]
    ds_read_b64_tr_b16 v[134:135], v17 offset:61440
    v_mfma_f32_16x16x32_bf16 v[64:67], v[136:139], v[240:243], v[64:67]
    s_waitcnt lgkmcnt(12)
    v_mfma_f32_16x16x32_bf16 v[68:71], v[140:143], v[232:235], v[68:71]
    ds_read_b64_tr_b16 v[136:137], v18 offset:57344
    v_mfma_f32_16x16x32_bf16 v[72:75], v[140:143], v[236:239], v[72:75]
    ds_read_b64_tr_b16 v[138:139], v18 offset:61440
    v_mfma_f32_16x16x32_bf16 v[76:79], v[140:143], v[240:243], v[76:79]
    s_waitcnt lgkmcnt(12)
    v_mfma_f32_16x16x32_bf16 v[80:83], v[144:147], v[232:235], v[80:83]
    ds_read_b64_tr_b16 v[140:141], v19 offset:57344
    v_mfma_f32_16x16x32_bf16 v[84:87], v[144:147], v[236:239], v[84:87]
    ds_read_b64_tr_b16 v[142:143], v19 offset:61440
    v_mfma_f32_16x16x32_bf16 v[88:91], v[144:147], v[240:243], v[88:91]
    s_waitcnt lgkmcnt(12)
    v_mfma_f32_16x16x32_bf16 v[92:95], v[148:151], v[232:235], v[92:95]
    ds_read_b64_tr_b16 v[144:145], v20 offset:57344
    v_mfma_f32_16x16x32_bf16 v[96:99], v[148:151], v[236:239], v[96:99]
    ds_read_b64_tr_b16 v[146:147], v20 offset:61440
    v_mfma_f32_16x16x32_bf16 v[100:103], v[148:151], v[240:243], v[100:103]
    s_waitcnt lgkmcnt(12)
    v_mfma_f32_16x16x32_bf16 v[104:107], v[152:155], v[232:235], v[104:107]
    ds_read_b64_tr_b16 v[148:149], v21 offset:57344
    v_mfma_f32_16x16x32_bf16 v[108:111], v[152:155], v[236:239], v[108:111]
    ds_read_b64_tr_b16 v[150:151], v21 offset:61440
    v_mfma_f32_16x16x32_bf16 v[112:115], v[152:155], v[240:243], v[112:115]
    s_waitcnt lgkmcnt(12)
    v_mfma_f32_16x16x32_bf16 v[116:119], v[156:159], v[232:235], v[116:119]
    ds_read_b64_tr_b16 v[152:153], v22 offset:57344
    v_mfma_f32_16x16x32_bf16 v[120:123], v[156:159], v[236:239], v[120:123]
    ds_read_b64_tr_b16 v[154:155], v22 offset:61440
    v_mfma_f32_16x16x32_bf16 v[124:127], v[156:159], v[240:243], v[124:127]
    s_waitcnt vmcnt(0)
    s_barrier
    s_waitcnt lgkmcnt(12)
    v_mfma_f32_16x16x32_bf16 v[32:35], v[128:131], v[244:247], v[32:35]
    ds_read_b64_tr_b16 v[156:157], v23 offset:57344
    v_mfma_f32_16x16x32_bf16 v[36:39], v[128:131], v[248:251], v[36:39]
    ds_read_b64_tr_b16 v[158:159], v23 offset:61440
    v_mfma_f32_16x16x32_bf16 v[40:43], v[128:131], v[252:255], v[40:43]
    s_waitcnt lgkmcnt(12)
    v_mfma_f32_16x16x32_bf16 v[44:47], v[132:135], v[244:247], v[44:47]
    v_mfma_f32_16x16x32_bf16 v[48:51], v[132:135], v[248:251], v[48:51]
    v_mfma_f32_16x16x32_bf16 v[52:55], v[132:135], v[252:255], v[52:55]
    s_waitcnt lgkmcnt(10)
    v_mfma_f32_16x16x32_bf16 v[56:59], v[136:139], v[244:247], v[56:59]
    ds_write_b128 v2, v[32:35] offset:0
    v_mfma_f32_16x16x32_bf16 v[60:63], v[136:139], v[248:251], v[60:63]
    ds_write_b128 v2, v[36:39] offset:1024
    v_mfma_f32_16x16x32_bf16 v[64:67], v[136:139], v[252:255], v[64:67]
    ds_write_b128 v2, v[40:43] offset:2048
    s_waitcnt lgkmcnt(11)
    v_mfma_f32_16x16x32_bf16 v[68:71], v[140:143], v[244:247], v[68:71]
    ds_write_b128 v2, v[44:47] offset:3072
    v_mfma_f32_16x16x32_bf16 v[72:75], v[140:143], v[248:251], v[72:75]
    ds_write_b128 v2, v[48:51] offset:4096
    v_mfma_f32_16x16x32_bf16 v[76:79], v[140:143], v[252:255], v[76:79]
    ds_write_b128 v2, v[52:55] offset:5120
    s_waitcnt lgkmcnt(12)
    v_mfma_f32_16x16x32_bf16 v[80:83], v[144:147], v[244:247], v[80:83]
    ds_write_b128 v2, v[56:59] offset:6144
    v_mfma_f32_16x16x32_bf16 v[84:87], v[144:147], v[248:251], v[84:87]
    ds_write_b128 v2, v[60:63] offset:7168
    v_mfma_f32_16x16x32_bf16 v[88:91], v[144:147], v[252:255], v[88:91]
    ds_write_b128 v2, v[64:67] offset:8192
    s_waitcnt lgkmcnt(13)
    v_mfma_f32_16x16x32_bf16 v[92:95], v[148:151], v[244:247], v[92:95]
    ds_write_b128 v2, v[68:71] offset:9216
    v_mfma_f32_16x16x32_bf16 v[96:99], v[148:151], v[248:251], v[96:99]
    ds_write_b128 v2, v[72:75] offset:10240
    v_mfma_f32_16x16x32_bf16 v[100:103], v[148:151], v[252:255], v[100:103]
    ds_write_b128 v2, v[76:79] offset:11264
    s_waitcnt lgkmcnt(14)
    v_mfma_f32_16x16x32_bf16 v[104:107], v[152:155], v[244:247], v[104:107]
    v_mfma_f32_16x16x32_bf16 v[108:111], v[152:155], v[248:251], v[108:111]
    v_mfma_f32_16x16x32_bf16 v[112:115], v[152:155], v[252:255], v[112:115]
    s_waitcnt lgkmcnt(12)
    v_mfma_f32_16x16x32_bf16 v[116:119], v[156:159], v[244:247], v[116:119]
    v_mfma_f32_16x16x32_bf16 v[120:123], v[156:159], v[248:251], v[120:123]
    v_mfma_f32_16x16x32_bf16 v[124:127], v[156:159], v[252:255], v[124:127]
    s_waitcnt lgkmcnt(0)
    s_barrier
    s_setprio 2
    ds_read_b128 v[160:163], v3 offset:0
    ds_read_b128 v[172:175], v3 offset:3072
    ds_read_b128 v[164:167], v3 offset:1024
    ds_read_b128 v[176:179], v3 offset:4096
    ds_read_b128 v[168:171], v3 offset:2048
    ds_read_b128 v[180:183], v3 offset:5120
    ds_read_b128 v[184:187], v3 offset:6144
    ds_read_b128 v[196:199], v3 offset:9216
    ds_read_b128 v[188:191], v3 offset:7168
    ds_read_b128 v[200:203], v3 offset:10240
    ds_read_b128 v[192:195], v3 offset:8192
    ds_read_b128 v[204:207], v3 offset:11264
    s_waitcnt lgkmcnt(10)
    v_pk_add_f32 v[80:81], v[80:81], v[160:161]
    v_pk_add_f32 v[82:83], v[82:83], v[162:163]
    v_pk_add_f32 v[92:93], v[92:93], v[172:173]
    v_pk_add_f32 v[94:95], v[94:95], v[174:175]
    v_pk_mul_f32 v[16:17], v[80:81], v[80:81]
    v_pk_mul_f32 v[18:19], v[82:83], v[82:83]
    v_pk_mul_f32 v[20:21], v[92:93], v[92:93]
    v_pk_mul_f32 v[22:23], v[94:95], v[94:95]
    v_pk_fma_f32 v[16:17], v[16:17], s[44:45], v[14:15]
    v_pk_fma_f32 v[18:19], v[18:19], s[44:45], v[14:15]
    v_pk_fma_f32 v[20:21], v[20:21], s[44:45], v[14:15]
    v_pk_fma_f32 v[22:23], v[22:23], s[44:45], v[14:15]
    v_pk_mul_f32 v[16:17], v[16:17], v[80:81]
    v_pk_mul_f32 v[18:19], v[18:19], v[82:83]
    v_pk_mul_f32 v[20:21], v[20:21], v[92:93]
    v_pk_mul_f32 v[22:23], v[22:23], v[94:95]
    v_exp_f32 v16, v16
    v_exp_f32 v17, v17
    v_exp_f32 v18, v18
    v_exp_f32 v19, v19
    v_exp_f32 v20, v20
    v_exp_f32 v21, v21
    v_exp_f32 v22, v22
    v_exp_f32 v23, v23
    v_pk_add_f32 v[16:17], v[16:17], 1.0 op_sel_hi:[1,0]
    v_pk_add_f32 v[18:19], v[18:19], 1.0 op_sel_hi:[1,0]
    v_pk_add_f32 v[20:21], v[20:21], 1.0 op_sel_hi:[1,0]
    v_pk_add_f32 v[22:23], v[22:23], 1.0 op_sel_hi:[1,0]
    v_rcp_f32 v16, v16
    v_rcp_f32 v17, v17
    v_rcp_f32 v18, v18
    v_rcp_f32 v19, v19
    v_rcp_f32 v20, v20
    v_rcp_f32 v21, v21
    v_rcp_f32 v22, v22
    v_rcp_f32 v23, v23
    v_pk_mul_f32 v[80:81], v[16:17], v[80:81]
    v_pk_mul_f32 v[82:83], v[18:19], v[82:83]
    v_pk_mul_f32 v[92:93], v[20:21], v[92:93]
    v_pk_mul_f32 v[94:95], v[22:23], v[94:95]
    v_cvt_pk_bf16_f32 v128, v80, v81
    v_cvt_pk_bf16_f32 v129, v82, v83
    v_cvt_pk_bf16_f32 v130, v92, v93
    v_cvt_pk_bf16_f32 v131, v94, v95
    buffer_store_dwordx4 v[128:131], v1, s[20:23], s42 offen offset:0 sc1
    s_waitcnt lgkmcnt(0)
    s_barrier
    v_pk_add_f32 v[84:85], v[84:85], v[164:165]
    v_pk_add_f32 v[86:87], v[86:87], v[166:167]
    v_pk_add_f32 v[96:97], v[96:97], v[176:177]
    v_pk_add_f32 v[98:99], v[98:99], v[178:179]
    v_pk_mul_f32 v[16:17], v[84:85], v[84:85]
    v_pk_mul_f32 v[18:19], v[86:87], v[86:87]
    v_pk_mul_f32 v[20:21], v[96:97], v[96:97]
    v_pk_mul_f32 v[22:23], v[98:99], v[98:99]
    v_pk_fma_f32 v[16:17], v[16:17], s[44:45], v[14:15]
    v_pk_fma_f32 v[18:19], v[18:19], s[44:45], v[14:15]
    v_pk_fma_f32 v[20:21], v[20:21], s[44:45], v[14:15]
    v_pk_fma_f32 v[22:23], v[22:23], s[44:45], v[14:15]
    v_pk_mul_f32 v[16:17], v[16:17], v[84:85]
    v_pk_mul_f32 v[18:19], v[18:19], v[86:87]
    v_pk_mul_f32 v[20:21], v[20:21], v[96:97]
    v_pk_mul_f32 v[22:23], v[22:23], v[98:99]
    v_exp_f32 v16, v16
    v_exp_f32 v17, v17
    v_exp_f32 v18, v18
    v_exp_f32 v19, v19
    v_exp_f32 v20, v20
    v_exp_f32 v21, v21
    v_exp_f32 v22, v22
    v_exp_f32 v23, v23
    v_pk_add_f32 v[16:17], v[16:17], 1.0 op_sel_hi:[1,0]
    v_pk_add_f32 v[18:19], v[18:19], 1.0 op_sel_hi:[1,0]
    v_pk_add_f32 v[20:21], v[20:21], 1.0 op_sel_hi:[1,0]
    v_pk_add_f32 v[22:23], v[22:23], 1.0 op_sel_hi:[1,0]
    v_rcp_f32 v16, v16
    v_rcp_f32 v17, v17
    v_rcp_f32 v18, v18
    v_rcp_f32 v19, v19
    v_rcp_f32 v20, v20
    v_rcp_f32 v21, v21
    v_rcp_f32 v22, v22
    v_rcp_f32 v23, v23
    v_pk_mul_f32 v[84:85], v[16:17], v[84:85]
    v_pk_mul_f32 v[86:87], v[18:19], v[86:87]
    v_pk_mul_f32 v[96:97], v[20:21], v[96:97]
    v_pk_mul_f32 v[98:99], v[22:23], v[98:99]
    v_cvt_pk_bf16_f32 v132, v84, v85
    v_cvt_pk_bf16_f32 v133, v86, v87
    v_cvt_pk_bf16_f32 v134, v96, v97
    v_cvt_pk_bf16_f32 v135, v98, v99
    buffer_store_dwordx4 v[132:135], v1, s[20:23], s42 offen offset:1024 sc1
    v_pk_add_f32 v[88:89], v[88:89], v[168:169]
    v_pk_add_f32 v[90:91], v[90:91], v[170:171]
    v_pk_add_f32 v[100:101], v[100:101], v[180:181]
    v_pk_add_f32 v[102:103], v[102:103], v[182:183]
    v_pk_mul_f32 v[16:17], v[88:89], v[88:89]
    v_pk_mul_f32 v[18:19], v[90:91], v[90:91]
    v_pk_mul_f32 v[20:21], v[100:101], v[100:101]
    v_pk_mul_f32 v[22:23], v[102:103], v[102:103]
    v_pk_fma_f32 v[16:17], v[16:17], s[44:45], v[14:15]
    v_pk_fma_f32 v[18:19], v[18:19], s[44:45], v[14:15]
    v_pk_fma_f32 v[20:21], v[20:21], s[44:45], v[14:15]
    v_pk_fma_f32 v[22:23], v[22:23], s[44:45], v[14:15]
    v_pk_mul_f32 v[16:17], v[16:17], v[88:89]
    v_pk_mul_f32 v[18:19], v[18:19], v[90:91]
    v_pk_mul_f32 v[20:21], v[20:21], v[100:101]
    v_pk_mul_f32 v[22:23], v[22:23], v[102:103]
    v_exp_f32 v16, v16
    v_exp_f32 v17, v17
    v_exp_f32 v18, v18
    v_exp_f32 v19, v19
    v_exp_f32 v20, v20
    v_exp_f32 v21, v21
    v_exp_f32 v22, v22
    v_exp_f32 v23, v23
    v_pk_add_f32 v[16:17], v[16:17], 1.0 op_sel_hi:[1,0]
    v_pk_add_f32 v[18:19], v[18:19], 1.0 op_sel_hi:[1,0]
    v_pk_add_f32 v[20:21], v[20:21], 1.0 op_sel_hi:[1,0]
    v_pk_add_f32 v[22:23], v[22:23], 1.0 op_sel_hi:[1,0]
    v_rcp_f32 v16, v16
    v_rcp_f32 v17, v17
    v_rcp_f32 v18, v18
    v_rcp_f32 v19, v19
    v_rcp_f32 v20, v20
    v_rcp_f32 v21, v21
    v_rcp_f32 v22, v22
    v_rcp_f32 v23, v23
    v_pk_mul_f32 v[88:89], v[16:17], v[88:89]
    v_pk_mul_f32 v[90:91], v[18:19], v[90:91]
    v_pk_mul_f32 v[100:101], v[20:21], v[100:101]
    v_pk_mul_f32 v[102:103], v[22:23], v[102:103]
    v_cvt_pk_bf16_f32 v136, v88, v89
    v_cvt_pk_bf16_f32 v137, v90, v91
    v_cvt_pk_bf16_f32 v138, v100, v101
    v_cvt_pk_bf16_f32 v139, v102, v103
    buffer_store_dwordx4 v[136:139], v1, s[20:23], s42 offen offset:2048 sc1
    s_add_u32 s42, s42, 3072
    v_pk_add_f32 v[104:105], v[104:105], v[184:185]
    v_pk_add_f32 v[106:107], v[106:107], v[186:187]
    v_pk_add_f32 v[116:117], v[116:117], v[196:197]
    v_pk_add_f32 v[118:119], v[118:119], v[198:199]
    v_pk_mul_f32 v[16:17], v[104:105], v[104:105]
    v_pk_mul_f32 v[18:19], v[106:107], v[106:107]
    v_pk_mul_f32 v[20:21], v[116:117], v[116:117]
    v_pk_mul_f32 v[22:23], v[118:119], v[118:119]
    v_pk_fma_f32 v[16:17], v[16:17], s[44:45], v[14:15]
    v_pk_fma_f32 v[18:19], v[18:19], s[44:45], v[14:15]
    v_pk_fma_f32 v[20:21], v[20:21], s[44:45], v[14:15]
    v_pk_fma_f32 v[22:23], v[22:23], s[44:45], v[14:15]
    v_pk_mul_f32 v[16:17], v[16:17], v[104:105]
    v_pk_mul_f32 v[18:19], v[18:19], v[106:107]
    v_pk_mul_f32 v[20:21], v[20:21], v[116:117]
    v_pk_mul_f32 v[22:23], v[22:23], v[118:119]
    v_exp_f32 v16, v16
    v_exp_f32 v17, v17
    v_exp_f32 v18, v18
    v_exp_f32 v19, v19
    v_exp_f32 v20, v20
    v_exp_f32 v21, v21
    v_exp_f32 v22, v22
    v_exp_f32 v23, v23
    v_pk_add_f32 v[16:17], v[16:17], 1.0 op_sel_hi:[1,0]
    v_pk_add_f32 v[18:19], v[18:19], 1.0 op_sel_hi:[1,0]
    v_pk_add_f32 v[20:21], v[20:21], 1.0 op_sel_hi:[1,0]
    v_pk_add_f32 v[22:23], v[22:23], 1.0 op_sel_hi:[1,0]
    v_rcp_f32 v16, v16
    v_rcp_f32 v17, v17
    v_rcp_f32 v18, v18
    v_rcp_f32 v19, v19
    v_rcp_f32 v20, v20
    v_rcp_f32 v21, v21
    v_rcp_f32 v22, v22
    v_rcp_f32 v23, v23
    v_pk_mul_f32 v[104:105], v[16:17], v[104:105]
    v_pk_mul_f32 v[106:107], v[18:19], v[106:107]
    v_pk_mul_f32 v[116:117], v[20:21], v[116:117]
    v_pk_mul_f32 v[118:119], v[22:23], v[118:119]
    v_cvt_pk_bf16_f32 v140, v104, v105
    v_cvt_pk_bf16_f32 v141, v106, v107
    v_cvt_pk_bf16_f32 v142, v116, v117
    v_cvt_pk_bf16_f32 v143, v118, v119
    buffer_store_dwordx4 v[140:143], v1, s[20:23], s42 offen offset:0 sc1
    v_pk_add_f32 v[108:109], v[108:109], v[188:189]
    v_pk_add_f32 v[110:111], v[110:111], v[190:191]
    v_pk_add_f32 v[120:121], v[120:121], v[200:201]
    v_pk_add_f32 v[122:123], v[122:123], v[202:203]
    v_pk_mul_f32 v[16:17], v[108:109], v[108:109]
    v_pk_mul_f32 v[18:19], v[110:111], v[110:111]
    v_pk_mul_f32 v[20:21], v[120:121], v[120:121]
    v_pk_mul_f32 v[22:23], v[122:123], v[122:123]
    v_pk_fma_f32 v[16:17], v[16:17], s[44:45], v[14:15]
    v_pk_fma_f32 v[18:19], v[18:19], s[44:45], v[14:15]
    v_pk_fma_f32 v[20:21], v[20:21], s[44:45], v[14:15]
    v_pk_fma_f32 v[22:23], v[22:23], s[44:45], v[14:15]
    v_pk_mul_f32 v[16:17], v[16:17], v[108:109]
    v_pk_mul_f32 v[18:19], v[18:19], v[110:111]
    v_pk_mul_f32 v[20:21], v[20:21], v[120:121]
    v_pk_mul_f32 v[22:23], v[22:23], v[122:123]
    v_exp_f32 v16, v16
    v_exp_f32 v17, v17
    v_exp_f32 v18, v18
    v_exp_f32 v19, v19
    v_exp_f32 v20, v20
    v_exp_f32 v21, v21
    v_exp_f32 v22, v22
    v_exp_f32 v23, v23
    v_pk_add_f32 v[16:17], v[16:17], 1.0 op_sel_hi:[1,0]
    v_pk_add_f32 v[18:19], v[18:19], 1.0 op_sel_hi:[1,0]
    v_pk_add_f32 v[20:21], v[20:21], 1.0 op_sel_hi:[1,0]
    v_pk_add_f32 v[22:23], v[22:23], 1.0 op_sel_hi:[1,0]
    v_rcp_f32 v16, v16
    v_rcp_f32 v17, v17
    v_rcp_f32 v18, v18
    v_rcp_f32 v19, v19
    v_rcp_f32 v20, v20
    v_rcp_f32 v21, v21
    v_rcp_f32 v22, v22
    v_rcp_f32 v23, v23
    v_pk_mul_f32 v[108:109], v[16:17], v[108:109]
    v_pk_mul_f32 v[110:111], v[18:19], v[110:111]
    v_pk_mul_f32 v[120:121], v[20:21], v[120:121]
    v_pk_mul_f32 v[122:123], v[22:23], v[122:123]
    v_cvt_pk_bf16_f32 v144, v108, v109
    v_cvt_pk_bf16_f32 v145, v110, v111
    v_cvt_pk_bf16_f32 v146, v120, v121
    v_cvt_pk_bf16_f32 v147, v122, v123
    buffer_store_dwordx4 v[144:147], v1, s[20:23], s42 offen offset:1024 sc1
    v_pk_add_f32 v[112:113], v[112:113], v[192:193]
    v_pk_add_f32 v[114:115], v[114:115], v[194:195]
    v_pk_add_f32 v[124:125], v[124:125], v[204:205]
    v_pk_add_f32 v[126:127], v[126:127], v[206:207]
    v_pk_mul_f32 v[16:17], v[112:113], v[112:113]
    v_pk_mul_f32 v[18:19], v[114:115], v[114:115]
    v_pk_mul_f32 v[20:21], v[124:125], v[124:125]
    v_pk_mul_f32 v[22:23], v[126:127], v[126:127]
    v_pk_fma_f32 v[16:17], v[16:17], s[44:45], v[14:15]
    v_pk_fma_f32 v[18:19], v[18:19], s[44:45], v[14:15]
    v_pk_fma_f32 v[20:21], v[20:21], s[44:45], v[14:15]
    v_pk_fma_f32 v[22:23], v[22:23], s[44:45], v[14:15]
    v_pk_mul_f32 v[16:17], v[16:17], v[112:113]
    v_pk_mul_f32 v[18:19], v[18:19], v[114:115]
    v_pk_mul_f32 v[20:21], v[20:21], v[124:125]
    v_pk_mul_f32 v[22:23], v[22:23], v[126:127]
    v_exp_f32 v16, v16
    v_exp_f32 v17, v17
    v_exp_f32 v18, v18
    v_exp_f32 v19, v19
    v_exp_f32 v20, v20
    v_exp_f32 v21, v21
    v_exp_f32 v22, v22
    v_exp_f32 v23, v23
    v_pk_add_f32 v[16:17], v[16:17], 1.0 op_sel_hi:[1,0]
    v_pk_add_f32 v[18:19], v[18:19], 1.0 op_sel_hi:[1,0]
    v_pk_add_f32 v[20:21], v[20:21], 1.0 op_sel_hi:[1,0]
    v_pk_add_f32 v[22:23], v[22:23], 1.0 op_sel_hi:[1,0]
    v_rcp_f32 v16, v16
    v_rcp_f32 v17, v17
    v_rcp_f32 v18, v18
    v_rcp_f32 v19, v19
    v_rcp_f32 v20, v20
    v_rcp_f32 v21, v21
    v_rcp_f32 v22, v22
    v_rcp_f32 v23, v23
    v_pk_mul_f32 v[112:113], v[16:17], v[112:113]
    v_pk_mul_f32 v[114:115], v[18:19], v[114:115]
    v_pk_mul_f32 v[124:125], v[20:21], v[124:125]
    v_pk_mul_f32 v[126:127], v[22:23], v[126:127]
    v_cvt_pk_bf16_f32 v148, v112, v113
    v_cvt_pk_bf16_f32 v149, v114, v115
    v_cvt_pk_bf16_f32 v150, v124, v125
    v_cvt_pk_bf16_f32 v151, v126, v127
    buffer_store_dwordx4 v[148:151], v1, s[20:23], s42 offen offset:2048 sc1
    s_setprio 0
    s_mov_b64 exec, 1
    s_waitcnt vmcnt(0)
    v_mov_b64 v[10:11], s[96:97]
    buffer_store_dwordx2 v[10:11], off, s[8:11], s47 sc1
    s_mov_b64 exec, -1
.c2_8:
    s_and_b32 s31, s2, 3
    s_bfe_u32 s33, s2, 0x10002
    s_lshl_b32 s33, s33, 3
    s_lshr_b32 s3, s2, 5
    s_add_u32 s33, s33, s3
    s_lshl_b32 s34, s33, 2
    s_add_u32 s34, s34, s29
    v_and_b32 v7, 15, v0
    v_lshrrev_b32 v8, 4, v0
    v_lshlrev_b32 v1, 4, v0
    v_lshrrev_b32 v2, 2, v7
    v_lshl_add_u32 v2, v8, 2, v2
    v_and_b32 v3, 7, v2
    s_lshl_b32 s3, s30, 1
    v_xor_b32 v3, s3, v3
    v_lshlrev_b32 v2, 8, v2
    v_lshl_add_u32 v2, v3, 5, v2
    v_and_b32 v3, 3, v7
    v_lshl_add_u32 v2, v3, 3, v2
    v_add_u32 v2, 65536, v2
    v_xor_b32 v3, 32, v2
    v_mov_b32 v9, 64512
    v_mov_b32 v10, 0
    ds_write_b32 v9, v10
    v_mov_b64 v[32:33], 0
    v_mov_b64 v[34:35], 0
    v_mov_b64 v[36:37], 0
    v_mov_b64 v[38:39], 0
    v_mov_b64 v[40:41], 0
    v_mov_b64 v[42:43], 0
    v_mov_b64 v[44:45], 0
    v_mov_b64 v[46:47], 0
    v_mov_b64 v[48:49], 0
    v_mov_b64 v[50:51], 0
    v_mov_b64 v[52:53], 0
    v_mov_b64 v[54:55], 0
    v_mov_b64 v[56:57], 0
    v_mov_b64 v[58:59], 0
    v_mov_b64 v[60:61], 0
    v_mov_b64 v[62:63], 0
    v_mov_b64 v[64:65], 0
    v_mov_b64 v[66:67], 0
    v_mov_b64 v[68:69], 0
    v_mov_b64 v[70:71], 0
    v_mov_b64 v[72:73], 0
    v_mov_b64 v[74:75], 0
    v_mov_b64 v[76:77], 0
    v_mov_b64 v[78:79], 0
    v_mov_b64 v[80:81], 0
    v_mov_b64 v[82:83], 0
    v_mov_b64 v[84:85], 0
    v_mov_b64 v[86:87], 0
    v_mov_b64 v[88:89], 0
    v_mov_b64 v[90:91], 0
    v_mov_b64 v[92:93], 0
    v_mov_b64 v[94:95], 0
    v_mov_b64 v[96:97], 0
    v_mov_b64 v[98:99], 0
    v_mov_b64 v[100:101], 0
    v_mov_b64 v[102:103], 0
    s_lshl_b32 s3, s34, 2
    s_add_u32 s43, s3, s30
    s_add_u32 s3, s3, s30
    s_lshl_b32 s3, s3, 2
    s_add_u32 s3, s3, s31
    s_mul_i32 s42, s3, 9216
    s_lshl_b32 s43, s43, 7
    s_add_u32 s43, s43, 196608
    s_mul_i32 s3, s31, 32
    s_add_u32 s43, s43, s3
    v_mov_b64 v[12:13], s[96:97]
    s_mov_b32 s40, 0
    s_mov_b32 s44, 0
    s_mov_b32 s41, 18
    s_add_u32 s12, s74, 12664832
    s_addc_u32 s13, s75, 0
    s_mov_b32 s14, 9437184
    s_mov_b32 s15, 0x20000
    s_add_u32 s40, s40, 9216
    s_cmp_eq_u32 s40, 64512
    s_cselect_b32 s40, 0, s40
    s_add_u32 s44, s44, 8192
    s_cmp_eq_u32 s44, 98304
    s_cselect_b32 s44, 0, s44
    v_add_u32 v4, s40, v1
    v_add_u32 v5, s44, v2
    v_add_u32 v6, s44, v3
    s_lshr_b32 s49, s2, 3
    s_lshl_b32 s49, s49, 2
    s_add_u32 s49, s49, s30
    s_add_u32 s49, s49, 200
    s_mov_b32 s16, s64
    s_mov_b32 s17, s65
    s_mov_b32 s18, 18874368
    s_mov_b32 s19, 0x20000
    s_and_b32 s3, s2, 3
    s_mul_i32 s50, s3, 4718592
    s_bfe_u32 s3, s2, 0x10002
    s_lshl_b32 s3, s3, 11
    s_add_u32 s50, s50, s3
    v_lshrrev_b32 v11, 1, v0
    v_mul_u32_u24 v11, 3840, v11
    v_lshl_add_u32 v11, v0, 7, v11
    s_lshr_b32 s51, s49, 3
    s_sub_u32 s3, s51, 12
    s_cselect_b32 s3, 0, s3
    s_mul_i32 s3, s3, 0
    s_add_u32 s51, s51, s3
    s_cmp_ge_u32 s51, 36
    s_cselect_b32 s3, 23, 0
    s_sub_u32 s51, s51, s3
    s_and_b32 s3, s49, 7
    s_mul_i32 s3, s3, 0
    s_lshr_b32 s3, s3, 1
    s_add_u32 s51, s51, s3
    s_sub_u32 s3, s51, 36
    s_cselect_b32 s51, s51, s3
    s_lshl_b32 s51, s51, 9
    s_and_b32 s3, s49, 7
    s_add_u32 s51, s51, s3
    s_lshl_b32 s51, s51, 8
    s_add_u32 s51, s51, s50
    s_cmp_ge_u32 s49, 288
    s_cselect_b32 s18, 0, s18
    s_barrier
    ds_read_b128 v[104:107], v1 offset:0
    ds_read_b64_tr_b16 v[176:177], v2 offset:0
    ds_read_b64_tr_b16 v[178:179], v2 offset:4096
    ds_read_b64_tr_b16 v[180:181], v3 offset:0
    ds_read_b64_tr_b16 v[182:183], v3 offset:4096
    ds_read_b128 v[108:111], v1 offset:1024
    ds_read_b128 v[112:115], v1 offset:2048
    ds_read_b128 v[116:119], v1 offset:3072
    ds_read_b128 v[120:123], v1 offset:4096
    ds_read_b128 v[124:127], v1 offset:5120
    ds_read_b128 v[128:131], v1 offset:6144
    ds_read_b128 v[132:135], v1 offset:7168
    ds_read_b128 v[136:139], v1 offset:8192
    buffer_load_dword v250, v11, s[16:19], s51 offen
.g2loop_31:
    s_waitcnt lgkmcnt(0)
    s_barrier
    v_mfma_f32_16x16x32_bf16 v[32:35], v[104:107], v[176:179], v[32:35]
    ds_read_b128 v[140:143], v4 offset:0
    v_mfma_f32_16x16x32_bf16 v[36:39], v[104:107], v[180:183], v[36:39]
    ds_read_b64_tr_b16 v[184:185], v5 offset:0
    v_mfma_f32_16x16x32_bf16 v[40:43], v[108:111], v[176:179], v[40:43]
    ds_read_b64_tr_b16 v[186:187], v5 offset:4096
    v_mfma_f32_16x16x32_bf16 v[44:47], v[108:111], v[180:183], v[44:47]
    ds_read_b64_tr_b16 v[188:189], v6 offset:0
    v_mfma_f32_16x16x32_bf16 v[48:51], v[112:115], v[176:179], v[48:51]
    ds_read_b64_tr_b16 v[190:191], v6 offset:4096
    v_mfma_f32_16x16x32_bf16 v[52:55], v[112:115], v[180:183], v[52:55]
    ds_read_b128 v[144:147], v4 offset:1024
    v_mfma_f32_16x16x32_bf16 v[56:59], v[116:119], v[176:179], v[56:59]
    ds_read_b128 v[148:151], v4 offset:2048
    v_mfma_f32_16x16x32_bf16 v[60:63], v[116:119], v[180:183], v[60:63]
    ds_read_b128 v[152:155], v4 offset:3072
    v_mfma_f32_16x16x32_bf16 v[64:67], v[120:123], v[176:179], v[64:67]
    ds_read_b128 v[156:159], v4 offset:4096
    v_mfma_f32_16x16x32_bf16 v[68:71], v[120:123], v[180:183], v[68:71]
    ds_read_b128 v[160:163], v4 offset:5120
    v_mfma_f32_16x16x32_bf16 v[72:75], v[124:127], v[176:179], v[72:75]
    ds_read_b128 v[164:167], v4 offset:6144
    v_mfma_f32_16x16x32_bf16 v[76:79], v[124:127], v[180:183], v[76:79]
    ds_read_b128 v[168:171], v4 offset:7168
    s_add_u32 s40, s40, 9216
    s_cmp_eq_u32 s40, 64512
    s_cselect_b32 s40, 0, s40
    v_mfma_f32_16x16x32_bf16 v[80:83], v[128:131], v[176:179], v[80:83]
    ds_read_b128 v[172:175], v4 offset:8192
    s_add_u32 s44, s44, 8192
    s_cmp_eq_u32 s44, 98304
    s_cselect_b32 s44, 0, s44
    v_mfma_f32_16x16x32_bf16 v[84:87], v[128:131], v[180:183], v[84:87]
    v_add_u32 v4, s40, v1
    v_mfma_f32_16x16x32_bf16 v[88:91], v[132:135], v[176:179], v[88:91]
    v_add_u32 v5, s44, v2
    v_mfma_f32_16x16x32_bf16 v[92:95], v[132:135], v[180:183], v[92:95]
    v_add_u32 v6, s44, v3
    v_mfma_f32_16x16x32_bf16 v[96:99], v[136:139], v[176:179], v[96:99]
    v_mfma_f32_16x16x32_bf16 v[100:103], v[136:139], v[180:183], v[100:103]
    s_waitcnt lgkmcnt(0)
    v_mfma_f32_16x16x32_bf16 v[32:35], v[140:143], v[184:187], v[32:35]
    ds_read_b128 v[104:107], v4 offset:0
    v_mfma_f32_16x16x32_bf16 v[36:39], v[140:143], v[188:191], v[36:39]
    ds_read_b64_tr_b16 v[176:177], v5 offset:0
    v_mfma_f32_16x16x32_bf16 v[40:43], v[144:147], v[184:187], v[40:43]
    ds_read_b64_tr_b16 v[178:179], v5 offset:4096
    v_mfma_f32_16x16x32_bf16 v[44:47], v[144:147], v[188:191], v[44:47]
    ds_read_b64_tr_b16 v[180:181], v6 offset:0
    v_mfma_f32_16x16x32_bf16 v[48:51], v[148:151], v[184:187], v[48:51]
    ds_read_b64_tr_b16 v[182:183], v6 offset:4096
    v_mfma_f32_16x16x32_bf16 v[52:55], v[148:151], v[188:191], v[52:55]
    ds_read_b128 v[108:111], v4 offset:1024
    v_mfma_f32_16x16x32_bf16 v[56:59], v[152:155], v[184:187], v[56:59]
    ds_read_b128 v[112:115], v4 offset:2048
    v_mfma_f32_16x16x32_bf16 v[60:63], v[152:155], v[188:191], v[60:63]
    ds_read_b128 v[116:119], v4 offset:3072
    v_mfma_f32_16x16x32_bf16 v[64:67], v[156:159], v[184:187], v[64:67]
    ds_read_b128 v[120:123], v4 offset:4096
    v_mfma_f32_16x16x32_bf16 v[68:71], v[156:159], v[188:191], v[68:71]
    ds_read_b128 v[124:127], v4 offset:5120
    v_mfma_f32_16x16x32_bf16 v[72:75], v[160:163], v[184:187], v[72:75]
    ds_read_b128 v[128:131], v4 offset:6144
    v_mfma_f32_16x16x32_bf16 v[76:79], v[160:163], v[188:191], v[76:79]
    ds_read_b128 v[132:135], v4 offset:7168
    s_add_u32 s40, s40, 9216
    s_cmp_eq_u32 s40, 64512
    s_cselect_b32 s40, 0, s40
    v_mfma_f32_16x16x32_bf16 v[80:83], v[164:167], v[184:187], v[80:83]
    ds_read_b128 v[136:139], v4 offset:8192
    s_add_u32 s44, s44, 8192
    s_cmp_eq_u32 s44, 98304
    s_cselect_b32 s44, 0, s44
    v_mfma_f32_16x16x32_bf16 v[84:87], v[164:167], v[188:191], v[84:87]
    v_add_u32 v4, s40, v1
    v_mfma_f32_16x16x32_bf16 v[88:91], v[168:171], v[184:187], v[88:91]
    v_add_u32 v5, s44, v2
    v_mfma_f32_16x16x32_bf16 v[92:95], v[168:171], v[188:191], v[92:95]
    v_add_u32 v6, s44, v3
    v_mfma_f32_16x16x32_bf16 v[96:99], v[172:175], v[184:187], v[96:99]
    s_sub_u32 s41, s41, 1
    s_cmp_lg_u32 s41, 0
    v_mfma_f32_16x16x32_bf16 v[100:103], v[172:175], v[188:191], v[100:103]
    s_cbranch_scc1 .g2loop_31
    s_cmp_eq_u32 s30, s31
    s_cbranch_scc1 .g2own_32
    v_cvt_pk_bf16_f32 v192, v32, v33
    v_cvt_pk_bf16_f32 v193, v34, v35
    v_cvt_pk_bf16_f32 v194, v40, v41
    v_cvt_pk_bf16_f32 v195, v42, v43
    v_cvt_pk_bf16_f32 v196, v48, v49
    v_cvt_pk_bf16_f32 v197, v50, v51
    v_cvt_pk_bf16_f32 v198, v36, v37
    v_cvt_pk_bf16_f32 v199, v38, v39
    v_cvt_pk_bf16_f32 v200, v44, v45
    v_cvt_pk_bf16_f32 v201, v46, v47
    v_cvt_pk_bf16_f32 v202, v52, v53
    v_cvt_pk_bf16_f32 v203, v54, v55
    buffer_store_dwordx4 v[192:195], v1, s[12:15], s42 offen offset:0 sc1
    buffer_store_dwordx4 v[196:199], v1, s[12:15], s42 offen offset:1024 sc1
    buffer_store_dwordx4 v[200:203], v1, s[12:15], s42 offen offset:2048 sc1
    s_add_u32 s42, s42, 3072
    v_cvt_pk_bf16_f32 v204, v56, v57
    v_cvt_pk_bf16_f32 v205, v58, v59
    v_cvt_pk_bf16_f32 v206, v64, v65
    v_cvt_pk_bf16_f32 v207, v66, v67
    v_cvt_pk_bf16_f32 v208, v72, v73
    v_cvt_pk_bf16_f32 v209, v74, v75
    v_cvt_pk_bf16_f32 v210, v60, v61
    v_cvt_pk_bf16_f32 v211, v62, v63
    v_cvt_pk_bf16_f32 v212, v68, v69
    v_cvt_pk_bf16_f32 v213, v70, v71
    v_cvt_pk_bf16_f32 v214, v76, v77
    v_cvt_pk_bf16_f32 v215, v78, v79
    buffer_store_dwordx4 v[204:207], v1, s[12:15], s42 offen offset:0 sc1
    buffer_store_dwordx4 v[208:211], v1, s[12:15], s42 offen offset:1024 sc1
    buffer_store_dwordx4 v[212:215], v1, s[12:15], s42 offen offset:2048 sc1
    s_add_u32 s42, s42, 3072
    v_cvt_pk_bf16_f32 v216, v80, v81
    v_cvt_pk_bf16_f32 v217, v82, v83
    v_cvt_pk_bf16_f32 v218, v88, v89
    v_cvt_pk_bf16_f32 v219, v90, v91
    v_cvt_pk_bf16_f32 v220, v96, v97
    v_cvt_pk_bf16_f32 v221, v98, v99
    v_cvt_pk_bf16_f32 v222, v84, v85
    v_cvt_pk_bf16_f32 v223, v86, v87
    v_cvt_pk_bf16_f32 v224, v92, v93
    v_cvt_pk_bf16_f32 v225, v94, v95
    v_cvt_pk_bf16_f32 v226, v100, v101
    v_cvt_pk_bf16_f32 v227, v102, v103
    buffer_store_dwordx4 v[216:219], v1, s[12:15], s42 offen offset:0 sc1
    buffer_store_dwordx4 v[220:223], v1, s[12:15], s42 offen offset:1024 sc1
    buffer_store_dwordx4 v[224:227], v1, s[12:15], s42 offen offset:2048 sc1
    s_branch .g2join_33
.g2own_32:
    s_nop 7
    v_add_u32 v4, 106496, v1
    ds_write_b128 v4, v[32:35] offset:0
    ds_write_b128 v4, v[36:39] offset:1024
    ds_write_b128 v4, v[40:43] offset:2048
    ds_write_b128 v4, v[44:47] offset:3072
    ds_write_b128 v4, v[48:51] offset:4096
    ds_write_b128 v4, v[52:55] offset:5120
    ds_write_b128 v4, v[56:59] offset:6144
    ds_write_b128 v4, v[60:63] offset:7168
    ds_write_b128 v4, v[64:67] offset:8192
    ds_write_b128 v4, v[68:71] offset:9216
    ds_write_b128 v4, v[72:75] offset:10240
    ds_write_b128 v4, v[76:79] offset:11264
    ds_write_b128 v4, v[80:83] offset:12288
    ds_write_b128 v4, v[84:87] offset:13312
    ds_write_b128 v4, v[88:91] offset:14336
    ds_write_b128 v4, v[92:95] offset:15360
    ds_write_b128 v4, v[96:99] offset:16384
    ds_write_b128 v4, v[100:103] offset:17408
.g2join_33:
    s_waitcnt vmcnt(0) lgkmcnt(0)
    s_mov_b64 exec, 1
    buffer_store_dwordx2 v[12:13], off, s[8:11], s43 sc1
    s_mov_b64 exec, -1
    s_endpgm
.fft_5:
    v_and_b32 v3, 31, v0
    v_lshrrev_b32 v4, 5, v0
    v_lshlrev_b32 v1, 4, v0
    v_add_u32 v2, 110592, v1
    v_lshlrev_b32 v9, 2, v4
    s_and_b32 s41, s30, 1
    s_bfe_u32 s42, s30, 0x10001
    s_lshr_b32 s43, s30, 2
    s_lshl_b32 s44, s42, 5
    s_lshl_b32 s45, s41, 4
    s_cmp_eq_u32 s43, 0
    s_cselect_b32 s46, s44, 0
    s_cselect_b32 s47, 0, s44
    s_add_u32 s46, s46, s45
    v_add_u32 v10, s46, v9
    v_add_u32 v11, s47, v3
    v_cvt_f32_u32 v10, v10
    v_cvt_f32_u32 v11, v11
    v_mul_f32 v11, 0x3a000000, v11
    v_mul_f32 v10, v10, v11
    s_lshr_b32 s3, s30, 1
    s_lshl_b32 s3, s3, 13
    s_lshl_b32 s46, s41, 11
    s_add_u32 s3, s3, s46
    v_add_u32 v12, s3, v2
    v_mov_b32 v208, v10
    v_fmamk_f32 v209, v11, 0x3f800000, v10
    v_fmamk_f32 v210, v11, 0x40000000, v10
    v_fmamk_f32 v211, v11, 0x40400000, v10
    v_fmamk_f32 v212, v11, 0x41000000, v10
    v_fmamk_f32 v213, v11, 0x41100000, v10
    v_fmamk_f32 v214, v11, 0x41200000, v10
    v_fmamk_f32 v215, v11, 0x41300000, v10
    v_sin_f32 v216, v208
    v_cos_f32 v208, v208
    v_sin_f32 v217, v209
    v_cos_f32 v209, v209
    v_sin_f32 v218, v210
    v_cos_f32 v210, v210
    v_sin_f32 v219, v211
    v_cos_f32 v211, v211
    v_sin_f32 v220, v212
    v_cos_f32 v212, v212
    v_sin_f32 v221, v213
    v_cos_f32 v213, v213
    v_sin_f32 v222, v214
    v_cos_f32 v214, v214
    v_sin_f32 v223, v215
    v_cos_f32 v215, v215
    ds_write_b128 v12, v[208:211] offset:0
    ds_write_b128 v12, v[212:215] offset:1024
    ds_write_b128 v12, v[216:219] offset:4096
    ds_write_b128 v12, v[220:223] offset:5120
    v_cvt_f32_u32 v13, s41
    v_mul_f32 v13, 0xbe800000, v13
    v_add_u32 v11, s44, v3
    v_cvt_f32_u32 v11, v11
    v_mul_f32 v11, 0x3c800000, v11
    s_lshl_b32 s3, s43, 5
    v_add_u32 v10, s3, v9
    v_cvt_f32_u32 v10, v10
    v_fma_f32 v10, v10, v11, v13
    s_lshl_b32 s3, s41, 13
    s_lshl_b32 s46, s42, 12
    s_add_u32 s3, s3, s46
    s_lshl_b32 s46, s43, 11
    s_add_u32 s3, s3, s46
    v_add_u32 v12, s3, v2
    v_cvt_f32_u32 v15, v3
    v_mul_f32 v15, 0x3d000000, v15
    s_lshl_b32 s3, s42, 4
    v_add_u32 v14, s3, v9
    v_cvt_f32_u32 v14, v14
    v_fma_f32 v14, v14, v15, v13
    s_lshl_b32 s3, s41, 11
    s_lshl_b32 s46, s42, 10
    s_add_u32 s3, s3, s46
    v_add_u32 v13, s3, v2
    v_mov_b32 v224, v10
    v_fmamk_f32 v225, v11, 0x3f800000, v10
    v_fmamk_f32 v226, v11, 0x40000000, v10
    v_fmamk_f32 v227, v11, 0x40400000, v10
    v_fmamk_f32 v228, v11, 0x41000000, v10
    v_fmamk_f32 v229, v11, 0x41100000, v10
    v_fmamk_f32 v230, v11, 0x41200000, v10
    v_fmamk_f32 v231, v11, 0x41300000, v10
    v_fmamk_f32 v232, v11, 0x41800000, v10
    v_fmamk_f32 v233, v11, 0x41880000, v10
    v_fmamk_f32 v234, v11, 0x41900000, v10
    v_fmamk_f32 v235, v11, 0x41980000, v10
    v_fmamk_f32 v236, v11, 0x41c00000, v10
    v_fmamk_f32 v237, v11, 0x41c80000, v10
    v_fmamk_f32 v238, v11, 0x41d00000, v10
    v_fmamk_f32 v239, v11, 0x41d80000, v10
    v_mov_b32 v240, v14
    v_fmamk_f32 v241, v15, 0x3f800000, v14
    v_fmamk_f32 v242, v15, 0x40000000, v14
    v_fmamk_f32 v243, v15, 0x40400000, v14
    v_fmamk_f32 v244, v15, 0x41000000, v14
    v_fmamk_f32 v245, v15, 0x41100000, v14
    v_fmamk_f32 v246, v15, 0x41200000, v14
    v_fmamk_f32 v247, v15, 0x41300000, v14
    v_cos_f32 v224, v224
    v_cos_f32 v225, v225
    v_cos_f32 v226, v226
    v_cos_f32 v227, v227
    v_cos_f32 v228, v228
    v_cos_f32 v229, v229
    v_cos_f32 v230, v230
    v_cos_f32 v231, v231
    v_cos_f32 v232, v232
    v_cos_f32 v233, v233
    v_cos_f32 v234, v234
    v_cos_f32 v235, v235
    v_cos_f32 v236, v236
    v_cos_f32 v237, v237
    v_cos_f32 v238, v238
    v_cos_f32 v239, v239
    v_cos_f32 v240, v240
    v_cos_f32 v241, v241
    v_cos_f32 v242, v242
    v_cos_f32 v243, v243
    v_cos_f32 v244, v244
    v_cos_f32 v245, v245
    v_cos_f32 v246, v246
    v_cos_f32 v247, v247
    v_cvt_pk_bf16_f32 v224, v224, v225
    v_cvt_pk_bf16_f32 v225, v226, v227
    v_cvt_pk_bf16_f32 v226, v228, v229
    v_cvt_pk_bf16_f32 v227, v230, v231
    v_cvt_pk_bf16_f32 v228, v232, v233
    v_cvt_pk_bf16_f32 v229, v234, v235
    v_cvt_pk_bf16_f32 v230, v236, v237
    v_cvt_pk_bf16_f32 v231, v238, v239
    v_cvt_pk_bf16_f32 v232, v240, v241
    v_cvt_pk_bf16_f32 v233, v242, v243
    v_cvt_pk_bf16_f32 v234, v244, v245
    v_cvt_pk_bf16_f32 v235, v246, v247
    ds_write_b128 v12, v[224:227] offset:32768
    ds_write_b128 v12, v[228:231] offset:33792
    ds_write_b128 v13, v[232:235] offset:49152
    s_waitcnt vmcnt(0)
    s_cmp_ge_u32 s30, 4
    s_cbranch_scc1 .nc_36
    s_mov_b64 exec, 1
    v_mov_b32 v10, s98
    v_mov_b32 v11, 1
    ds_add_rtn_u32 v11, v10, v11
    v_mov_b64 v[12:13], s[96:97]
    s_waitcnt lgkmcnt(0)
    v_readfirstlane_b32 s3, v11
    s_cmp_lg_u32 s3, s99
    s_cbranch_scc1 .nf_37
    buffer_store_dwordx2 v[12:13], off, s[8:11], s51 sc1
.nf_37:
    s_mov_b64 exec, -1
.nc_36:
    s_waitcnt lgkmcnt(0)
    s_barrier
    s_and_b32 s31, s2, 7
    s_lshr_b32 s32, s2, 3
    s_lshl_b32 s49, s32, 3
    s_add_u32 s49, s49, s30
    s_add_u32 s49, s49, 0
    s_mov_b32 s20, s64
    s_mov_b32 s21, s65
    s_mov_b32 s22, 18874368
    s_mov_b32 s23, 0x20000
    s_and_b32 s3, s2, 3
    s_mul_i32 s50, s3, 4718592
    s_bfe_u32 s3, s2, 0x10002
    s_lshl_b32 s3, s3, 11
    s_add_u32 s50, s50, s3
    v_lshrrev_b32 v5, 1, v0
    v_mul_u32_u24 v5, 3840, v5
    v_lshl_add_u32 v5, v0, 7, v5
    s_mul_i32 s33, s31, 5
    s_add_u32 s33, s33, s32
    s_cmp_ge_u32 s33, 37
    s_cbranch_scc1 .idle_34
    ds_read_b128 v[192:195], v2 offset:49152
    ds_read_b128 v[196:199], v2 offset:50176
    ds_read_b128 v[200:203], v2 offset:51200
    ds_read_b128 v[204:207], v2 offset:52224
    ds_read_b128 v[208:211], v2 offset:0
    ds_read_b128 v[212:215], v2 offset:1024
    ds_read_b128 v[216:219], v2 offset:2048
    ds_read_b128 v[220:223], v2 offset:3072
    ds_read_b128 v[224:227], v2 offset:4096
    ds_read_b128 v[228:231], v2 offset:5120
    ds_read_b128 v[232:235], v2 offset:6144
    ds_read_b128 v[236:239], v2 offset:7168
    ds_read_b128 v[128:131], v2 offset:32768
    ds_read_b128 v[132:135], v2 offset:33792
    ds_read_b128 v[136:139], v2 offset:34816
    ds_read_b128 v[140:143], v2 offset:35840
    ds_read_b128 v[144:147], v2 offset:36864
    ds_read_b128 v[148:151], v2 offset:37888
    ds_read_b128 v[152:155], v2 offset:38912
    ds_read_b128 v[156:159], v2 offset:39936
    ds_read_b128 v[160:163], v2 offset:40960
    ds_read_b128 v[164:167], v2 offset:41984
    ds_read_b128 v[168:171], v2 offset:43008
    ds_read_b128 v[172:175], v2 offset:44032
    ds_read_b128 v[176:179], v2 offset:45056
    ds_read_b128 v[180:183], v2 offset:46080
    ds_read_b128 v[184:187], v2 offset:47104
    ds_read_b128 v[188:191], v2 offset:48128
    s_lshl_b32 s34, s33, 3
    s_min_u32 s34, s34, 281
    s_mul_i32 s41, s33, 57
    s_lshr_b32 s41, s41, 9
    s_min_u32 s41, s41, 3
    s_lshl_b32 s41, s41, 13
    s_add_u32 s41, s41, 40960
    s_add_u32 s34, s34, s30
    v_lshrrev_b32 v6, 4, v0
    v_xor_b32 v6, v6, v0
    v_lshlrev_b32 v6, 4, v6
    v_xor_b32 v7, 64, v6
    v_lshlrev_b32 v9, 7, v0
    s_lshl_b32 s35, s34, 13
    s_lshl_b32 s39, s34, 13
    s_lshl_b32 s38, s30, 13
    s_add_u32 s42, s41, 188416
    s_cmp_eq_u32 s34, 0
    s_cselect_b32 s44, 0x0f0f0f0f, -1
    s_cselect_b32 s46, 0xf0f0f0f0, -1
    s_cmp_eq_u32 s34, 288
    s_cselect_b32 s44, 0xf0f0f0f0, s44
    s_cselect_b32 s46, 0x0f0f0f0f, s46
    s_cselect_b32 s35, 0, s35
    s_cselect_b32 s41, 40960, s41
    s_cselect_b32 s3, 64, 0
    s_mov_b32 s45, s44
    s_mov_b32 s47, s46
    s_add_u32 s3, s3, s38
    s_add_u32 s40, s35, 4096
    s_mov_b32 s48, 0x80008000
    v_bfe_u32 v12, v0, 1, 3
    v_lshlrev_b32 v12, 4, v12
    v_lshl_add_u32 v12, v3, 7, v12
    v_xor_b32 v3, s3, v12
    v_lshlrev_b32 v4, 4, v4
    v_xor_b32 v12, v3, v4
    v_xor_b32 v13, 32, v12
    v_xor_b32 v14, 64, v12
    v_xor_b32 v15, 0x60, v12
    s_mov_b32 m0, s38
    s_add_u32 s12, s74, 2621440
    s_addc_u32 s13, s75, 0
    s_mov_b32 s14, 2359296
    s_mov_b32 s15, 0x20000
    s_add_u32 s24, s74, 22102016
    s_addc_u32 s25, s75, 0
    s_mov_b32 s26, 2367488
    s_mov_b32 s27, 0x20000
    s_mov_b32 s3, 0x40000
.poll_38:
    buffer_load_dwordx2 v[10:11], v9, s[8:11], s41 offen sc1
    s_sub_u32 s3, s3, 1
    s_cbranch_scc1 .got_39
    s_waitcnt vmcnt(0)
    v_cmp_ne_u64 vcc, s[96:97], v[10:11]
    s_cbranch_vccnz .poll_38
.got_39:
    buffer_load_dwordx4 v6, s[12:15], s35 offen offset:0 sc1 lds
    buffer_load_dwordx4 v7, s[12:15], s35 offen offset:1024 sc1 lds
    buffer_load_dwordx4 v6, s[12:15], s35 offen offset:2048 sc1 lds
    buffer_load_dwordx4 v7, s[12:15], s35 offen offset:3072 sc1 lds
    s_add_u32 m0, s38, 4096
    s_nop 0
    buffer_load_dwordx4 v6, s[12:15], s40 offen offset:0 sc1 lds
    buffer_load_dwordx4 v7, s[12:15], s40 offen offset:1024 sc1 lds
    buffer_load_dwordx4 v6, s[12:15], s40 offen offset:2048 sc1 lds
    buffer_load_dwordx4 v7, s[12:15], s40 offen offset:3072 sc1 lds
    s_mov_b32 s3, 0x40000
.poll_40:
    buffer_load_dwordx2 v[10:11], v9, s[8:11], s42 offen sc1
    s_sub_u32 s3, s3, 1
    s_cbranch_scc1 .got_41
    s_waitcnt vmcnt(0)
    v_cmp_ne_u64 vcc, s[96:97], v[10:11]
    s_cbranch_vccnz .poll_40
.got_41:
    s_waitcnt vmcnt(0) lgkmcnt(0)
    ds_read_b128 v[16:19], v12 offset:0
    ds_read_b128 v[32:35], v14 offset:0
    ds_read_b128 v[20:23], v13 offset:0
    ds_read_b128 v[36:39], v15 offset:0
    ds_read_b128 v[24:27], v12 offset:4096
    ds_read_b128 v[40:43], v14 offset:4096
    ds_read_b128 v[28:31], v13 offset:4096
    ds_read_b128 v[44:47], v15 offset:4096
    s_add_u32 s12, s74, 10289152
    s_addc_u32 s13, s75, 0
    s_mov_b32 s14, 2359296
    s_mov_b32 s15, 0x20000
    s_mov_b32 m0, s38
    v_lshrrev_b32 v7, 3, v0
    v_lshl_add_u32 v6, v7, 7, v6
    v_xor_b32 v7, 64, v6
    v_lshlrev_b32 v4, 1, v4
    s_waitcnt lgkmcnt(0)
    buffer_load_dwordx4 v1, s[24:27], s39 offen offset:0 sc1 lds
    buffer_load_dwordx4 v1, s[24:27], s39 offen offset:1024 sc1 lds
    buffer_load_dwordx4 v1, s[24:27], s39 offen offset:2048 sc1 lds
    buffer_load_dwordx4 v1, s[24:27], s39 offen offset:3072 sc1 lds
    s_add_u32 m0, s38, 4096
    s_add_u32 s39, s39, 4096
    buffer_load_dwordx4 v1, s[24:27], s39 offen offset:0 sc1 lds
    buffer_load_dwordx4 v1, s[24:27], s39 offen offset:1024 sc1 lds
    buffer_load_dwordx4 v1, s[24:27], s39 offen offset:2048 sc1 lds
    buffer_load_dwordx4 v1, s[24:27], s39 offen offset:3072 sc1 lds
    v_add_u32 v1, s38, v1
    v_xor_b32 v12, v3, v4
    v_xor_b32 v13, 16, v12
    v_xor_b32 v14, 64, v12
    v_xor_b32 v15, 0x50, v12
    s_cmp_eq_u32 s44, -1
    s_cbranch_scc1 .nz_42
    v_mov_b64 v[32:33], 0
    v_mov_b64 v[34:35], 0
    v_mov_b64 v[36:37], 0
    v_mov_b64 v[38:39], 0
    v_mov_b64 v[40:41], 0
    v_mov_b64 v[42:43], 0
    v_mov_b64 v[44:45], 0
    v_mov_b64 v[46:47], 0
.nz_42:
    v_xor_b32 v48, s48, v16
    v_xor_b32 v49, s48, v17
    v_xor_b32 v50, s48, v18
    v_xor_b32 v51, s48, v19
    v_xor_b32 v52, s48, v20
    v_xor_b32 v53, s48, v21
    v_xor_b32 v54, s48, v22
    v_xor_b32 v55, s48, v23
    v_xor_b32 v56, s48, v24
    v_xor_b32 v57, s48, v25
    v_xor_b32 v58, s48, v26
    v_xor_b32 v59, s48, v27
    v_xor_b32 v60, s48, v28
    v_xor_b32 v61, s48, v29
    v_xor_b32 v62, s48, v30
    v_xor_b32 v63, s48, v31
    s_lshr_b32 s51, s49, 3
    s_sub_u32 s3, s51, 12
    s_cselect_b32 s3, 0, s3
    s_mul_i32 s3, s3, 0
    s_add_u32 s51, s51, s3
    s_cmp_ge_u32 s51, 36
    s_cselect_b32 s3, 23, 0
    s_sub_u32 s51, s51, s3
    s_and_b32 s3, s49, 7
    s_mul_i32 s3, s3, 0
    s_lshr_b32 s3, s3, 1
    s_add_u32 s51, s51, s3
    s_sub_u32 s3, s51, 36
    s_cselect_b32 s51, s51, s3
    s_lshl_b32 s51, s51, 9
    s_and_b32 s3, s49, 7
    s_add_u32 s51, s51, s3
    s_lshl_b32 s51, s51, 8
    s_add_u32 s51, s51, s50
    buffer_load_dword v8, v5, s[20:23], s51 offen
    s_add_u32 s49, s49, 40
    v_mfma_f32_32x32x16_bf16 v[64:79], v[16:19], v[192:195], 0
    v_mfma_f32_32x32x16_bf16 v[96:111], v[32:35], v[192:195], 0
    v_mfma_f32_32x32x16_bf16 v[64:79], v[32:35], v[200:203], v[64:79]
    v_mfma_f32_32x32x16_bf16 v[96:111], v[48:51], v[200:203], v[96:111]
    v_mfma_f32_32x32x16_bf16 v[64:79], v[20:23], v[196:199], v[64:79]
    v_mfma_f32_32x32x16_bf16 v[96:111], v[36:39], v[196:199], v[96:111]
    v_mfma_f32_32x32x16_bf16 v[64:79], v[36:39], v[204:207], v[64:79]
    v_mfma_f32_32x32x16_bf16 v[96:111], v[52:55], v[204:207], v[96:111]
    v_mfma_f32_32x32x16_bf16 v[80:95], v[24:27], v[192:195], 0
    v_mfma_f32_32x32x16_bf16 v[112:127], v[40:43], v[192:195], 0
    v_mfma_f32_32x32x16_bf16 v[80:95], v[40:43], v[200:203], v[80:95]
    v_mfma_f32_32x32x16_bf16 v[112:127], v[56:59], v[200:203], v[112:127]
    v_mfma_f32_32x32x16_bf16 v[80:95], v[28:31], v[196:199], v[80:95]
    v_mfma_f32_32x32x16_bf16 v[112:127], v[44:47], v[196:199], v[112:127]
    v_mfma_f32_32x32x16_bf16 v[80:95], v[44:47], v[204:207], v[80:95]
    v_mfma_f32_32x32x16_bf16 v[112:127], v[60:63], v[204:207], v[112:127]
    s_nop 2
    v_pk_mul_f32 v[240:241], v[64:65], v[208:209]
    v_pk_mul_f32 v[208:209], v[96:97], v[208:209]
    v_pk_fma_f32 v[240:241], v[96:97], v[224:225], v[240:241]
    v_pk_fma_f32 v[208:209], v[64:65], v[224:225], v[208:209] neg_lo:[1,0,0] neg_hi:[1,0,0]
    v_pk_mul_f32 v[242:243], v[66:67], v[210:211]
    v_pk_mul_f32 v[210:211], v[98:99], v[210:211]
    v_pk_fma_f32 v[242:243], v[98:99], v[226:227], v[242:243]
    v_pk_fma_f32 v[210:211], v[66:67], v[226:227], v[210:211] neg_lo:[1,0,0] neg_hi:[1,0,0]
    v_pk_mul_f32 v[244:245], v[68:69], v[212:213]
    v_pk_mul_f32 v[212:213], v[100:101], v[212:213]
    v_pk_fma_f32 v[244:245], v[100:101], v[228:229], v[244:245]
    v_pk_fma_f32 v[212:213], v[68:69], v[228:229], v[212:213] neg_lo:[1,0,0] neg_hi:[1,0,0]
    v_pk_mul_f32 v[246:247], v[70:71], v[214:215]
    v_pk_mul_f32 v[214:215], v[102:103], v[214:215]
    v_pk_fma_f32 v[246:247], v[102:103], v[230:231], v[246:247]
    v_pk_fma_f32 v[214:215], v[70:71], v[230:231], v[214:215] neg_lo:[1,0,0] neg_hi:[1,0,0]
    v_pk_mul_f32 v[248:249], v[72:73], v[216:217]
    v_pk_mul_f32 v[216:217], v[104:105], v[216:217]
    v_pk_fma_f32 v[248:249], v[104:105], v[232:233], v[248:249]
    v_pk_fma_f32 v[216:217], v[72:73], v[232:233], v[216:217] neg_lo:[1,0,0] neg_hi:[1,0,0]
    v_pk_mul_f32 v[250:251], v[74:75], v[218:219]
    v_pk_mul_f32 v[218:219], v[106:107], v[218:219]
    v_pk_fma_f32 v[250:251], v[106:107], v[234:235], v[250:251]
    v_pk_fma_f32 v[218:219], v[74:75], v[234:235], v[218:219] neg_lo:[1,0,0] neg_hi:[1,0,0]
    v_pk_mul_f32 v[252:253], v[76:77], v[220:221]
    v_pk_mul_f32 v[220:221], v[108:109], v[220:221]
    v_pk_fma_f32 v[252:253], v[108:109], v[236:237], v[252:253]
    v_pk_fma_f32 v[220:221], v[76:77], v[236:237], v[220:221] neg_lo:[1,0,0] neg_hi:[1,0,0]
    v_pk_mul_f32 v[254:255], v[78:79], v[222:223]
    v_pk_mul_f32 v[222:223], v[110:111], v[222:223]
    v_pk_fma_f32 v[254:255], v[110:111], v[238:239], v[254:255]
    v_pk_fma_f32 v[222:223], v[78:79], v[238:239], v[222:223] neg_lo:[1,0,0] neg_hi:[1,0,0]
    v_cvt_pk_bf16_f32 v16, v240, v241
    v_cvt_pk_bf16_f32 v32, v208, v209
    v_cvt_pk_bf16_f32 v48, -v240, -v241
    v_cvt_pk_bf16_f32 v17, v242, v243
    v_cvt_pk_bf16_f32 v33, v210, v211
    v_cvt_pk_bf16_f32 v49, -v242, -v243
    v_cvt_pk_bf16_f32 v18, v244, v245
    v_cvt_pk_bf16_f32 v34, v212, v213
    v_cvt_pk_bf16_f32 v50, -v244, -v245
    v_cvt_pk_bf16_f32 v19, v246, v247
    v_cvt_pk_bf16_f32 v35, v214, v215
    v_cvt_pk_bf16_f32 v51, -v246, -v247
    v_cvt_pk_bf16_f32 v20, v248, v249
    v_cvt_pk_bf16_f32 v36, v216, v217
    v_cvt_pk_bf16_f32 v52, -v248, -v249
    v_cvt_pk_bf16_f32 v21, v250, v251
    v_cvt_pk_bf16_f32 v37, v218, v219
    v_cvt_pk_bf16_f32 v53, -v250, -v251
    v_cvt_pk_bf16_f32 v22, v252, v253
    v_cvt_pk_bf16_f32 v38, v220, v221
    v_cvt_pk_bf16_f32 v54, -v252, -v253
    v_cvt_pk_bf16_f32 v23, v254, v255
    v_cvt_pk_bf16_f32 v39, v222, v223
    v_cvt_pk_bf16_f32 v55, -v254, -v255
    ds_read_b128 v[208:211], v2 offset:8192
    ds_read_b128 v[212:215], v2 offset:9216
    ds_read_b128 v[216:219], v2 offset:10240
    ds_read_b128 v[220:223], v2 offset:11264
    ds_read_b128 v[224:227], v2 offset:12288
    ds_read_b128 v[228:231], v2 offset:13312
    ds_read_b128 v[232:235], v2 offset:14336
    ds_read_b128 v[236:239], v2 offset:15360
    s_waitcnt lgkmcnt(0)
    v_pk_mul_f32 v[240:241], v[80:81], v[208:209]
    v_pk_mul_f32 v[208:209], v[112:113], v[208:209]
    v_pk_fma_f32 v[240:241], v[112:113], v[224:225], v[240:241]
    v_pk_fma_f32 v[208:209], v[80:81], v[224:225], v[208:209] neg_lo:[1,0,0] neg_hi:[1,0,0]
    v_pk_mul_f32 v[242:243], v[82:83], v[210:211]
    v_pk_mul_f32 v[210:211], v[114:115], v[210:211]
    v_pk_fma_f32 v[242:243], v[114:115], v[226:227], v[242:243]
    v_pk_fma_f32 v[210:211], v[82:83], v[226:227], v[210:211] neg_lo:[1,0,0] neg_hi:[1,0,0]
    v_pk_mul_f32 v[244:245], v[84:85], v[212:213]
    v_pk_mul_f32 v[212:213], v[116:117], v[212:213]
    v_pk_fma_f32 v[244:245], v[116:117], v[228:229], v[244:245]
    v_pk_fma_f32 v[212:213], v[84:85], v[228:229], v[212:213] neg_lo:[1,0,0] neg_hi:[1,0,0]
    v_pk_mul_f32 v[246:247], v[86:87], v[214:215]
    v_pk_mul_f32 v[214:215], v[118:119], v[214:215]
    v_pk_fma_f32 v[246:247], v[118:119], v[230:231], v[246:247]
    v_pk_fma_f32 v[214:215], v[86:87], v[230:231], v[214:215] neg_lo:[1,0,0] neg_hi:[1,0,0]
    v_pk_mul_f32 v[248:249], v[88:89], v[216:217]
    v_pk_mul_f32 v[216:217], v[120:121], v[216:217]
    v_pk_fma_f32 v[248:249], v[120:121], v[232:233], v[248:249]
    v_pk_fma_f32 v[216:217], v[88:89], v[232:233], v[216:217] neg_lo:[1,0,0] neg_hi:[1,0,0]
    v_pk_mul_f32 v[250:251], v[90:91], v[218:219]
    v_pk_mul_f32 v[218:219], v[122:123], v[218:219]
    v_pk_fma_f32 v[250:251], v[122:123], v[234:235], v[250:251]
    v_pk_fma_f32 v[218:219], v[90:91], v[234:235], v[218:219] neg_lo:[1,0,0] neg_hi:[1,0,0]
    v_pk_mul_f32 v[252:253], v[92:93], v[220:221]
    v_pk_mul_f32 v[220:221], v[124:125], v[220:221]
    v_pk_fma_f32 v[252:253], v[124:125], v[236:237], v[252:253]
    v_pk_fma_f32 v[220:221], v[92:93], v[236:237], v[220:221] neg_lo:[1,0,0] neg_hi:[1,0,0]
    v_pk_mul_f32 v[254:255], v[94:95], v[222:223]
    v_pk_mul_f32 v[222:223], v[126:127], v[222:223]
    v_pk_fma_f32 v[254:255], v[126:127], v[238:239], v[254:255]
    v_pk_fma_f32 v[222:223], v[94:95], v[238:239], v[222:223] neg_lo:[1,0,0] neg_hi:[1,0,0]
    v_cvt_pk_bf16_f32 v24, v240, v241
    v_cvt_pk_bf16_f32 v40, v208, v209
    v_cvt_pk_bf16_f32 v56, -v240, -v241
    v_cvt_pk_bf16_f32 v25, v242, v243
    v_cvt_pk_bf16_f32 v41, v210, v211
    v_cvt_pk_bf16_f32 v57, -v242, -v243
    v_cvt_pk_bf16_f32 v26, v244, v245
    v_cvt_pk_bf16_f32 v42, v212, v213
    v_cvt_pk_bf16_f32 v58, -v244, -v245
    v_cvt_pk_bf16_f32 v27, v246, v247
    v_cvt_pk_bf16_f32 v43, v214, v215
    v_cvt_pk_bf16_f32 v59, -v246, -v247
    v_cvt_pk_bf16_f32 v28, v248, v249
    v_cvt_pk_bf16_f32 v44, v216, v217
    v_cvt_pk_bf16_f32 v60, -v248, -v249
    v_cvt_pk_bf16_f32 v29, v250, v251
    v_cvt_pk_bf16_f32 v45, v218, v219
    v_cvt_pk_bf16_f32 v61, -v250, -v251
    v_cvt_pk_bf16_f32 v30, v252, v253
    v_cvt_pk_bf16_f32 v46, v220, v221
    v_cvt_pk_bf16_f32 v62, -v252, -v253
    v_cvt_pk_bf16_f32 v31, v254, v255
    v_cvt_pk_bf16_f32 v47, v222, v223
    v_cvt_pk_bf16_f32 v63, -v254, -v255
    s_waitcnt vmcnt(1)
    ds_read_b128 v[240:243], v1 offset:0
    ds_read_b128 v[248:251], v1 offset:1024
    ds_read_b128 v[244:247], v1 offset:2048
    ds_read_b128 v[252:255], v1 offset:3072
    s_lshr_b32 s51, s49, 3
    s_sub_u32 s3, s51, 12
    s_cselect_b32 s3, 0, s3
    s_mul_i32 s3, s3, 0
    s_add_u32 s51, s51, s3
    s_cmp_ge_u32 s51, 36
    s_cselect_b32 s3, 23, 0
    s_sub_u32 s51, s51, s3
    s_and_b32 s3, s49, 7
    s_mul_i32 s3, s3, 0
    s_lshr_b32 s3, s3, 1
    s_add_u32 s51, s51, s3
    s_sub_u32 s3, s51, 36
    s_cselect_b32 s51, s51, s3
    s_lshl_b32 s51, s51, 9
    s_and_b32 s3, s49, 7
    s_add_u32 s51, s51, s3
    s_lshl_b32 s51, s51, 8
    s_add_u32 s51, s51, s50
    buffer_load_dword v8, v5, s[20:23], s51 offen
    s_add_u32 s49, s49, 40
    v_mfma_f32_32x32x16_bf16 v[64:79], v[128:131], v[16:19], 0
    v_mfma_f32_32x32x16_bf16 v[96:111], v[128:131], v[32:35], 0
    v_mfma_f32_32x32x16_bf16 v[64:79], v[160:163], v[32:35], v[64:79]
    v_mfma_f32_32x32x16_bf16 v[96:111], v[160:163], v[48:51], v[96:111]
    v_mfma_f32_32x32x16_bf16 v[64:79], v[132:135], v[20:23], v[64:79]
    v_mfma_f32_32x32x16_bf16 v[96:111], v[132:135], v[36:39], v[96:111]
    v_mfma_f32_32x32x16_bf16 v[64:79], v[164:167], v[36:39], v[64:79]
    v_mfma_f32_32x32x16_bf16 v[96:111], v[164:167], v[52:55], v[96:111]
    v_mfma_f32_32x32x16_bf16 v[64:79], v[136:139], v[24:27], v[64:79]
    v_mfma_f32_32x32x16_bf16 v[96:111], v[136:139], v[40:43], v[96:111]
    v_mfma_f32_32x32x16_bf16 v[64:79], v[168:171], v[40:43], v[64:79]
    v_mfma_f32_32x32x16_bf16 v[96:111], v[168:171], v[56:59], v[96:111]
    v_mfma_f32_32x32x16_bf16 v[64:79], v[140:143], v[28:31], v[64:79]
    v_mfma_f32_32x32x16_bf16 v[96:111], v[140:143], v[44:47], v[96:111]
    v_mfma_f32_32x32x16_bf16 v[64:79], v[172:175], v[44:47], v[64:79]
    v_mfma_f32_32x32x16_bf16 v[96:111], v[172:175], v[60:63], v[96:111]
    v_mfma_f32_32x32x16_bf16 v[80:95], v[144:147], v[16:19], 0
    v_mfma_f32_32x32x16_bf16 v[112:127], v[144:147], v[32:35], 0
    v_mfma_f32_32x32x16_bf16 v[80:95], v[176:179], v[32:35], v[80:95]
    v_mfma_f32_32x32x16_bf16 v[112:127], v[176:179], v[48:51], v[112:127]
    v_mfma_f32_32x32x16_bf16 v[80:95], v[148:151], v[20:23], v[80:95]
    v_mfma_f32_32x32x16_bf16 v[112:127], v[148:151], v[36:39], v[112:127]
    v_mfma_f32_32x32x16_bf16 v[80:95], v[180:183], v[36:39], v[80:95]
    v_mfma_f32_32x32x16_bf16 v[112:127], v[180:183], v[52:55], v[112:127]
    v_mfma_f32_32x32x16_bf16 v[80:95], v[152:155], v[24:27], v[80:95]
    v_mfma_f32_32x32x16_bf16 v[112:127], v[152:155], v[40:43], v[112:127]
    v_mfma_f32_32x32x16_bf16 v[80:95], v[184:187], v[40:43], v[80:95]
    v_mfma_f32_32x32x16_bf16 v[112:127], v[184:187], v[56:59], v[112:127]
    v_mfma_f32_32x32x16_bf16 v[80:95], v[156:159], v[28:31], v[80:95]
    v_mfma_f32_32x32x16_bf16 v[112:127], v[156:159], v[44:47], v[112:127]
    v_mfma_f32_32x32x16_bf16 v[80:95], v[188:191], v[44:47], v[80:95]
    v_mfma_f32_32x32x16_bf16 v[112:127], v[188:191], v[60:63], v[112:127]
    s_waitcnt lgkmcnt(0)
    v_lshlrev_b32 v208, 16, v240
    v_and_b32 v209, 0xffff0000, v240
    v_lshlrev_b32 v210, 16, v241
    v_and_b32 v211, 0xffff0000, v241
    v_lshlrev_b32 v212, 16, v242
    v_and_b32 v213, 0xffff0000, v242
    v_lshlrev_b32 v214, 16, v243
    v_and_b32 v215, 0xffff0000, v243
    v_lshlrev_b32 v216, 16, v244
    v_and_b32 v217, 0xffff0000, v244
    v_lshlrev_b32 v218, 16, v245
    v_and_b32 v219, 0xffff0000, v245
    v_lshlrev_b32 v220, 16, v246
    v_and_b32 v221, 0xffff0000, v246
    v_lshlrev_b32 v222, 16, v247
    v_and_b32 v223, 0xffff0000, v247
    v_lshlrev_b32 v224, 16, v248
    v_and_b32 v225, 0xffff0000, v248
    v_lshlrev_b32 v226, 16, v249
    v_and_b32 v227, 0xffff0000, v249
    v_lshlrev_b32 v228, 16, v250
    v_and_b32 v229, 0xffff0000, v250
    v_lshlrev_b32 v230, 16, v251
    v_and_b32 v231, 0xffff0000, v251
    v_lshlrev_b32 v232, 16, v252
    v_and_b32 v233, 0xffff0000, v252
    v_lshlrev_b32 v234, 16, v253
    v_and_b32 v235, 0xffff0000, v253
    v_lshlrev_b32 v236, 16, v254
    v_and_b32 v237, 0xffff0000, v254
    v_lshlrev_b32 v238, 16, v255
    v_and_b32 v239, 0xffff0000, v255
    v_pk_mul_f32 v[240:241], v[64:65], v[208:209]
    v_pk_mul_f32 v[208:209], v[96:97], v[208:209]
    v_pk_fma_f32 v[240:241], v[96:97], v[224:225], v[240:241] neg_lo:[1,0,0] neg_hi:[1,0,0]
    v_pk_fma_f32 v[208:209], v[64:65], v[224:225], v[208:209]
    v_pk_mul_f32 v[242:243], v[66:67], v[210:211]
    v_pk_mul_f32 v[210:211], v[98:99], v[210:211]
    v_pk_fma_f32 v[242:243], v[98:99], v[226:227], v[242:243] neg_lo:[1,0,0] neg_hi:[1,0,0]
    v_pk_fma_f32 v[210:211], v[66:67], v[226:227], v[210:211]
    v_pk_mul_f32 v[244:245], v[68:69], v[212:213]
    v_pk_mul_f32 v[212:213], v[100:101], v[212:213]
    v_pk_fma_f32 v[244:245], v[100:101], v[228:229], v[244:245] neg_lo:[1,0,0] neg_hi:[1,0,0]
    v_pk_fma_f32 v[212:213], v[68:69], v[228:229], v[212:213]
    v_pk_mul_f32 v[246:247], v[70:71], v[214:215]
    v_pk_mul_f32 v[214:215], v[102:103], v[214:215]
    v_pk_fma_f32 v[246:247], v[102:103], v[230:231], v[246:247] neg_lo:[1,0,0] neg_hi:[1,0,0]
    v_pk_fma_f32 v[214:215], v[70:71], v[230:231], v[214:215]
    v_pk_mul_f32 v[248:249], v[72:73], v[216:217]
    v_pk_mul_f32 v[216:217], v[104:105], v[216:217]
    v_pk_fma_f32 v[248:249], v[104:105], v[232:233], v[248:249] neg_lo:[1,0,0] neg_hi:[1,0,0]
    v_pk_fma_f32 v[216:217], v[72:73], v[232:233], v[216:217]
    v_pk_mul_f32 v[250:251], v[74:75], v[218:219]
    v_pk_mul_f32 v[218:219], v[106:107], v[218:219]
    v_pk_fma_f32 v[250:251], v[106:107], v[234:235], v[250:251] neg_lo:[1,0,0] neg_hi:[1,0,0]
    v_pk_fma_f32 v[218:219], v[74:75], v[234:235], v[218:219]
    v_pk_mul_f32 v[252:253], v[76:77], v[220:221]
    v_pk_mul_f32 v[220:221], v[108:109], v[220:221]
    v_pk_fma_f32 v[252:253], v[108:109], v[236:237], v[252:253] neg_lo:[1,0,0] neg_hi:[1,0,0]
    v_pk_fma_f32 v[220:221], v[76:77], v[236:237], v[220:221]
    v_pk_mul_f32 v[254:255], v[78:79], v[222:223]
    v_pk_mul_f32 v[222:223], v[110:111], v[222:223]
    v_pk_fma_f32 v[254:255], v[110:111], v[238:239], v[254:255] neg_lo:[1,0,0] neg_hi:[1,0,0]
    v_pk_fma_f32 v[222:223], v[78:79], v[238:239], v[222:223]
    v_cvt_pk_bf16_f32 v16, v240, v241
    v_cvt_pk_bf16_f32 v32, v208, v209
    v_cvt_pk_bf16_f32 v48, -v208, -v209
    v_cvt_pk_bf16_f32 v17, v242, v243
    v_cvt_pk_bf16_f32 v33, v210, v211
    v_cvt_pk_bf16_f32 v49, -v210, -v211
    v_cvt_pk_bf16_f32 v18, v244, v245
    v_cvt_pk_bf16_f32 v34, v212, v213
    v_cvt_pk_bf16_f32 v50, -v212, -v213
    v_cvt_pk_bf16_f32 v19, v246, v247
    v_cvt_pk_bf16_f32 v35, v214, v215
    v_cvt_pk_bf16_f32 v51, -v214, -v215
    v_cvt_pk_bf16_f32 v20, v248, v249
    v_cvt_pk_bf16_f32 v36, v216, v217
    v_cvt_pk_bf16_f32 v52, -v216, -v217
    v_cvt_pk_bf16_f32 v21, v250, v251
    v_cvt_pk_bf16_f32 v37, v218, v219
    v_cvt_pk_bf16_f32 v53, -v218, -v219
    v_cvt_pk_bf16_f32 v22, v252, v253
    v_cvt_pk_bf16_f32 v38, v220, v221
    v_cvt_pk_bf16_f32 v54, -v220, -v221
    v_cvt_pk_bf16_f32 v23, v254, v255
    v_cvt_pk_bf16_f32 v39, v222, v223
    v_cvt_pk_bf16_f32 v55, -v222, -v223
    ds_read_b128 v[240:243], v1 offset:4096
    ds_read_b128 v[248:251], v1 offset:5120
    ds_read_b128 v[244:247], v1 offset:6144
    ds_read_b128 v[252:255], v1 offset:7168
    s_waitcnt lgkmcnt(0)
    v_lshlrev_b32 v208, 16, v240
    v_and_b32 v209, 0xffff0000, v240
    v_lshlrev_b32 v210, 16, v241
    v_and_b32 v211, 0xffff0000, v241
    v_lshlrev_b32 v212, 16, v242
    v_and_b32 v213, 0xffff0000, v242
    v_lshlrev_b32 v214, 16, v243
    v_and_b32 v215, 0xffff0000, v243
    v_lshlrev_b32 v216, 16, v244
    v_and_b32 v217, 0xffff0000, v244
    v_lshlrev_b32 v218, 16, v245
    v_and_b32 v219, 0xffff0000, v245
    v_lshlrev_b32 v220, 16, v246
    v_and_b32 v221, 0xffff0000, v246
    v_lshlrev_b32 v222, 16, v247
    v_and_b32 v223, 0xffff0000, v247
    v_lshlrev_b32 v224, 16, v248
    v_and_b32 v225, 0xffff0000, v248
    v_lshlrev_b32 v226, 16, v249
    v_and_b32 v227, 0xffff0000, v249
    v_lshlrev_b32 v228, 16, v250
    v_and_b32 v229, 0xffff0000, v250
    v_lshlrev_b32 v230, 16, v251
    v_and_b32 v231, 0xffff0000, v251
    v_lshlrev_b32 v232, 16, v252
    v_and_b32 v233, 0xffff0000, v252
    v_lshlrev_b32 v234, 16, v253
    v_and_b32 v235, 0xffff0000, v253
    v_lshlrev_b32 v236, 16, v254
    v_and_b32 v237, 0xffff0000, v254
    v_lshlrev_b32 v238, 16, v255
    v_and_b32 v239, 0xffff0000, v255
    v_pk_mul_f32 v[240:241], v[80:81], v[208:209]
    v_pk_mul_f32 v[208:209], v[112:113], v[208:209]
    v_pk_fma_f32 v[240:241], v[112:113], v[224:225], v[240:241] neg_lo:[1,0,0] neg_hi:[1,0,0]
    v_pk_fma_f32 v[208:209], v[80:81], v[224:225], v[208:209]
    v_pk_mul_f32 v[242:243], v[82:83], v[210:211]
    v_pk_mul_f32 v[210:211], v[114:115], v[210:211]
    v_pk_fma_f32 v[242:243], v[114:115], v[226:227], v[242:243] neg_lo:[1,0,0] neg_hi:[1,0,0]
    v_pk_fma_f32 v[210:211], v[82:83], v[226:227], v[210:211]
    v_pk_mul_f32 v[244:245], v[84:85], v[212:213]
    v_pk_mul_f32 v[212:213], v[116:117], v[212:213]
    v_pk_fma_f32 v[244:245], v[116:117], v[228:229], v[244:245] neg_lo:[1,0,0] neg_hi:[1,0,0]
    v_pk_fma_f32 v[212:213], v[84:85], v[228:229], v[212:213]
    v_pk_mul_f32 v[246:247], v[86:87], v[214:215]
    v_pk_mul_f32 v[214:215], v[118:119], v[214:215]
    v_pk_fma_f32 v[246:247], v[118:119], v[230:231], v[246:247] neg_lo:[1,0,0] neg_hi:[1,0,0]
    v_pk_fma_f32 v[214:215], v[86:87], v[230:231], v[214:215]
    v_pk_mul_f32 v[248:249], v[88:89], v[216:217]
    v_pk_mul_f32 v[216:217], v[120:121], v[216:217]
    v_pk_fma_f32 v[248:249], v[120:121], v[232:233], v[248:249] neg_lo:[1,0,0] neg_hi:[1,0,0]
    v_pk_fma_f32 v[216:217], v[88:89], v[232:233], v[216:217]
    v_pk_mul_f32 v[250:251], v[90:91], v[218:219]
    v_pk_mul_f32 v[218:219], v[122:123], v[218:219]
    v_pk_fma_f32 v[250:251], v[122:123], v[234:235], v[250:251] neg_lo:[1,0,0] neg_hi:[1,0,0]
    v_pk_fma_f32 v[218:219], v[90:91], v[234:235], v[218:219]
    v_pk_mul_f32 v[252:253], v[92:93], v[220:221]
    v_pk_mul_f32 v[220:221], v[124:125], v[220:221]
    v_pk_fma_f32 v[252:253], v[124:125], v[236:237], v[252:253] neg_lo:[1,0,0] neg_hi:[1,0,0]
    v_pk_fma_f32 v[220:221], v[92:93], v[236:237], v[220:221]
    v_pk_mul_f32 v[254:255], v[94:95], v[222:223]
    v_pk_mul_f32 v[222:223], v[126:127], v[222:223]
    v_pk_fma_f32 v[254:255], v[126:127], v[238:239], v[254:255] neg_lo:[1,0,0] neg_hi:[1,0,0]
    v_pk_fma_f32 v[222:223], v[94:95], v[238:239], v[222:223]
    v_cvt_pk_bf16_f32 v24, v240, v241
    v_cvt_pk_bf16_f32 v40, v208, v209
    v_cvt_pk_bf16_f32 v56, -v208, -v209
    v_cvt_pk_bf16_f32 v25, v242, v243
    v_cvt_pk_bf16_f32 v41, v210, v211
    v_cvt_pk_bf16_f32 v57, -v210, -v211
    v_cvt_pk_bf16_f32 v26, v244, v245
    v_cvt_pk_bf16_f32 v42, v212, v213
    v_cvt_pk_bf16_f32 v58, -v212, -v213
    v_cvt_pk_bf16_f32 v27, v246, v247
    v_cvt_pk_bf16_f32 v43, v214, v215
    v_cvt_pk_bf16_f32 v59, -v214, -v215
    v_cvt_pk_bf16_f32 v28, v248, v249
    v_cvt_pk_bf16_f32 v44, v216, v217
    v_cvt_pk_bf16_f32 v60, -v216, -v217
    v_cvt_pk_bf16_f32 v29, v250, v251
    v_cvt_pk_bf16_f32 v45, v218, v219
    v_cvt_pk_bf16_f32 v61, -v218, -v219
    v_cvt_pk_bf16_f32 v30, v252, v253
    v_cvt_pk_bf16_f32 v46, v220, v221
    v_cvt_pk_bf16_f32 v62, -v220, -v221
    v_cvt_pk_bf16_f32 v31, v254, v255
    v_cvt_pk_bf16_f32 v47, v222, v223
    v_cvt_pk_bf16_f32 v63, -v222, -v223
    ds_read_b128 v[208:211], v2 offset:16384
    ds_read_b128 v[212:215], v2 offset:17408
    ds_read_b128 v[216:219], v2 offset:18432
    ds_read_b128 v[220:223], v2 offset:19456
    ds_read_b128 v[224:227], v2 offset:20480
    ds_read_b128 v[228:231], v2 offset:21504
    ds_read_b128 v[232:235], v2 offset:22528
    ds_read_b128 v[236:239], v2 offset:23552
    s_lshr_b32 s51, s49, 3
    s_sub_u32 s3, s51, 12
    s_cselect_b32 s3, 0, s3
    s_mul_i32 s3, s3, 0
    s_add_u32 s51, s51, s3
    s_cmp_ge_u32 s51, 36
    s_cselect_b32 s3, 23, 0
    s_sub_u32 s51, s51, s3
    s_and_b32 s3, s49, 7
    s_mul_i32 s3, s3, 0
    s_lshr_b32 s3, s3, 1
    s_add_u32 s51, s51, s3
    s_sub_u32 s3, s51, 36
    s_cselect_b32 s51, s51, s3
    s_lshl_b32 s51, s51, 9
    s_and_b32 s3, s49, 7
    s_add_u32 s51, s51, s3
    s_lshl_b32 s51, s51, 8
    s_add_u32 s51, s51, s50
    buffer_load_dword v8, v5, s[20:23], s51 offen
    s_add_u32 s49, s49, 40
    v_mfma_f32_32x32x16_bf16 v[64:79], v[16:19], v[128:131], 0
    v_mfma_f32_32x32x16_bf16 v[96:111], v[32:35], v[128:131], 0
    v_mfma_f32_32x32x16_bf16 v[64:79], v[48:51], v[160:163], v[64:79]
    v_mfma_f32_32x32x16_bf16 v[96:111], v[16:19], v[160:163], v[96:111]
    v_mfma_f32_32x32x16_bf16 v[64:79], v[20:23], v[132:135], v[64:79]
    v_mfma_f32_32x32x16_bf16 v[96:111], v[36:39], v[132:135], v[96:111]
    v_mfma_f32_32x32x16_bf16 v[64:79], v[52:55], v[164:167], v[64:79]
    v_mfma_f32_32x32x16_bf16 v[96:111], v[20:23], v[164:167], v[96:111]
    v_mfma_f32_32x32x16_bf16 v[64:79], v[24:27], v[136:139], v[64:79]
    v_mfma_f32_32x32x16_bf16 v[96:111], v[40:43], v[136:139], v[96:111]
    v_mfma_f32_32x32x16_bf16 v[64:79], v[56:59], v[168:171], v[64:79]
    v_mfma_f32_32x32x16_bf16 v[96:111], v[24:27], v[168:171], v[96:111]
    v_mfma_f32_32x32x16_bf16 v[64:79], v[28:31], v[140:143], v[64:79]
    v_mfma_f32_32x32x16_bf16 v[96:111], v[44:47], v[140:143], v[96:111]
    v_mfma_f32_32x32x16_bf16 v[64:79], v[60:63], v[172:175], v[64:79]
    v_mfma_f32_32x32x16_bf16 v[96:111], v[28:31], v[172:175], v[96:111]
    v_mfma_f32_32x32x16_bf16 v[80:95], v[16:19], v[144:147], 0
    v_mfma_f32_32x32x16_bf16 v[112:127], v[32:35], v[144:147], 0
    v_mfma_f32_32x32x16_bf16 v[80:95], v[48:51], v[176:179], v[80:95]
    v_mfma_f32_32x32x16_bf16 v[112:127], v[16:19], v[176:179], v[112:127]
    v_mfma_f32_32x32x16_bf16 v[80:95], v[20:23], v[148:151], v[80:95]
    v_mfma_f32_32x32x16_bf16 v[112:127], v[36:39], v[148:151], v[112:127]
    v_mfma_f32_32x32x16_bf16 v[80:95], v[52:55], v[180:183], v[80:95]
    v_mfma_f32_32x32x16_bf16 v[112:127], v[20:23], v[180:183], v[112:127]
    v_mfma_f32_32x32x16_bf16 v[80:95], v[24:27], v[152:155], v[80:95]
    v_mfma_f32_32x32x16_bf16 v[112:127], v[40:43], v[152:155], v[112:127]
    v_mfma_f32_32x32x16_bf16 v[80:95], v[56:59], v[184:187], v[80:95]
    v_mfma_f32_32x32x16_bf16 v[112:127], v[24:27], v[184:187], v[112:127]
    v_mfma_f32_32x32x16_bf16 v[80:95], v[28:31], v[156:159], v[80:95]
    v_mfma_f32_32x32x16_bf16 v[112:127], v[44:47], v[156:159], v[112:127]
    v_mfma_f32_32x32x16_bf16 v[80:95], v[60:63], v[188:191], v[80:95]
    v_mfma_f32_32x32x16_bf16 v[112:127], v[28:31], v[188:191], v[112:127]
    s_waitcnt lgkmcnt(0)
    v_pk_mul_f32 v[240:241], v[64:65], v[208:209]
    v_pk_mul_f32 v[208:209], v[96:97], v[208:209]
    v_pk_fma_f32 v[240:241], v[96:97], v[224:225], v[240:241] neg_lo:[1,0,0] neg_hi:[1,0,0]
    v_pk_fma_f32 v[208:209], v[64:65], v[224:225], v[208:209]
    v_pk_mul_f32 v[242:243], v[66:67], v[210:211]
    v_pk_mul_f32 v[210:211], v[98:99], v[210:211]
    v_pk_fma_f32 v[242:243], v[98:99], v[226:227], v[242:243] neg_lo:[1,0,0] neg_hi:[1,0,0]
    v_pk_fma_f32 v[210:211], v[66:67], v[226:227], v[210:211]
    v_pk_mul_f32 v[244:245], v[68:69], v[212:213]
    v_pk_mul_f32 v[212:213], v[100:101], v[212:213]
    v_pk_fma_f32 v[244:245], v[100:101], v[228:229], v[244:245] neg_lo:[1,0,0] neg_hi:[1,0,0]
    v_pk_fma_f32 v[212:213], v[68:69], v[228:229], v[212:213]
    v_pk_mul_f32 v[246:247], v[70:71], v[214:215]
    v_pk_mul_f32 v[214:215], v[102:103], v[214:215]
    v_pk_fma_f32 v[246:247], v[102:103], v[230:231], v[246:247] neg_lo:[1,0,0] neg_hi:[1,0,0]
    v_pk_fma_f32 v[214:215], v[70:71], v[230:231], v[214:215]
    v_pk_mul_f32 v[248:249], v[72:73], v[216:217]
    v_pk_mul_f32 v[216:217], v[104:105], v[216:217]
    v_pk_fma_f32 v[248:249], v[104:105], v[232:233], v[248:249] neg_lo:[1,0,0] neg_hi:[1,0,0]
    v_pk_fma_f32 v[216:217], v[72:73], v[232:233], v[216:217]
    v_pk_mul_f32 v[250:251], v[74:75], v[218:219]
    v_pk_mul_f32 v[218:219], v[106:107], v[218:219]
    v_pk_fma_f32 v[250:251], v[106:107], v[234:235], v[250:251] neg_lo:[1,0,0] neg_hi:[1,0,0]
    v_pk_fma_f32 v[218:219], v[74:75], v[234:235], v[218:219]
    v_pk_mul_f32 v[252:253], v[76:77], v[220:221]
    v_pk_mul_f32 v[220:221], v[108:109], v[220:221]
    v_pk_fma_f32 v[252:253], v[108:109], v[236:237], v[252:253] neg_lo:[1,0,0] neg_hi:[1,0,0]
    v_pk_fma_f32 v[220:221], v[76:77], v[236:237], v[220:221]
    v_pk_mul_f32 v[254:255], v[78:79], v[222:223]
    v_pk_mul_f32 v[222:223], v[110:111], v[222:223]
    v_pk_fma_f32 v[254:255], v[110:111], v[238:239], v[254:255] neg_lo:[1,0,0] neg_hi:[1,0,0]
    v_pk_fma_f32 v[222:223], v[78:79], v[238:239], v[222:223]
    v_cvt_pk_bf16_f32 v16, v240, v241
    v_cvt_pk_bf16_f32 v32, v208, v209
    v_cvt_pk_bf16_f32 v48, -v208, -v209
    v_cvt_pk_bf16_f32 v17, v242, v243
    v_cvt_pk_bf16_f32 v33, v210, v211
    v_cvt_pk_bf16_f32 v49, -v210, -v211
    v_cvt_pk_bf16_f32 v18, v244, v245
    v_cvt_pk_bf16_f32 v34, v212, v213
    v_cvt_pk_bf16_f32 v50, -v212, -v213
    v_cvt_pk_bf16_f32 v19, v246, v247
    v_cvt_pk_bf16_f32 v35, v214, v215
    v_cvt_pk_bf16_f32 v51, -v214, -v215
    v_cvt_pk_bf16_f32 v20, v248, v249
    v_cvt_pk_bf16_f32 v36, v216, v217
    v_cvt_pk_bf16_f32 v52, -v216, -v217
    v_cvt_pk_bf16_f32 v21, v250, v251
    v_cvt_pk_bf16_f32 v37, v218, v219
    v_cvt_pk_bf16_f32 v53, -v218, -v219
    v_cvt_pk_bf16_f32 v22, v252, v253
    v_cvt_pk_bf16_f32 v38, v220, v221
    v_cvt_pk_bf16_f32 v54, -v220, -v221
    v_cvt_pk_bf16_f32 v23, v254, v255
    v_cvt_pk_bf16_f32 v39, v222, v223
    v_cvt_pk_bf16_f32 v55, -v222, -v223
    ds_read_b128 v[208:211], v2 offset:24576
    ds_read_b128 v[212:215], v2 offset:25600
    ds_read_b128 v[216:219], v2 offset:26624
    ds_read_b128 v[220:223], v2 offset:27648
    ds_read_b128 v[224:227], v2 offset:28672
    ds_read_b128 v[228:231], v2 offset:29696
    ds_read_b128 v[232:235], v2 offset:30720
    ds_read_b128 v[236:239], v2 offset:31744
    s_waitcnt lgkmcnt(0)
    v_pk_mul_f32 v[240:241], v[80:81], v[208:209]
    v_pk_mul_f32 v[208:209], v[112:113], v[208:209]
    v_pk_fma_f32 v[240:241], v[112:113], v[224:225], v[240:241] neg_lo:[1,0,0] neg_hi:[1,0,0]
    v_pk_fma_f32 v[208:209], v[80:81], v[224:225], v[208:209]
    v_pk_mul_f32 v[242:243], v[82:83], v[210:211]
    v_pk_mul_f32 v[210:211], v[114:115], v[210:211]
    v_pk_fma_f32 v[242:243], v[114:115], v[226:227], v[242:243] neg_lo:[1,0,0] neg_hi:[1,0,0]
    v_pk_fma_f32 v[210:211], v[82:83], v[226:227], v[210:211]
    v_pk_mul_f32 v[244:245], v[84:85], v[212:213]
    v_pk_mul_f32 v[212:213], v[116:117], v[212:213]
    v_pk_fma_f32 v[244:245], v[116:117], v[228:229], v[244:245] neg_lo:[1,0,0] neg_hi:[1,0,0]
    v_pk_fma_f32 v[212:213], v[84:85], v[228:229], v[212:213]
    v_pk_mul_f32 v[246:247], v[86:87], v[214:215]
    v_pk_mul_f32 v[214:215], v[118:119], v[214:215]
    v_pk_fma_f32 v[246:247], v[118:119], v[230:231], v[246:247] neg_lo:[1,0,0] neg_hi:[1,0,0]
    v_pk_fma_f32 v[214:215], v[86:87], v[230:231], v[214:215]
    v_pk_mul_f32 v[248:249], v[88:89], v[216:217]
    v_pk_mul_f32 v[216:217], v[120:121], v[216:217]
    v_pk_fma_f32 v[248:249], v[120:121], v[232:233], v[248:249] neg_lo:[1,0,0] neg_hi:[1,0,0]
    v_pk_fma_f32 v[216:217], v[88:89], v[232:233], v[216:217]
    v_pk_mul_f32 v[250:251], v[90:91], v[218:219]
    v_pk_mul_f32 v[218:219], v[122:123], v[218:219]
    v_pk_fma_f32 v[250:251], v[122:123], v[234:235], v[250:251] neg_lo:[1,0,0] neg_hi:[1,0,0]
    v_pk_fma_f32 v[218:219], v[90:91], v[234:235], v[218:219]
    v_pk_mul_f32 v[252:253], v[92:93], v[220:221]
    v_pk_mul_f32 v[220:221], v[124:125], v[220:221]
    v_pk_fma_f32 v[252:253], v[124:125], v[236:237], v[252:253] neg_lo:[1,0,0] neg_hi:[1,0,0]
    v_pk_fma_f32 v[220:221], v[92:93], v[236:237], v[220:221]
    v_pk_mul_f32 v[254:255], v[94:95], v[222:223]
    v_pk_mul_f32 v[222:223], v[126:127], v[222:223]
    v_pk_fma_f32 v[254:255], v[126:127], v[238:239], v[254:255] neg_lo:[1,0,0] neg_hi:[1,0,0]
    v_pk_fma_f32 v[222:223], v[94:95], v[238:239], v[222:223]
    v_cvt_pk_bf16_f32 v24, v240, v241
    v_cvt_pk_bf16_f32 v40, v208, v209
    v_cvt_pk_bf16_f32 v56, -v208, -v209
    v_cvt_pk_bf16_f32 v25, v242, v243
    v_cvt_pk_bf16_f32 v41, v210, v211
    v_cvt_pk_bf16_f32 v57, -v210, -v211
    v_cvt_pk_bf16_f32 v26, v244, v245
    v_cvt_pk_bf16_f32 v42, v212, v213
    v_cvt_pk_bf16_f32 v58, -v212, -v213
    v_cvt_pk_bf16_f32 v27, v246, v247
    v_cvt_pk_bf16_f32 v43, v214, v215
    v_cvt_pk_bf16_f32 v59, -v214, -v215
    v_cvt_pk_bf16_f32 v28, v248, v249
    v_cvt_pk_bf16_f32 v44, v216, v217
    v_cvt_pk_bf16_f32 v60, -v216, -v217
    v_cvt_pk_bf16_f32 v29, v250, v251
    v_cvt_pk_bf16_f32 v45, v218, v219
    v_cvt_pk_bf16_f32 v61, -v218, -v219
    v_cvt_pk_bf16_f32 v30, v252, v253
    v_cvt_pk_bf16_f32 v46, v220, v221
    v_cvt_pk_bf16_f32 v62, -v220, -v221
    v_cvt_pk_bf16_f32 v31, v254, v255
    v_cvt_pk_bf16_f32 v47, v222, v223
    v_cvt_pk_bf16_f32 v63, -v222, -v223
    s_lshr_b32 s51, s49, 3
    s_sub_u32 s3, s51, 12
    s_cselect_b32 s3, 0, s3
    s_mul_i32 s3, s3, 0
    s_add_u32 s51, s51, s3
    s_cmp_ge_u32 s51, 36
    s_cselect_b32 s3, 23, 0
    s_sub_u32 s51, s51, s3
    s_and_b32 s3, s49, 7
    s_mul_i32 s3, s3, 0
    s_lshr_b32 s3, s3, 1
    s_add_u32 s51, s51, s3
    s_sub_u32 s3, s51, 36
    s_cselect_b32 s51, s51, s3
    s_lshl_b32 s51, s51, 9
    s_and_b32 s3, s49, 7
    s_add_u32 s51, s51, s3
    s_lshl_b32 s51, s51, 8
    s_add_u32 s51, s51, s50
    buffer_load_dword v8, v5, s[20:23], s51 offen
    s_add_u32 s49, s49, 40
    v_mfma_f32_32x32x16_bf16 v[64:79], v[16:19], v[192:195], 0
    v_mfma_f32_32x32x16_bf16 v[96:111], v[32:35], v[192:195], 0
    v_mfma_f32_32x32x16_bf16 v[64:79], v[48:51], v[200:203], v[64:79]
    v_mfma_f32_32x32x16_bf16 v[96:111], v[16:19], v[200:203], v[96:111]
    v_mfma_f32_32x32x16_bf16 v[64:79], v[20:23], v[196:199], v[64:79]
    v_mfma_f32_32x32x16_bf16 v[96:111], v[36:39], v[196:199], v[96:111]
    v_mfma_f32_32x32x16_bf16 v[64:79], v[52:55], v[204:207], v[64:79]
    v_mfma_f32_32x32x16_bf16 v[96:111], v[20:23], v[204:207], v[96:111]
    v_mfma_f32_32x32x16_bf16 v[80:95], v[24:27], v[192:195], 0
    v_mfma_f32_32x32x16_bf16 v[112:127], v[40:43], v[192:195], 0
    v_mfma_f32_32x32x16_bf16 v[80:95], v[56:59], v[200:203], v[80:95]
    v_mfma_f32_32x32x16_bf16 v[112:127], v[24:27], v[200:203], v[112:127]
    v_mfma_f32_32x32x16_bf16 v[80:95], v[28:31], v[196:199], v[80:95]
    v_mfma_f32_32x32x16_bf16 v[112:127], v[44:47], v[196:199], v[112:127]
    v_mfma_f32_32x32x16_bf16 v[80:95], v[60:63], v[204:207], v[80:95]
    v_mfma_f32_32x32x16_bf16 v[112:127], v[28:31], v[204:207], v[112:127]
    s_nop 2
    v_cvt_pk_bf16_f32 v208, v64, v65
    v_cvt_pk_bf16_f32 v209, v66, v67
    v_cvt_pk_bf16_f32 v210, v68, v69
    v_cvt_pk_bf16_f32 v211, v70, v71
    v_cvt_pk_bf16_f32 v212, v72, v73
    v_cvt_pk_bf16_f32 v213, v74, v75
    v_cvt_pk_bf16_f32 v214, v76, v77
    v_cvt_pk_bf16_f32 v215, v78, v79
    ds_write_b128 v12, v[208:211] offset:0
    ds_write_b128 v13, v[212:215] offset:0
    v_cvt_pk_bf16_f32 v216, v96, v97
    v_cvt_pk_bf16_f32 v217, v98, v99
    v_cvt_pk_bf16_f32 v218, v100, v101
    v_cvt_pk_bf16_f32 v219, v102, v103
    v_cvt_pk_bf16_f32 v220, v104, v105
    v_cvt_pk_bf16_f32 v221, v106, v107
    v_cvt_pk_bf16_f32 v222, v108, v109
    v_cvt_pk_bf16_f32 v223, v110, v111
    ds_write_b128 v14, v[216:219] offset:0
    ds_write_b128 v15, v[220:223] offset:0
    ds_read_b128 v[16:19], v1 offset:0
    ds_read_b128 v[20:23], v1 offset:1024
    ds_read_b128 v[24:27], v1 offset:2048
    ds_read_b128 v[28:31], v1 offset:3072
    v_cvt_pk_bf16_f32 v224, v80, v81
    v_cvt_pk_bf16_f32 v225, v82, v83
    v_cvt_pk_bf16_f32 v226, v84, v85
    v_cvt_pk_bf16_f32 v227, v86, v87
    v_cvt_pk_bf16_f32 v228, v88, v89
    v_cvt_pk_bf16_f32 v229, v90, v91
    v_cvt_pk_bf16_f32 v230, v92, v93
    v_cvt_pk_bf16_f32 v231, v94, v95
    ds_write_b128 v12, v[224:227] offset:4096
    ds_write_b128 v13, v[228:231] offset:4096
    v_cvt_pk_bf16_f32 v232, v112, v113
    v_cvt_pk_bf16_f32 v233, v114, v115
    v_cvt_pk_bf16_f32 v234, v116, v117
    v_cvt_pk_bf16_f32 v235, v118, v119
    v_cvt_pk_bf16_f32 v236, v120, v121
    v_cvt_pk_bf16_f32 v237, v122, v123
    v_cvt_pk_bf16_f32 v238, v124, v125
    v_cvt_pk_bf16_f32 v239, v126, v127
    ds_write_b128 v14, v[232:235] offset:4096
    ds_write_b128 v15, v[236:239] offset:4096
    ds_read_b128 v[32:35], v1 offset:4096
    ds_read_b128 v[36:39], v1 offset:5120
    ds_read_b128 v[40:43], v1 offset:6144
    ds_read_b128 v[44:47], v1 offset:7168
    s_mov_b64 exec, s[44:45]
    s_waitcnt lgkmcnt(10)
    buffer_store_dwordx4 v[16:19], v6, s[12:15], s35 offen offset:0 sc1
    s_waitcnt lgkmcnt(8)
    buffer_store_dwordx4 v[24:27], v6, s[12:15], s40 offen offset:0 sc1
    s_waitcnt lgkmcnt(2)
    buffer_store_dwordx4 v[32:35], v6, s[12:15], s35 offen offset:128 sc1
    s_waitcnt lgkmcnt(0)
    buffer_store_dwordx4 v[40:43], v6, s[12:15], s40 offen offset:128 sc1
    s_mov_b64 exec, s[46:47]
    buffer_store_dwordx4 v[20:23], v7, s[12:15], s35 offen offset:2048 sc1
    buffer_store_dwordx4 v[28:31], v7, s[12:15], s40 offen offset:2048 sc1
    buffer_store_dwordx4 v[36:39], v7, s[12:15], s35 offen offset:2176 sc1
    buffer_store_dwordx4 v[44:47], v7, s[12:15], s40 offen offset:2176 sc1
    s_mov_b64 exec, -1
    s_lshl_b32 s41, s33, 7
    s_add_u32 s41, s41, 184320
    s_waitcnt vmcnt(0)
    s_barrier
    s_cmp_lg_u32 s30, 0
    s_cbranch_scc1 .fdone_35
    s_mov_b64 exec, 1
    v_mov_b64 v[10:11], s[96:97]
    buffer_store_dwordx2 v[10:11], off, s[8:11], s41 sc1
    s_mov_b64 exec, -1
    s_branch .fdone_35
.idle_34:
    s_mov_b32 s41, 65536
    v_lshlrev_b32 v9, 7, v0
    s_mov_b32 s3, 0x40000
.poll_43:
    buffer_load_dwordx2 v[10:11], v9, s[8:11], s41 offen sc1
    s_sub_u32 s3, s3, 1
    s_cbranch_scc1 .got_44
    s_waitcnt vmcnt(0)
    v_cmp_ne_u64 vcc, s[96:97], v[10:11]
    s_cbranch_vccnz .poll_43
.got_44:
    s_lshr_b32 s51, s49, 3
    s_sub_u32 s3, s51, 12
    s_cselect_b32 s3, 0, s3
    s_mul_i32 s3, s3, 0
    s_add_u32 s51, s51, s3
    s_cmp_ge_u32 s51, 36
    s_cselect_b32 s3, 23, 0
    s_sub_u32 s51, s51, s3
    s_and_b32 s3, s49, 7
    s_mul_i32 s3, s3, 0
    s_lshr_b32 s3, s3, 1
    s_add_u32 s51, s51, s3
    s_sub_u32 s3, s51, 36
    s_cselect_b32 s51, s51, s3
    s_lshl_b32 s51, s51, 9
    s_and_b32 s3, s49, 7
    s_add_u32 s51, s51, s3
    s_lshl_b32 s51, s51, 8
    s_add_u32 s51, s51, s50
    buffer_load_dword v8, v5, s[20:23], s51 offen
    s_add_u32 s49, s49, 40
    s_lshr_b32 s51, s49, 3
    s_sub_u32 s3, s51, 12
    s_cselect_b32 s3, 0, s3
    s_mul_i32 s3, s3, 0
    s_add_u32 s51, s51, s3
    s_cmp_ge_u32 s51, 36
    s_cselect_b32 s3, 23, 0
    s_sub_u32 s51, s51, s3
    s_and_b32 s3, s49, 7
    s_mul_i32 s3, s3, 0
    s_lshr_b32 s3, s3, 1
    s_add_u32 s51, s51, s3
    s_sub_u32 s3, s51, 36
    s_cselect_b32 s51, s51, s3
    s_lshl_b32 s51, s51, 9
    s_and_b32 s3, s49, 7
    s_add_u32 s51, s51, s3
    s_lshl_b32 s51, s51, 8
    s_add_u32 s51, s51, s50
    buffer_load_dword v8, v5, s[20:23], s51 offen
    s_add_u32 s49, s49, 40
    s_lshr_b32 s51, s49, 3
    s_sub_u32 s3, s51, 12
    s_cselect_b32 s3, 0, s3
    s_mul_i32 s3, s3, 0
    s_add_u32 s51, s51, s3
    s_cmp_ge_u32 s51, 36
    s_cselect_b32 s3, 23, 0
    s_sub_u32 s51, s51, s3
    s_and_b32 s3, s49, 7
    s_mul_i32 s3, s3, 0
    s_lshr_b32 s3, s3, 1
    s_add_u32 s51, s51, s3
    s_sub_u32 s3, s51, 36
    s_cselect_b32 s51, s51, s3
    s_lshl_b32 s51, s51, 9
    s_and_b32 s3, s49, 7
    s_add_u32 s51, s51, s3
    s_lshl_b32 s51, s51, 8
    s_add_u32 s51, s51, s50
    buffer_load_dword v8, v5, s[20:23], s51 offen
    s_add_u32 s49, s49, 40
    s_lshr_b32 s51, s49, 3
    s_sub_u32 s3, s51, 12
    s_cselect_b32 s3, 0, s3
    s_mul_i32 s3, s3, 0
    s_add_u32 s51, s51, s3
    s_cmp_ge_u32 s51, 36
    s_cselect_b32 s3, 23, 0
    s_sub_u32 s51, s51, s3
    s_and_b32 s3, s49, 7
    s_mul_i32 s3, s3, 0
    s_lshr_b32 s3, s3, 1
    s_add_u32 s51, s51, s3
    s_sub_u32 s3, s51, 36
    s_cselect_b32 s51, s51, s3
    s_lshl_b32 s51, s51, 9
    s_and_b32 s3, s49, 7
    s_add_u32 s51, s51, s3
    s_lshl_b32 s51, s51, 8
    s_add_u32 s51, s51, s50
    buffer_load_dword v8, v5, s[20:23], s51 offen
    s_add_u32 s49, s49, 40
    s_waitcnt vmcnt(0)
.fdone_35:
    s_and_b32 s35, s30, 3
    s_cmp_ge_u32 s30, 4
    s_cbranch_scc1 .tabs_6
    s_lshl_b32 s49, s32, 2
    s_add_u32 s49, s49, s30
    s_add_u32 s49, s49, 160
    s_mov_b32 s20, s64
    s_mov_b32 s21, s65
    s_mov_b32 s22, 18874368
    s_mov_b32 s23, 0x20000
    s_and_b32 s3, s2, 3
    s_mul_i32 s50, s3, 4718592
    s_bfe_u32 s3, s2, 0x10002
    s_lshl_b32 s3, s3, 11
    s_add_u32 s50, s50, s3
    v_lshrrev_b32 v5, 1, v0
    v_mul_u32_u24 v5, 3840, v5
    v_lshl_add_u32 v5, v0, 7, v5
    s_lshr_b32 s51, s49, 3
    s_sub_u32 s3, s51, 12
    s_cselect_b32 s3, 0, s3
    s_mul_i32 s3, s3, 0
    s_add_u32 s51, s51, s3
    s_cmp_ge_u32 s51, 36
    s_cselect_b32 s3, 23, 0
    s_sub_u32 s51, s51, s3
    s_and_b32 s3, s49, 7
    s_mul_i32 s3, s3, 0
    s_lshr_b32 s3, s3, 1
    s_add_u32 s51, s51, s3
    s_sub_u32 s3, s51, 36
    s_cselect_b32 s51, s51, s3
    s_lshl_b32 s51, s51, 9
    s_and_b32 s3, s49, 7
    s_add_u32 s51, s51, s3
    s_lshl_b32 s51, s51, 8
    s_add_u32 s51, s51, s50
    buffer_load_dword v250, v5, s[20:23], s51 offen
    s_add_u32 s49, s49, 20
    s_lshr_b32 s51, s49, 3
    s_sub_u32 s3, s51, 12
    s_cselect_b32 s3, 0, s3
    s_mul_i32 s3, s3, 0
    s_add_u32 s51, s51, s3
    s_cmp_ge_u32 s51, 36
    s_cselect_b32 s3, 23, 0
    s_sub_u32 s51, s51, s3
    s_and_b32 s3, s49, 7
    s_mul_i32 s3, s3, 0
    s_lshr_b32 s3, s3, 1
    s_add_u32 s51, s51, s3
    s_sub_u32 s3, s51, 36
    s_cselect_b32 s51, s51, s3
    s_lshl_b32 s51, s51, 9
    s_and_b32 s3, s49, 7
    s_add_u32 s51, s51, s3
    s_lshl_b32 s51, s51, 8
    s_add_u32 s51, s51, s50
    buffer_load_dword v250, v5, s[20:23], s51 offen
    s_add_u32 s49, s49, 20
    s_barrier
    s_barrier
    s_barrier
    s_barrier
    s_barrier
    s_barrier
    s_branch .c2_8
.end_1:
    s_endpgm
.Lkend:
.section .rodata,"a"
.p2align 6
.amdhsa_kernel gated_mix__spectral_gfnet__mixer_token_mlp__prompt_kernel
  .amdhsa_next_free_vgpr 256
  .amdhsa_next_free_sgpr 102
  .amdhsa_accum_offset 256
  .amdhsa_group_segment_fixed_size 0
  .amdhsa_kernarg_size 96
  .amdhsa_user_sgpr_count 2
  .amdhsa_user_sgpr_kernarg_segment_ptr 1
  .amdhsa_system_sgpr_workgroup_id_x 1
  .amdhsa_float_denorm_mode_32 3
.end_amdhsa_kernel
```
